```python
import torch

def _softmax(x, axis=-1):
    return torch.softmax(x, dim=axis)
def _gelu(x):
    return torch.nn.functional.gelu(x, approximate="tanh")
def _silu(x):
    return torch.nn.functional.silu(x)
def _sigmoid(x):
    return torch.sigmoid(x)
def _layernorm(x, axis=-1, eps=1e-5):
    m = x.mean(dim=axis, keepdim=True)
    v = x.var(dim=axis, keepdim=True, unbiased=False)
    return (x - m) / torch.sqrt(v + eps)
def _scatter_add(tgt, idx, src, axis=0):
    return tgt.clone().index_add_(axis, idx, src)
def _segment_sum(src, seg, n):
    out = torch.zeros((n,) + src.shape[1:], dtype=src.dtype)
    return out.index_add_(0, seg, src)
def _pad(x, pw):
    flat = tuple(v for pair in reversed(pw) for v in pair)
    return torch.nn.functional.pad(x, flat)

kernel_name = 'gated_mix__linear_kernel_hedgehog__mixer_s_mlp__prompt'

def setup_inputs():

    _w = (lambda a: (lambda t: t.to(torch.bfloat16) if t.is_floating_point() else t)(torch.as_tensor(a)))
    def _A_setup():
        B, S, D, H = 1, 2048, 512, 32
        Dh = D // H
        return {
            "x": _w((lambda *s: torch.randn(*s, dtype=torch.bfloat16) * 0.05)(B, S, D)),
            "wqkv": _w((lambda *s: torch.randn(*s, dtype=torch.bfloat16) * 3.2)(D, 3 * D)),
            "w_phi": _w((lambda *s: torch.randn(*s, dtype=torch.bfloat16) * 3.2)(H, Dh, Dh) * (Dh ** -0.5)),
            "wo": _w((lambda *s: torch.randn(*s, dtype=torch.bfloat16) * 1.6)(D, D)),
        }
    _A_in = _A_setup()

    def _B_setup():
        B, S, D, F = 1, 2048, 512, 1376
        return {
            "x":  _w((lambda *s: torch.randn(*s, dtype=torch.bfloat16) * 0.05)(B, S, D)),
            "w1": _w((lambda *s: torch.randn(*s, dtype=torch.bfloat16) * 3.2)(D, D) * (D ** -0.5)),
            "w2": _w((lambda *s: torch.randn(*s, dtype=torch.bfloat16) * 3.2)(D, D) * (D ** -0.5)),
            "w3": _w((lambda *s: torch.randn(*s, dtype=torch.bfloat16) * 3.2)(D, F) * (D ** -0.5)),
            "w4": _w((lambda *s: torch.randn(*s, dtype=torch.bfloat16) * 3.2)(F, D) * (F ** -0.5)),
        }
    _B_in = _B_setup()

    return {
        "A_x": _A_in["x"],
        "A_wqkv": _A_in["wqkv"],
        "A_w_phi": _A_in["w_phi"],
        "A_wo": _A_in["wo"],
        "B_x": _B_in["x"],
        "B_w1": _B_in["w1"],
        "B_w2": _B_in["w2"],
        "B_w3": _B_in["w3"],
        "B_w4": _B_in["w4"],
        "gate_w": _w((lambda *s: torch.randn(*s, dtype=torch.bfloat16) * 0.05)(512) * 16.0),
    }

def reference(A_x, A_wqkv, A_w_phi, A_wo, B_x, B_w1, B_w2, B_w3, B_w4, gate_w):
    def _A_ref(x, wqkv, w_phi, wo):
        B, S, D = x.shape
        H = 32; Dh = D // H
        qkv = (lambda x, *d: x.permute(*d))((x @ wqkv).reshape(B, S, 3, H, Dh), 2, 0, 3, 1, 4)
        q, k, v = qkv[0], qkv[1], qkv[2]
        pq = torch.einsum("bhsd,hdf->bhsf", q, w_phi)
        pk = torch.einsum("bhsd,hdf->bhsf", k, w_phi)
        phi_q = torch.concatenate([_softmax(pq, axis=-1), _softmax(-pq, axis=-1)], axis=-1)
        phi_k = torch.concatenate([_softmax(pk, axis=-1), _softmax(-pk, axis=-1)], axis=-1)
        kv = torch.einsum("bhsf,bhsd->bhfd", phi_k, v)
        z  = torch.einsum("bhsf->bhf", phi_k)
        num = torch.einsum("bhqf,bhfd->bhqd", phi_q, kv)
        den = torch.einsum("bhqf,bhf->bhq", phi_q, z)[..., None] + 1e-6
        o = num / den
        return (lambda x, *d: x.permute(*d))(o, 0, 2, 1, 3).reshape(B, S, D) @ wo

    def _B_ref(x, w1, w2, w3, w4):
        B, S, D = x.shape
        h = _gelu(_layernorm(x, axis=-1) @ w1)
        c = D // 4
        g0 = _pad(h[:, :, 0*c:1*c], ((0, 0), (1, 0), (0, 0)))[:, :S, :]
        g1 = _pad(h[:, :, 1*c:2*c], ((0, 0), (0, 1), (0, 0)))[:, 1:, :]
        g2 = _pad(h[:, :, 2*c:3*c], ((0, 0), (2, 0), (0, 0)))[:, :S, :]
        g3 = _pad(h[:, :, 3*c:   ], ((0, 0), (0, 2), (0, 0)))[:, 2:, :]
        hs = torch.concatenate([g0, g1, g2, g3], axis=-1) @ w2
        x1 = x + hs
        h2 = _gelu(_layernorm(x1, axis=-1) @ w3) @ w4
        return x1 + h2

    x = A_x
    g = _sigmoid((x * gate_w).sum(-1, keepdims=True))
    a = _A_ref(x, A_wqkv, A_w_phi, A_wo)
    b = _B_ref(x, B_w1, B_w2, B_w3, B_w4)
    return g * a + (1 - g) * b
```

```asm
; @launch grid=(256,1,1) block=(512,1,1) lds=163840
.amdgcn_target "amdgcn-amd-amdhsa--gfx950"
.text
.globl gated_mix__linear_kernel_hedgehog__mixer_s_mlp__prompt_kernel
.p2align 8
.type gated_mix__linear_kernel_hedgehog__mixer_s_mlp__prompt_kernel,@function
gated_mix__linear_kernel_hedgehog__mixer_s_mlp__prompt_kernel:
  s_getpc_b64 s[96:97]
L_pc:
  s_cmp_ge_u32 s2, 8
  s_cbranch_scc1 L_nopf0b
  v_lshlrev_b32 v2, 7, v0
  v_cmp_gt_u32 vcc, L_end-L_pc, v2
  s_nop 3
  s_and_saveexec_b64 s[98:99], vcc
  s_cbranch_execz L_nopf0
  global_load_dword v3, v2, s[96:97]
L_nopf0:
  s_mov_b64 exec, s[98:99]
L_nopf0b:
  s_cmp_ge_u32 s2, 256
  s_cbranch_scc1 L_end
  s_load_dwordx16 s[8:23], s[0:1], 0
  s_load_dwordx8 s[24:31], s[0:1], 64
  s_load_dwordx2 s[32:33], s[0:1], 96
  v_lshrrev_b32 v1, 6, v0
  v_and_b32 v0, 63, v0
  v_readfirstlane_b32 s35, v1
  s_and_b32 s36, s2, 7
  s_lshr_b32 s37, s2, 3
  s_and_b32 s72, s36, 1
  s_lshl_b32 s72, s72, 3
  s_and_b32 s73, s37, 7
  s_add_u32 s38, s72, s73
  s_lshr_b32 s72, s36, 1
  s_lshl_b32 s72, s72, 2
  s_lshr_b32 s74, s37, 3
  s_add_u32 s39, s72, s74
  s_lshl_b32 s74, s74, 1
  s_add_u32 s59, s73, s74
  s_and_b32 s59, s59, 7
  s_and_b32 s57, s35, 1
  s_bfe_u32 s56, s35, 0x10001
  s_and_b32 s58, s35, 3
  s_cmp_lt_u32 s35, 4
  s_cbranch_scc1 L_compute
  v_mov_b32 v33, 0
  s_lshl_b32 s63, s58, 12
  s_lshl_b32 s64, s58, 11
  v_lshrrev_b32 v40, 3, v0
  v_and_b32 v41, 7, v0
  v_lshrrev_b32 v42, 4, v0
  s_lshl_b32 s72, s38, 2
  s_add_u32 s72, s72, s58
  s_lshl_b32 s72, s72, 15
  v_lshlrev_b32 v40, 10, v40
  v_add_u32 v40, s72, v40
  v_xor_b32 v43, v42, v41
  v_lshlrev_b32 v43, 4, v43
  v_add_u32 v4, v40, v43
  v_xor_b32 v43, 64, v43
  v_add_u32 v43, v40, v43
  v_add_u32 v5, 7168, v43
  v_add_u32 v6, 14336, v4
  v_add_u32 v7, 21504, v43
  s_and_b32 s75, s39, 7
  s_lshl_b32 s75, s75, 7
  s_cmp_lt_u32 s39, 8
  s_cselect_b32 s74, 1024, 0
  s_add_u32 s74, s74, s75
  s_cmp_lt_u32 s39, 8
  s_cselect_b32 s76, 2048, 0
  s_add_u32 s75, s75, s76
  s_movk_i32 s72, 3072
  s_cmp_lt_u32 s39, 8
  s_cselect_b32 s73, s72, 1024
  v_lshrrev_b32 v40, 3, v0
  s_lshl_b32 s78, s58, 4
  v_add_u32 v40, s78, v40
  v_bfe_u32 v41, v0, 4, 1
  v_lshlrev_b32 v41, 2, v41
  v_and_b32 v42, 7, v0
  v_xor_b32 v41, v41, v42
  v_lshlrev_b32 v41, 4, v41
  v_mul_lo_u32 v42, v40, s72
  v_add_u32 v42, v42, v41
  v_add_u32 v8, s74, v42
  s_lshl_b32 s78, s72, 3
  s_sub_u32 s78, s78, 1024
  v_add_u32 v9, s78, v8
  s_lshl_b32 s65, s72, 6
  v_mul_lo_u32 v42, v40, s73
  v_add_u32 v42, v42, v41
  v_add_u32 v10, s75, v42
  s_lshl_b32 s78, s73, 3
  s_sub_u32 s78, s78, 1024
  v_add_u32 v11, s78, v10
  s_lshl_b32 s66, s73, 6
  v_lshlrev_b32 v32, 4, v0
  s_waitcnt lgkmcnt(0)
  s_mov_b32 s40, s8
  s_mov_b32 s41, s9
  s_mov_b32 s42, 0x200000
  s_mov_b32 s43, 0x20000
  s_mov_b32 s44, s10
  s_mov_b32 s45, s11
  s_mov_b32 s46, 0x180000
  s_mov_b32 s47, 0x20000
  s_cmp_lt_u32 s39, 8
  s_cselect_b32 s4, s10, s18
  s_cselect_b32 s5, s11, s19
  s_mov_b32 s72, 0x180000
  s_cselect_b32 s6, s72, 0x80000
  s_mov_b32 s7, 0x20000
  s_add_u32 s72, s59, 0
  s_and_b32 s72, s72, 7
  s_lshl_b32 s75, s72, 7
  s_add_u32 m0, s63, 0
  s_nop 0
  buffer_load_dwordx4 v4, s[40:43], s75 offen lds
  buffer_load_dwordx4 v5, s[40:43], s75 offen offset:1024 lds
  buffer_load_dwordx4 v6, s[40:43], s75 offen offset:2048 lds
  buffer_load_dwordx4 v7, s[40:43], s75 offen offset:3072 lds
  s_mul_i32 s73, s72, s65
  s_mul_i32 s74, s72, s66
  s_add_u32 m0, s64, 65536
  s_nop 0
  buffer_load_dwordx4 v8, s[44:47], s73 offen lds
  buffer_load_dwordx4 v9, s[44:47], s73 offen offset:1024 lds
  s_add_u32 m0, s64, 73728
  s_nop 0
  buffer_load_dwordx4 v10, s[4:7], s74 offen lds
  buffer_load_dwordx4 v11, s[4:7], s74 offen offset:1024 lds
  s_cmp_lt_u32 s39, 8
  s_cbranch_scc0 L_h1_small_done
  s_mov_b32 s52, s12
  s_mov_b32 s53, s13
  s_mov_b32 s54, 0x4000
  s_mov_b32 s55, 0x20000
  s_lshl_b32 s72, s39, 11
  s_lshl_b32 s73, s58, 10
  s_add_u32 s72, s72, s73
  s_add_u32 m0, s73, 147456
  s_cmp_lt_u32 s58, 2
  s_cbranch_scc0 L_h1_small_done
  buffer_load_dwordx4 v32, s[52:55], s72 offen lds
L_h1_small_done:
  s_mov_b32 s48, s32
  s_mov_b32 s49, s33
  s_mov_b32 s50, 0x1400000
  s_mov_b32 s51, 0x20000
  s_add_u32 s72, s32, 0x1281000
  s_addc_u32 s73, s33, 0
  s_load_dword s34, s[72:73], 0
  s_add_u32 s72, s59, 1
  s_and_b32 s72, s72, 7
  s_lshl_b32 s75, s72, 7
  s_add_u32 m0, s63, 16384
  s_nop 0
  buffer_load_dwordx4 v4, s[40:43], s75 offen lds
  buffer_load_dwordx4 v5, s[40:43], s75 offen offset:1024 lds
  buffer_load_dwordx4 v6, s[40:43], s75 offen offset:2048 lds
  buffer_load_dwordx4 v7, s[40:43], s75 offen offset:3072 lds
  s_mul_i32 s73, s72, s65
  s_mul_i32 s74, s72, s66
  s_add_u32 m0, s64, 81920
  s_nop 0
  buffer_load_dwordx4 v8, s[44:47], s73 offen lds
  buffer_load_dwordx4 v9, s[44:47], s73 offen offset:1024 lds
  s_add_u32 m0, s64, 90112
  s_nop 0
  buffer_load_dwordx4 v10, s[4:7], s74 offen lds
  buffer_load_dwordx4 v11, s[4:7], s74 offen offset:1024 lds
  s_waitcnt lgkmcnt(0)
  s_mul_i32 s34, s34, 0x9e3779b1
  s_add_u32 s34, s34, 0x7f4a7c15
  s_waitcnt vmcnt(8)
  s_barrier
  s_add_u32 s72, s59, 2
  s_and_b32 s72, s72, 7
  s_lshl_b32 s75, s72, 7
  s_add_u32 m0, s63, 32768
  s_nop 0
  buffer_load_dwordx4 v4, s[40:43], s75 offen lds
  buffer_load_dwordx4 v5, s[40:43], s75 offen offset:1024 lds
  buffer_load_dwordx4 v6, s[40:43], s75 offen offset:2048 lds
  buffer_load_dwordx4 v7, s[40:43], s75 offen offset:3072 lds
  s_mul_i32 s73, s72, s65
  s_mul_i32 s74, s72, s66
  s_add_u32 m0, s64, 98304
  s_nop 0
  buffer_load_dwordx4 v8, s[44:47], s73 offen lds
  buffer_load_dwordx4 v9, s[44:47], s73 offen offset:1024 lds
  s_add_u32 m0, s64, 106496
  s_nop 0
  buffer_load_dwordx4 v10, s[4:7], s74 offen lds
  buffer_load_dwordx4 v11, s[4:7], s74 offen offset:1024 lds
  s_lshl_b32 s61, s36, 2
  s_and_b32 s72, s37, 3
  s_add_u32 s61, s61, s72
  s_lshr_b32 s62, s37, 2
  v_lshrrev_b32 v42, 3, v0
  s_lshl_b32 s72, s58, 5
  v_add_u32 v42, s72, v42
  v_lshlrev_b32 v42, 10, v42
  v_bfe_u32 v43, v0, 4, 1
  v_lshlrev_b32 v43, 2, v43
  v_and_b32 v12, 7, v0
  v_xor_b32 v43, v43, v12
  v_lshlrev_b32 v43, 4, v43
  v_add_u32 v42, v42, v43
  s_lshl_b32 s72, s62, 7
  v_add_u32 v12, s72, v42
  v_add_u32 v13, 7168, v12
  v_add_u32 v14, 7168, v13
  v_add_u32 v15, 7168, v14
  s_waitcnt vmcnt(8)
  s_barrier
  s_add_u32 s72, s59, 3
  s_and_b32 s72, s72, 7
  s_lshl_b32 s75, s72, 7
  s_add_u32 m0, s63, 49152
  s_nop 0
  buffer_load_dwordx4 v4, s[40:43], s75 offen lds
  buffer_load_dwordx4 v5, s[40:43], s75 offen offset:1024 lds
  buffer_load_dwordx4 v6, s[40:43], s75 offen offset:2048 lds
  buffer_load_dwordx4 v7, s[40:43], s75 offen offset:3072 lds
  s_mul_i32 s73, s72, s65
  s_mul_i32 s74, s72, s66
  s_add_u32 m0, s64, 114688
  s_nop 0
  buffer_load_dwordx4 v8, s[44:47], s73 offen lds
  buffer_load_dwordx4 v9, s[44:47], s73 offen offset:1024 lds
  s_add_u32 m0, s64, 122880
  s_nop 0
  buffer_load_dwordx4 v10, s[4:7], s74 offen lds
  buffer_load_dwordx4 v11, s[4:7], s74 offen offset:1024 lds
  s_waitcnt vmcnt(8)
  s_barrier
  s_add_u32 s72, s59, 4
  s_and_b32 s72, s72, 7
  s_lshl_b32 s75, s72, 7
  s_add_u32 m0, s63, 0
  s_nop 0
  buffer_load_dwordx4 v4, s[40:43], s75 offen lds
  buffer_load_dwordx4 v5, s[40:43], s75 offen offset:1024 lds
  buffer_load_dwordx4 v6, s[40:43], s75 offen offset:2048 lds
  buffer_load_dwordx4 v7, s[40:43], s75 offen offset:3072 lds
  s_mul_i32 s73, s72, s65
  s_mul_i32 s74, s72, s66
  s_add_u32 m0, s64, 65536
  s_nop 0
  buffer_load_dwordx4 v8, s[44:47], s73 offen lds
  buffer_load_dwordx4 v9, s[44:47], s73 offen offset:1024 lds
  s_add_u32 m0, s64, 73728
  s_nop 0
  buffer_load_dwordx4 v10, s[4:7], s74 offen lds
  buffer_load_dwordx4 v11, s[4:7], s74 offen offset:1024 lds
  s_lshl_b32 s72, s2, 2
  s_add_u32 s72, s72, s58
  s_mov_b32 s52, s20
  s_mov_b32 s53, s21
  s_mov_b32 s54, 0x80000
  s_mov_b32 s55, 0x20000
  s_lshl_b32 s73, s72, 10
  buffer_load_dwordx4 v[36:39], v32, s[52:55], s73 offen
  s_mov_b32 s52, s14
  s_mov_b32 s53, s15
  s_mov_b32 s54, 0x80000
  s_mov_b32 s55, 0x20000
  s_lshl_b32 s73, s72, 10
  buffer_load_dwordx4 v[36:39], v32, s[52:55], s73 offen
  s_mov_b32 s52, s22
  s_mov_b32 s53, s23
  s_mov_b32 s54, 0x158000
  s_mov_b32 s55, 0x20000
  s_lshl_b32 s73, s72, 10
  buffer_load_dwordx4 v[36:39], v32, s[52:55], s73 offen
  s_add_u32 s73, s73, 0x100000
  buffer_load_dwordx4 v[36:39], v32, s[52:55], s73 offen
  s_mov_b32 s52, s24
  s_mov_b32 s53, s25
  s_mov_b32 s54, 0x158000
  s_mov_b32 s55, 0x20000
  s_lshl_b32 s73, s72, 10
  buffer_load_dwordx4 v[36:39], v32, s[52:55], s73 offen
  s_add_u32 s73, s73, 0x100000
  buffer_load_dwordx4 v[36:39], v32, s[52:55], s73 offen
  s_waitcnt vmcnt(14)
  s_barrier
  s_add_u32 s72, s59, 5
  s_and_b32 s72, s72, 7
  s_lshl_b32 s75, s72, 7
  s_add_u32 m0, s63, 16384
  s_nop 0
  buffer_load_dwordx4 v4, s[40:43], s75 offen lds
  buffer_load_dwordx4 v5, s[40:43], s75 offen offset:1024 lds
  buffer_load_dwordx4 v6, s[40:43], s75 offen offset:2048 lds
  buffer_load_dwordx4 v7, s[40:43], s75 offen offset:3072 lds
  s_mul_i32 s73, s72, s65
  s_mul_i32 s74, s72, s66
  s_add_u32 m0, s64, 81920
  s_nop 0
  buffer_load_dwordx4 v8, s[44:47], s73 offen lds
  buffer_load_dwordx4 v9, s[44:47], s73 offen offset:1024 lds
  s_add_u32 m0, s64, 90112
  s_nop 0
  buffer_load_dwordx4 v10, s[4:7], s74 offen lds
  buffer_load_dwordx4 v11, s[4:7], s74 offen offset:1024 lds
  s_waitcnt vmcnt(14)
  s_barrier
  s_add_u32 s72, s59, 6
  s_and_b32 s72, s72, 7
  s_lshl_b32 s75, s72, 7
  s_add_u32 m0, s63, 32768
  s_nop 0
  buffer_load_dwordx4 v4, s[40:43], s75 offen lds
  buffer_load_dwordx4 v5, s[40:43], s75 offen offset:1024 lds
  buffer_load_dwordx4 v6, s[40:43], s75 offen offset:2048 lds
  buffer_load_dwordx4 v7, s[40:43], s75 offen offset:3072 lds
  s_mul_i32 s73, s72, s65
  s_mul_i32 s74, s72, s66
  s_add_u32 m0, s64, 98304
  s_nop 0
  buffer_load_dwordx4 v8, s[44:47], s73 offen lds
  buffer_load_dwordx4 v9, s[44:47], s73 offen offset:1024 lds
  s_add_u32 m0, s64, 106496
  s_nop 0
  buffer_load_dwordx4 v10, s[4:7], s74 offen lds
  buffer_load_dwordx4 v11, s[4:7], s74 offen offset:1024 lds
  s_waitcnt vmcnt(8)
  s_barrier
  s_add_u32 s72, s59, 7
  s_and_b32 s72, s72, 7
  s_lshl_b32 s75, s72, 7
  s_add_u32 m0, s63, 49152
  s_nop 0
  buffer_load_dwordx4 v4, s[40:43], s75 offen lds
  buffer_load_dwordx4 v5, s[40:43], s75 offen offset:1024 lds
  buffer_load_dwordx4 v6, s[40:43], s75 offen offset:2048 lds
  buffer_load_dwordx4 v7, s[40:43], s75 offen offset:3072 lds
  s_mul_i32 s73, s72, s65
  s_mul_i32 s74, s72, s66
  s_add_u32 m0, s64, 114688
  s_nop 0
  buffer_load_dwordx4 v8, s[44:47], s73 offen lds
  buffer_load_dwordx4 v9, s[44:47], s73 offen offset:1024 lds
  s_add_u32 m0, s64, 122880
  s_nop 0
  buffer_load_dwordx4 v10, s[4:7], s74 offen lds
  buffer_load_dwordx4 v11, s[4:7], s74 offen offset:1024 lds
  v_and_b32 v40, 7, v0
  v_lshlrev_b32 v40, 2, v40
  s_lshl_b32 s72, s2, 7
  s_add_u32 s68, s72, 0x1230000
  buffer_load_dword v41, v40, s[48:51], s68 offen sc1
  s_mov_b32 s52, s20
  s_mov_b32 s53, s21
  s_mov_b32 s54, 0x80000
  s_mov_b32 s55, 0x20000
  s_mov_b32 s72, 0x0
  s_add_u32 m0, s63, 65536
  s_nop 0
  buffer_load_dwordx4 v12, s[52:55], s72 offen lds
  buffer_load_dwordx4 v13, s[52:55], s72 offen offset:1024 lds
  buffer_load_dwordx4 v14, s[52:55], s72 offen offset:2048 lds
  buffer_load_dwordx4 v15, s[52:55], s72 offen offset:3072 lds
  s_waitcnt vmcnt(13)
  s_barrier
  s_mov_b32 s72, 0x20000
  s_add_u32 m0, s63, 81920
  s_nop 0
  buffer_load_dwordx4 v12, s[52:55], s72 offen lds
  buffer_load_dwordx4 v13, s[52:55], s72 offen offset:1024 lds
  buffer_load_dwordx4 v14, s[52:55], s72 offen offset:2048 lds
  buffer_load_dwordx4 v15, s[52:55], s72 offen offset:3072 lds
  s_waitcnt vmcnt(9)
  s_waitcnt vmcnt(8)
  s_cmp_lt_u32 s39, 8
  s_cbranch_scc1 L_h1_noxs
  s_cmp_lg_u32 s58, 0
  s_cbranch_scc1 L_h1_noxs
  s_mov_b32 s73, 0x40000
L_h1_xspoll:
  v_cmp_ne_u32 vcc, s34, v41
  s_nop 3
  s_cmp_eq_u64 vcc, 0
  s_cbranch_scc1 L_h1_xsok
  buffer_load_dword v41, v40, s[48:51], s68 offen sc1
  s_waitcnt vmcnt(0)
  s_sub_u32 s73, s73, 1
  s_cmp_lg_u32 s73, 0
  s_cbranch_scc1 L_h1_xspoll
L_h1_xsok:
  s_lshl_b32 s72, s38, 10
  s_add_u32 s72, s72, 0x1204000
  s_mov_b32 m0, 150528
  s_nop 0
  buffer_load_dwordx4 v32, s[48:51], s72 offen sc1 lds
L_h1_noxs:
  s_barrier
  s_mov_b32 s72, 0x40000
  s_add_u32 m0, s63, 98304
  s_nop 0
  buffer_load_dwordx4 v12, s[52:55], s72 offen lds
  buffer_load_dwordx4 v13, s[52:55], s72 offen offset:1024 lds
  buffer_load_dwordx4 v14, s[52:55], s72 offen offset:2048 lds
  buffer_load_dwordx4 v15, s[52:55], s72 offen offset:3072 lds
  s_waitcnt vmcnt(4)
L_h1_done:
  s_barrier
  s_mov_b32 s72, 0x60000
  s_add_u32 m0, s63, 114688
  s_nop 0
  buffer_load_dwordx4 v12, s[52:55], s72 offen lds
  buffer_load_dwordx4 v13, s[52:55], s72 offen offset:1024 lds
  buffer_load_dwordx4 v14, s[52:55], s72 offen offset:2048 lds
  buffer_load_dwordx4 v15, s[52:55], s72 offen offset:3072 lds
  v_lshrrev_b32 v40, 4, v0
  s_lshl_b32 s72, s61, 6
  s_lshl_b32 s73, s58, 4
  s_add_u32 s72, s72, s73
  v_and_b32 v41, 15, v0
  s_mov_b32 s74, 1024
  v_add_u32 v42, 0, v40
  v_xor_b32 v43, v42, v41
  v_lshlrev_b32 v43, 4, v43
  v_add_u32 v42, s72, v42
  v_add_u32 v42, 4294967295, v42
  v_mul_lo_u32 v16, v42, s74
  v_add_u32 v16, v16, v43
  v_cmp_gt_u32 vcc, 2048, v42
  v_mov_b32 v43, 0x80000000
  s_nop 0
  v_cndmask_b32 v16, v43, v16, vcc
  v_add_u32 v42, 4, v40
  v_xor_b32 v43, v42, v41
  v_lshlrev_b32 v43, 4, v43
  v_add_u32 v42, s72, v42
  v_add_u32 v42, 4294967295, v42
  v_mul_lo_u32 v17, v42, s74
  v_add_u32 v17, v17, v43
  v_add_u32 v17, 4294966272, v17
  v_cmp_gt_u32 vcc, 2048, v42
  v_mov_b32 v43, 0x80000000
  s_nop 0
  v_cndmask_b32 v17, v43, v17, vcc
  v_add_u32 v42, 8, v40
  v_xor_b32 v43, v42, v41
  v_lshlrev_b32 v43, 4, v43
  v_add_u32 v42, s72, v42
  v_add_u32 v42, 4294967295, v42
  v_mul_lo_u32 v18, v42, s74
  v_add_u32 v18, v18, v43
  v_add_u32 v18, 4294965248, v18
  v_cmp_gt_u32 vcc, 2048, v42
  v_mov_b32 v43, 0x80000000
  s_nop 0
  v_cndmask_b32 v18, v43, v18, vcc
  v_add_u32 v42, 12, v40
  v_xor_b32 v43, v42, v41
  v_lshlrev_b32 v43, 4, v43
  v_add_u32 v42, s72, v42
  v_add_u32 v42, 4294967295, v42
  v_mul_lo_u32 v19, v42, s74
  v_add_u32 v19, v19, v43
  v_add_u32 v19, 4294964224, v19
  v_cmp_gt_u32 vcc, 2048, v42
  v_mov_b32 v43, 0x80000000
  s_nop 0
  v_cndmask_b32 v19, v43, v19, vcc
  v_lshrrev_b32 v40, 4, v0
  s_lshl_b32 s72, s61, 6
  s_lshl_b32 s73, s58, 4
  s_add_u32 s72, s72, s73
  v_and_b32 v41, 15, v0
  s_mov_b32 s74, 1024
  v_add_u32 v42, 0, v40
  v_xor_b32 v43, v42, v41
  v_lshlrev_b32 v43, 4, v43
  v_add_u32 v42, s72, v42
  v_add_u32 v42, 1, v42
  v_mul_lo_u32 v20, v42, s74
  v_add_u32 v20, v20, v43
  v_cmp_gt_u32 vcc, 2048, v42
  v_mov_b32 v43, 0x80000000
  s_nop 0
  v_cndmask_b32 v20, v43, v20, vcc
  v_add_u32 v42, 4, v40
  v_xor_b32 v43, v42, v41
  v_lshlrev_b32 v43, 4, v43
  v_add_u32 v42, s72, v42
  v_add_u32 v42, 1, v42
  v_mul_lo_u32 v21, v42, s74
  v_add_u32 v21, v21, v43
  v_add_u32 v21, 4294966272, v21
  v_cmp_gt_u32 vcc, 2048, v42
  v_mov_b32 v43, 0x80000000
  s_nop 0
  v_cndmask_b32 v21, v43, v21, vcc
  v_add_u32 v42, 8, v40
  v_xor_b32 v43, v42, v41
  v_lshlrev_b32 v43, 4, v43
  v_add_u32 v42, s72, v42
  v_add_u32 v42, 1, v42
  v_mul_lo_u32 v22, v42, s74
  v_add_u32 v22, v22, v43
  v_add_u32 v22, 4294965248, v22
  v_cmp_gt_u32 vcc, 2048, v42
  v_mov_b32 v43, 0x80000000
  s_nop 0
  v_cndmask_b32 v22, v43, v22, vcc
  v_add_u32 v42, 12, v40
  v_xor_b32 v43, v42, v41
  v_lshlrev_b32 v43, 4, v43
  v_add_u32 v42, s72, v42
  v_add_u32 v42, 1, v42
  v_mul_lo_u32 v23, v42, s74
  v_add_u32 v23, v23, v43
  v_add_u32 v23, 4294964224, v23
  v_cmp_gt_u32 vcc, 2048, v42
  v_mov_b32 v43, 0x80000000
  s_nop 0
  v_cndmask_b32 v23, v43, v23, vcc
  v_lshrrev_b32 v40, 4, v0
  s_lshl_b32 s72, s61, 6
  s_lshl_b32 s73, s58, 4
  s_add_u32 s72, s72, s73
  v_and_b32 v41, 15, v0
  s_mov_b32 s74, 1024
  v_add_u32 v42, 0, v40
  v_xor_b32 v43, v42, v41
  v_lshlrev_b32 v43, 4, v43
  v_add_u32 v42, s72, v42
  v_add_u32 v42, 4294967294, v42
  v_mul_lo_u32 v24, v42, s74
  v_add_u32 v24, v24, v43
  v_cmp_gt_u32 vcc, 2048, v42
  v_mov_b32 v43, 0x80000000
  s_nop 0
  v_cndmask_b32 v24, v43, v24, vcc
  v_add_u32 v42, 4, v40
  v_xor_b32 v43, v42, v41
  v_lshlrev_b32 v43, 4, v43
  v_add_u32 v42, s72, v42
  v_add_u32 v42, 4294967294, v42
  v_mul_lo_u32 v25, v42, s74
  v_add_u32 v25, v25, v43
  v_add_u32 v25, 4294966272, v25
  v_cmp_gt_u32 vcc, 2048, v42
  v_mov_b32 v43, 0x80000000
  s_nop 0
  v_cndmask_b32 v25, v43, v25, vcc
  v_add_u32 v42, 8, v40
  v_xor_b32 v43, v42, v41
  v_lshlrev_b32 v43, 4, v43
  v_add_u32 v42, s72, v42
  v_add_u32 v42, 4294967294, v42
  v_mul_lo_u32 v26, v42, s74
  v_add_u32 v26, v26, v43
  v_add_u32 v26, 4294965248, v26
  v_cmp_gt_u32 vcc, 2048, v42
  v_mov_b32 v43, 0x80000000
  s_nop 0
  v_cndmask_b32 v26, v43, v26, vcc
  v_add_u32 v42, 12, v40
  v_xor_b32 v43, v42, v41
  v_lshlrev_b32 v43, 4, v43
  v_add_u32 v42, s72, v42
  v_add_u32 v42, 4294967294, v42
  v_mul_lo_u32 v27, v42, s74
  v_add_u32 v27, v27, v43
  v_add_u32 v27, 4294964224, v27
  v_cmp_gt_u32 vcc, 2048, v42
  v_mov_b32 v43, 0x80000000
  s_nop 0
  v_cndmask_b32 v27, v43, v27, vcc
  v_lshrrev_b32 v40, 4, v0
  s_lshl_b32 s72, s61, 6
  s_lshl_b32 s73, s58, 4
  s_add_u32 s72, s72, s73
  v_and_b32 v41, 15, v0
  s_mov_b32 s74, 1024
  v_add_u32 v42, 0, v40
  v_xor_b32 v43, v42, v41
  v_lshlrev_b32 v43, 4, v43
  v_add_u32 v42, s72, v42
  v_add_u32 v42, 2, v42
  v_mul_lo_u32 v28, v42, s74
  v_add_u32 v28, v28, v43
  v_cmp_gt_u32 vcc, 2048, v42
  v_mov_b32 v43, 0x80000000
  s_nop 0
  v_cndmask_b32 v28, v43, v28, vcc
  v_add_u32 v42, 4, v40
  v_xor_b32 v43, v42, v41
  v_lshlrev_b32 v43, 4, v43
  v_add_u32 v42, s72, v42
  v_add_u32 v42, 2, v42
  v_mul_lo_u32 v29, v42, s74
  v_add_u32 v29, v29, v43
  v_add_u32 v29, 4294966272, v29
  v_cmp_gt_u32 vcc, 2048, v42
  v_mov_b32 v43, 0x80000000
  s_nop 0
  v_cndmask_b32 v29, v43, v29, vcc
  v_add_u32 v42, 8, v40
  v_xor_b32 v43, v42, v41
  v_lshlrev_b32 v43, 4, v43
  v_add_u32 v42, s72, v42
  v_add_u32 v42, 2, v42
  v_mul_lo_u32 v30, v42, s74
  v_add_u32 v30, v30, v43
  v_add_u32 v30, 4294965248, v30
  v_cmp_gt_u32 vcc, 2048, v42
  v_mov_b32 v43, 0x80000000
  s_nop 0
  v_cndmask_b32 v30, v43, v30, vcc
  v_add_u32 v42, 12, v40
  v_xor_b32 v43, v42, v41
  v_lshlrev_b32 v43, 4, v43
  v_add_u32 v42, s72, v42
  v_add_u32 v42, 2, v42
  v_mul_lo_u32 v31, v42, s74
  v_add_u32 v31, v31, v43
  v_add_u32 v31, 4294964224, v31
  v_cmp_gt_u32 vcc, 2048, v42
  v_mov_b32 v43, 0x80000000
  s_nop 0
  v_cndmask_b32 v31, v43, v31, vcc
  s_mov_b32 s44, s22
  s_mov_b32 s45, s23
  s_mov_b32 s46, 0x158000
  s_mov_b32 s47, 0x20000
  s_mul_i32 s64, s58, 3072
  s_cmp_eq_u32 s39, 15
  s_cselect_b32 s73, s38, s39
  s_mul_i32 s72, s58, 192
  s_mul_i32 s73, s73, 192
  v_add_u32 v40, s72, v0
  v_mul_u32_u24 v41, 43691, v40
  v_lshrrev_b32 v41, 19, v41
  v_mul_u32_u24 v8, 12, v41
  v_sub_u32 v40, v40, v8
  v_lshlrev_b32 v40, 4, v40
  v_mul_u32_u24 v41, 2752, v41
  v_add_u32 v40, v40, v41
  v_add_u32 v40, s73, v40
  v_mov_b32 v8, v40
  v_add_u32 v40, s72, v0
  v_add_u32 v40, 64, v40
  v_mul_u32_u24 v41, 43691, v40
  v_lshrrev_b32 v41, 19, v41
  v_mul_u32_u24 v9, 12, v41
  v_sub_u32 v40, v40, v9
  v_lshlrev_b32 v40, 4, v40
  v_mul_u32_u24 v41, 2752, v41
  v_add_u32 v40, v40, v41
  v_add_u32 v40, s73, v40
  v_add_u32 v9, 0xfffffc00, v40
  v_add_u32 v40, s72, v0
  v_add_u32 v40, 128, v40
  v_mul_u32_u24 v41, 43691, v40
  v_lshrrev_b32 v41, 19, v41
  v_mul_u32_u24 v10, 12, v41
  v_sub_u32 v40, v40, v10
  v_lshlrev_b32 v40, 4, v40
  v_mul_u32_u24 v41, 2752, v41
  v_add_u32 v40, v40, v41
  v_add_u32 v40, s73, v40
  v_add_u32 v10, 0xfffff800, v40
  s_mov_b32 s69, s61
  v_bfe_u32 v43, v0, 3, 2
  s_lshl_b32 s72, s62, 2
  v_add_u32 v43, s72, v43
  v_and_b32 v44, 7, v0
  v_lshlrev_b32 v40, 2, v44
  v_and_b32 v42, 3, v43
  v_or_b32 v40, v40, v42
  v_lshlrev_b32 v40, 3, v40
  v_lshrrev_b32 v42, 2, v43
  v_add_u32 v40, v40, v42
  v_mov_b32 v41, s69
  v_lshlrev_b32 v33, 7, v40
  v_lshlrev_b32 v41, 2, v41
  v_add_u32 v33, v33, v41
  v_add_u32 v33, 0x1238000, v33
  s_cmp_lg_u32 s58, 0
  s_nop 0
  s_cbranch_scc1 L_h2_noatt0
  s_mov_b32 s52, s12
  s_mov_b32 s53, s13
  s_mov_b32 s54, 0x4000
  s_mov_b32 s55, 0x20000
  s_lshr_b32 s72, s69, 1
  s_lshl_b32 s72, s72, 10
  s_mov_b32 m0, 153088
  s_nop 0
  buffer_load_dwordx4 v32, s[52:55], s72 offen lds
L_h2_noatt0:
  s_mov_b32 s40, s32
  s_mov_b32 s41, s33
  s_mov_b32 s42, 0x200000
  s_mov_b32 s43, 0x20000
  s_waitcnt vmcnt(0)
  v_and_b32 v40, 31, v0
  v_lshlrev_b32 v40, 2, v40
  s_lshl_b32 s72, s2, 7
  s_add_u32 s67, s72, 0x1228000
  v_mov_b32 v92, 0x00003f80
  v_mov_b32 v93, 0x3f800000
  s_lshl_b32 s72, s69, 4
  s_lshl_b32 s73, s58, 2
  s_add_u32 s72, s72, s73
  s_lshl_b32 s72, s72, 11
  s_add_u32 s72, s72, 0x400000
  s_mov_b32 s98, s72
  v_and_b32 v134, 31, v0
  v_lshlrev_b32 v134, 5, v134
  v_lshrrev_b32 v135, 5, v0
  v_lshlrev_b32 v135, 4, v135
  v_add_u32 v134, v134, v135
  s_lshl_b32 s72, s69, 16
  s_lshl_b32 s73, s62, 13
  s_add_u32 s72, s72, s73
  s_lshl_b32 s73, s35, 10
  s_add_u32 s76, s72, s73
  s_add_u32 s68, s76, 0x800000
  v_mov_b32 v132, 0x3fb8aa3b
  v_mov_b32 v133, 0xbfb8aa3b
  v_lshrrev_b32 v136, 5, v0
  v_lshlrev_b32 v136, 3, v136
  v_bfe_u32 v137, v0, 2, 2
  v_add_u32 v136, v136, v137
  v_lshlrev_b32 v136, 5, v136
  v_and_b32 v137, 3, v0
  v_lshlrev_b32 v137, 3, v137
  v_add_u32 v136, v136, v137
  s_and_b32 s72, s69, 1
  s_lshl_b32 s72, s72, 9
  s_add_u32 s72, s72, 153088
  v_add_u32 v136, s72, v136
  s_barrier
  buffer_load_dword v41, v40, s[48:51], s67 offen sc1
  s_mov_b32 s72, 0
  s_add_u32 m0, s63, 0
  s_nop 0
  buffer_load_dwordx4 v16, s[40:43], s72 offen sc1 lds
  buffer_load_dwordx4 v17, s[40:43], s72 offen offset:1024 sc1 lds
  buffer_load_dwordx4 v18, s[40:43], s72 offen offset:2048 sc1 lds
  buffer_load_dwordx4 v19, s[40:43], s72 offen offset:3072 sc1 lds
  s_mov_b32 s72, 256
  s_add_u32 m0, s63, 16384
  s_nop 0
  buffer_load_dwordx4 v20, s[40:43], s72 offen sc1 lds
  buffer_load_dwordx4 v21, s[40:43], s72 offen offset:1024 sc1 lds
  buffer_load_dwordx4 v22, s[40:43], s72 offen offset:2048 sc1 lds
  buffer_load_dwordx4 v23, s[40:43], s72 offen offset:3072 sc1 lds
  s_mov_b32 s72, 512
  s_add_u32 m0, s63, 32768
  s_nop 0
  buffer_load_dwordx4 v24, s[40:43], s72 offen sc1 lds
  buffer_load_dwordx4 v25, s[40:43], s72 offen offset:1024 sc1 lds
  buffer_load_dwordx4 v26, s[40:43], s72 offen offset:2048 sc1 lds
  buffer_load_dwordx4 v27, s[40:43], s72 offen offset:3072 sc1 lds
  s_waitcnt vmcnt(8)
  s_barrier
  s_mov_b32 s72, 768
  s_add_u32 m0, s63, 49152
  s_nop 0
  buffer_load_dwordx4 v28, s[40:43], s72 offen sc1 lds
  buffer_load_dwordx4 v29, s[40:43], s72 offen offset:1024 sc1 lds
  buffer_load_dwordx4 v30, s[40:43], s72 offen offset:2048 sc1 lds
  buffer_load_dwordx4 v31, s[40:43], s72 offen offset:3072 sc1 lds
  s_mov_b32 s73, 0x40000
L_kvpoll:
  v_cmp_ne_u32 vcc, s34, v41
  s_nop 3
  s_and_b32 s74, vcc_lo, 0x3ffff
  s_cbranch_scc0 L_kvpoll_ok
  buffer_load_dword v41, v40, s[48:51], s67 offen sc1
  s_waitcnt vmcnt(0)
  s_sub_u32 s73, s73, 1
  s_cmp_lg_u32 s73, 0
  s_cbranch_scc1 L_kvpoll
L_kvpoll_ok:
  s_waitcnt vmcnt(8)
  s_barrier
  v_mov_b32 v42, 152604
  v_mov_b32 v43, 1
  s_mov_b64 exec, 1
  ds_write_b32 v42, v43
  s_mov_b64 exec, -1
  s_waitcnt vmcnt(4)
  s_barrier
  s_waitcnt vmcnt(0)
  s_barrier
  s_add_u32 s73, s98, 4096
  buffer_load_dwordx4 v[44:47], v32, s[48:51], s98 offen offset:0 sc1
  buffer_load_dwordx4 v[48:51], v32, s[48:51], s98 offen offset:1024 sc1
  buffer_load_dwordx4 v[52:55], v32, s[48:51], s98 offen offset:2048 sc1
  buffer_load_dwordx4 v[56:59], v32, s[48:51], s98 offen offset:3072 sc1
  buffer_load_dwordx4 v[60:63], v32, s[48:51], s73 offen offset:0 sc1
  buffer_load_dwordx4 v[64:67], v32, s[48:51], s73 offen offset:1024 sc1
  buffer_load_dwordx4 v[68:71], v32, s[48:51], s73 offen offset:2048 sc1
  buffer_load_dwordx4 v[72:75], v32, s[48:51], s73 offen offset:3072 sc1
  s_sub_u32 s77, s68, 0x600000
  buffer_load_dwordx4 v[116:119], v134, s[48:51], s77 offen sc1
  s_barrier
  s_waitcnt vmcnt(0)
  v_lshlrev_b32 v76, 16, v44
  v_and_b32 v77, 0xffff0000, v44
  v_dot2_f32_bf16 v76, v52, v92, v76
  v_dot2_f32_bf16 v77, v52, v93, v77
  v_dot2_f32_bf16 v76, v60, v92, v76
  v_dot2_f32_bf16 v77, v60, v93, v77
  v_dot2_f32_bf16 v76, v68, v92, v76
  v_dot2_f32_bf16 v77, v68, v93, v77
  v_lshlrev_b32 v78, 16, v45
  v_and_b32 v79, 0xffff0000, v45
  v_dot2_f32_bf16 v78, v53, v92, v78
  v_dot2_f32_bf16 v79, v53, v93, v79
  v_dot2_f32_bf16 v78, v61, v92, v78
  v_dot2_f32_bf16 v79, v61, v93, v79
  v_dot2_f32_bf16 v78, v69, v92, v78
  v_dot2_f32_bf16 v79, v69, v93, v79
  v_lshlrev_b32 v80, 16, v46
  v_and_b32 v81, 0xffff0000, v46
  v_dot2_f32_bf16 v80, v54, v92, v80
  v_dot2_f32_bf16 v81, v54, v93, v81
  v_dot2_f32_bf16 v80, v62, v92, v80
  v_dot2_f32_bf16 v81, v62, v93, v81
  v_dot2_f32_bf16 v80, v70, v92, v80
  v_dot2_f32_bf16 v81, v70, v93, v81
  v_lshlrev_b32 v82, 16, v47
  v_and_b32 v83, 0xffff0000, v47
  v_dot2_f32_bf16 v82, v55, v92, v82
  v_dot2_f32_bf16 v83, v55, v93, v83
  v_dot2_f32_bf16 v82, v63, v92, v82
  v_dot2_f32_bf16 v83, v63, v93, v83
  v_dot2_f32_bf16 v82, v71, v92, v82
  v_dot2_f32_bf16 v83, v71, v93, v83
  v_lshlrev_b32 v84, 16, v48
  v_and_b32 v85, 0xffff0000, v48
  v_dot2_f32_bf16 v84, v56, v92, v84
  v_dot2_f32_bf16 v85, v56, v93, v85
  v_dot2_f32_bf16 v84, v64, v92, v84
  v_dot2_f32_bf16 v85, v64, v93, v85
  v_dot2_f32_bf16 v84, v72, v92, v84
  v_dot2_f32_bf16 v85, v72, v93, v85
  v_lshlrev_b32 v86, 16, v49
  v_and_b32 v87, 0xffff0000, v49
  v_dot2_f32_bf16 v86, v57, v92, v86
  v_dot2_f32_bf16 v87, v57, v93, v87
  v_dot2_f32_bf16 v86, v65, v92, v86
  v_dot2_f32_bf16 v87, v65, v93, v87
  v_dot2_f32_bf16 v86, v73, v92, v86
  v_dot2_f32_bf16 v87, v73, v93, v87
  v_lshlrev_b32 v88, 16, v50
  v_and_b32 v89, 0xffff0000, v50
  v_dot2_f32_bf16 v88, v58, v92, v88
  v_dot2_f32_bf16 v89, v58, v93, v89
  v_dot2_f32_bf16 v88, v66, v92, v88
  v_dot2_f32_bf16 v89, v66, v93, v89
  v_dot2_f32_bf16 v88, v74, v92, v88
  v_dot2_f32_bf16 v89, v74, v93, v89
  v_lshlrev_b32 v90, 16, v51
  v_and_b32 v91, 0xffff0000, v51
  v_dot2_f32_bf16 v90, v59, v92, v90
  v_dot2_f32_bf16 v91, v59, v93, v91
  v_dot2_f32_bf16 v90, v67, v92, v90
  v_dot2_f32_bf16 v91, v67, v93, v91
  v_dot2_f32_bf16 v90, v75, v92, v90
  v_dot2_f32_bf16 v91, v75, v93, v91
  v_add_u32 v94, s63, v32
  ds_write_b128 v94, v[76:79] offset:0
  ds_write_b128 v94, v[80:83] offset:1024
  ds_write_b128 v94, v[84:87] offset:2048
  ds_write_b128 v94, v[88:91] offset:3072
  s_waitcnt lgkmcnt(0)
  v_mov_b32 v104, 152592
  v_mov_b32 v105, 1
  s_mov_b64 exec, 1
  ds_add_u32 v104, v105
  s_mov_b64 exec, -1
  v_mov_b32 v104, 152592
  s_mov_b32 s78, 0x100000
  s_nop 0
L_spin1:
  ds_read_b32 v105, v104
  s_waitcnt lgkmcnt(0)
  v_readfirstlane_b32 s79, v105
  s_nop 3
  s_cmp_eq_u32 s79, 4
  s_cbranch_scc1 L_spin1_ok
  s_sub_u32 s78, s78, 1
  s_cmp_lg_u32 s78, 0
  s_cbranch_scc1 L_spin1
L_spin1_ok:
  s_lshl_b32 s72, s58, 10
  v_add_u32 v94, s72, v32
  ds_read_b128 v[44:47], v94 offset:0
  ds_read_b128 v[48:51], v94 offset:4096
  ds_read_b128 v[52:55], v94 offset:8192
  ds_read_b128 v[56:59], v94 offset:12288
  s_waitcnt lgkmcnt(0)
  v_pk_add_f32 v[44:45], v[44:45], v[48:49]
  v_pk_add_f32 v[46:47], v[46:47], v[50:51]
  v_pk_add_f32 v[44:45], v[44:45], v[52:53]
  v_pk_add_f32 v[46:47], v[46:47], v[54:55]
  v_pk_add_f32 v[44:45], v[44:45], v[56:57]
  v_pk_add_f32 v[46:47], v[46:47], v[58:59]
  v_cvt_pk_bf16_f32 v96, v44, v45
  v_cvt_pk_bf16_f32 v97, v46, v47
  s_lshr_b32 s72, s58, 1
  s_lshl_b32 s72, s72, 10
  s_and_b32 s73, s58, 1
  s_lshl_b32 s73, s73, 3
  s_add_u32 s72, s72, s73
  s_add_u32 s72, s72, 159744
  v_add_u32 v94, s72, v32
  ds_write_b64 v94, v[96:97]
  s_waitcnt lgkmcnt(0)
  v_mov_b32 v104, 152600
  v_mov_b32 v105, 1
  s_mov_b64 exec, 1
  ds_add_u32 v104, v105
  s_mov_b64 exec, -1
  s_add_u32 s72, s38, 0
  s_and_b32 s72, s72, 7
  s_cmp_eq_u32 s39, 15
  s_cselect_b32 s72, 0, s72
  s_mul_i32 s73, s72, 176128
  s_add_u32 m0, s64, 65536
  s_nop 0
  buffer_load_dwordx4 v8, s[44:47], s73 offen lds
  buffer_load_dwordx4 v9, s[44:47], s73 offen offset:1024 lds
  buffer_load_dwordx4 v10, s[44:47], s73 offen offset:2048 lds
  s_add_u32 s72, s38, 1
  s_and_b32 s72, s72, 7
  s_cmp_eq_u32 s39, 15
  s_cselect_b32 s72, 1, s72
  s_mul_i32 s73, s72, 176128
  s_add_u32 m0, s64, 81920
  s_nop 0
  buffer_load_dwordx4 v8, s[44:47], s73 offen lds
  buffer_load_dwordx4 v9, s[44:47], s73 offen offset:1024 lds
  buffer_load_dwordx4 v10, s[44:47], s73 offen offset:2048 lds
  s_add_u32 s72, s38, 2
  s_and_b32 s72, s72, 7
  s_cmp_eq_u32 s39, 15
  s_cselect_b32 s72, 2, s72
  s_mul_i32 s73, s72, 176128
  s_add_u32 m0, s64, 98304
  s_nop 0
  buffer_load_dwordx4 v8, s[44:47], s73 offen lds
  buffer_load_dwordx4 v9, s[44:47], s73 offen offset:1024 lds
  buffer_load_dwordx4 v10, s[44:47], s73 offen offset:2048 lds
  s_add_u32 s72, s38, 3
  s_and_b32 s72, s72, 7
  s_cmp_eq_u32 s39, 15
  s_cselect_b32 s72, 3, s72
  s_mul_i32 s73, s72, 176128
  s_add_u32 m0, s64, 114688
  s_nop 0
  buffer_load_dwordx4 v8, s[44:47], s73 offen lds
  buffer_load_dwordx4 v9, s[44:47], s73 offen offset:1024 lds
  buffer_load_dwordx4 v10, s[44:47], s73 offen offset:2048 lds
  s_cmp_lg_u32 s39, 15
  s_cbranch_scc1 L_pfJ2
  s_movk_i32 s72, 4
  s_mul_i32 s73, s72, 176128
  s_add_u32 m0, s64, 16384
  s_nop 0
  buffer_load_dwordx4 v8, s[44:47], s73 offen lds
  buffer_load_dwordx4 v9, s[44:47], s73 offen offset:1024 lds
  buffer_load_dwordx4 v10, s[44:47], s73 offen offset:2048 lds
L_pfJ2:
  s_cmp_lg_u32 s39, 15
  s_cbranch_scc1 L_pfJ3
  s_movk_i32 s72, 5
  s_mul_i32 s73, s72, 176128
  s_add_u32 m0, s64, 32768
  s_nop 0
  buffer_load_dwordx4 v8, s[44:47], s73 offen lds
  buffer_load_dwordx4 v9, s[44:47], s73 offen offset:1024 lds
  buffer_load_dwordx4 v10, s[44:47], s73 offen offset:2048 lds
L_pfJ3:
  s_cmp_lg_u32 s39, 15
  s_cbranch_scc1 L_pfJ4
  s_movk_i32 s72, 6
  s_mul_i32 s73, s72, 176128
  s_add_u32 m0, s64, 49152
  s_nop 0
  buffer_load_dwordx4 v8, s[44:47], s73 offen lds
  buffer_load_dwordx4 v9, s[44:47], s73 offen offset:1024 lds
  buffer_load_dwordx4 v10, s[44:47], s73 offen offset:2048 lds
L_pfJ4:
  ds_read_b64_tr_b16 v[128:129], v136
  ds_read_b64_tr_b16 v[130:131], v136 offset:128
  s_waitcnt vmcnt(63) lgkmcnt(0)
  v_mfma_f32_32x32x16_bf16 v[140:155], v[128:131], v[116:119], 0
  s_nop 11
  v_max3_f32 v188, v140, v141, v142
  v_max3_f32 v189, -v140, -v141, -v142
  v_max3_f32 v188, v188, v143, v144
  v_max3_f32 v189, v189, -v143, -v144
  v_max3_f32 v188, v188, v145, v146
  v_max3_f32 v189, v189, -v145, -v146
  v_max_f32 v188, v188, v147
  v_max_f32 v189, v189, -v147
  s_nop 1
  v_permlane32_swap_b32 v188, v189
  v_max_f32 v188, v188, v189
  v_mov_b32 v189, v188
  s_nop 1
  v_permlane32_swap_b32 v188, v189
  v_pk_mul_f32 v[188:189], v[188:189], v[132:133] op_sel:[0,1] op_sel_hi:[1,1]
  v_pk_fma_f32 v[172:173], v[140:141], v[132:133], v[188:189] op_sel:[0,0,0] op_sel_hi:[1,0,0]
  v_pk_fma_f32 v[174:175], v[142:143], v[132:133], v[188:189] op_sel:[0,0,0] op_sel_hi:[1,0,0]
  v_pk_fma_f32 v[176:177], v[144:145], v[132:133], v[188:189] op_sel:[0,0,0] op_sel_hi:[1,0,0]
  v_pk_fma_f32 v[178:179], v[146:147], v[132:133], v[188:189] op_sel:[0,0,0] op_sel_hi:[1,0,0]
  v_pk_fma_f32 v[180:181], v[140:141], v[132:133], v[188:189] op_sel:[0,1,1] op_sel_hi:[1,1,1]
  v_pk_fma_f32 v[182:183], v[142:143], v[132:133], v[188:189] op_sel:[0,1,1] op_sel_hi:[1,1,1]
  v_pk_fma_f32 v[184:185], v[144:145], v[132:133], v[188:189] op_sel:[0,1,1] op_sel_hi:[1,1,1]
  v_pk_fma_f32 v[186:187], v[146:147], v[132:133], v[188:189] op_sel:[0,1,1] op_sel_hi:[1,1,1]
  v_exp_f32 v172, v172
  v_exp_f32 v173, v173
  v_exp_f32 v174, v174
  v_exp_f32 v175, v175
  v_exp_f32 v176, v176
  v_exp_f32 v177, v177
  v_exp_f32 v178, v178
  v_exp_f32 v179, v179
  v_exp_f32 v180, v180
  v_exp_f32 v181, v181
  v_exp_f32 v182, v182
  v_exp_f32 v183, v183
  v_exp_f32 v184, v184
  v_exp_f32 v185, v185
  v_exp_f32 v186, v186
  v_exp_f32 v187, v187
  v_pk_add_f32 v[192:193], v[172:173], v[174:175]
  v_pk_add_f32 v[194:195], v[176:177], v[178:179]
  v_pk_add_f32 v[196:197], v[180:181], v[182:183]
  v_pk_add_f32 v[198:199], v[184:185], v[186:187]
  v_pk_add_f32 v[192:193], v[192:193], v[194:195]
  v_pk_add_f32 v[196:197], v[196:197], v[198:199]
  v_add_f32 v190, v192, v193
  v_add_f32 v191, v196, v197
  s_nop 1
  v_permlane32_swap_b32 v190, v191
  v_add_f32 v190, v190, v191
  v_mov_b32 v191, v190
  s_nop 1
  v_permlane32_swap_b32 v190, v191
  v_rcp_f32 v190, v190
  v_rcp_f32 v191, v191
  s_nop 0
  v_pk_mul_f32 v[172:173], v[172:173], v[190:191] op_sel:[0,0] op_sel_hi:[1,0]
  v_pk_mul_f32 v[174:175], v[174:175], v[190:191] op_sel:[0,0] op_sel_hi:[1,0]
  v_pk_mul_f32 v[176:177], v[176:177], v[190:191] op_sel:[0,0] op_sel_hi:[1,0]
  v_pk_mul_f32 v[178:179], v[178:179], v[190:191] op_sel:[0,0] op_sel_hi:[1,0]
  v_pk_mul_f32 v[180:181], v[180:181], v[190:191] op_sel:[0,1] op_sel_hi:[1,1]
  v_pk_mul_f32 v[182:183], v[182:183], v[190:191] op_sel:[0,1] op_sel_hi:[1,1]
  v_pk_mul_f32 v[184:185], v[184:185], v[190:191] op_sel:[0,1] op_sel_hi:[1,1]
  v_pk_mul_f32 v[186:187], v[186:187], v[190:191] op_sel:[0,1] op_sel_hi:[1,1]
  v_cvt_pk_bf16_f32 v192, v172, v173
  v_cvt_pk_bf16_f32 v193, v174, v175
  v_cvt_pk_bf16_f32 v194, v176, v177
  v_cvt_pk_bf16_f32 v195, v178, v179
  v_cvt_pk_bf16_f32 v196, v180, v181
  v_cvt_pk_bf16_f32 v197, v182, v183
  v_cvt_pk_bf16_f32 v198, v184, v185
  v_cvt_pk_bf16_f32 v199, v186, v187
  v_mov_b32 v200, 152600
  s_mov_b32 s78, 0x100000
  s_nop 0
L_spin5:
  ds_read_b32 v201, v200
  s_waitcnt lgkmcnt(0)
  v_readfirstlane_b32 s79, v201
  s_nop 3
  s_cmp_eq_u32 s79, 4
  s_cbranch_scc1 L_spin5_ok
  s_sub_u32 s78, s78, 1
  s_cmp_lg_u32 s78, 0
  s_cbranch_scc1 L_spin5
L_spin5_ok:
  v_lshlrev_b32 v135, 4, v0
  v_add_u32 v135, 159744, v135
  ds_read_b128 v[120:123], v135
  ds_read_b128 v[124:127], v135 offset:1024
  s_waitcnt lgkmcnt(0)
  v_mfma_f32_32x32x16_bf16 v[156:171], v[120:123], v[192:195], 0
  v_mfma_f32_32x32x16_bf16 v[156:171], v[124:127], v[196:199], v[156:171]
  s_nop 11
  v_add_f32 v136, 0x358637bd, v164
  v_rcp_f32 v136, v136
  s_nop 0
  v_mul_f32 v156, v156, v136
  v_mul_f32 v157, v157, v136
  v_mul_f32 v158, v158, v136
  v_mul_f32 v159, v159, v136
  v_mul_f32 v160, v160, v136
  v_mul_f32 v161, v161, v136
  v_mul_f32 v162, v162, v136
  v_mul_f32 v163, v163, v136
  v_cvt_pk_bf16_f32 v140, v156, v157
  v_cvt_pk_bf16_f32 v141, v158, v159
  v_cvt_pk_bf16_f32 v142, v160, v161
  v_cvt_pk_bf16_f32 v143, v162, v163
  s_nop 0
  v_permlane32_swap_b32 v140, v142
  v_permlane32_swap_b32 v141, v143
  buffer_store_dwordx4 v[140:143], v134, s[48:51], s68 offen sc1
  s_mov_b32 s76, s70
  s_mov_b32 s77, s71
  s_mov_b32 s70, -1
  s_mov_b32 s71, 0
  s_waitcnt vmcnt(0)
  v_mov_b32 v42, 152584
  v_mov_b32 v43, 1
  s_mov_b64 exec, 1
  ds_add_rtn_u32 v43, v42, v43
  s_waitcnt lgkmcnt(0)
  v_readfirstlane_b32 s72, v43
  s_mov_b64 exec, -1
  s_nop 2
  s_cmp_lg_u32 s72, 7
  s_cbranch_scc1 L_nopush_o_h
  v_mov_b32 v43, s34
  s_mov_b64 exec, s[70:71]
  buffer_store_dword v43, v33, s[48:51], 0 offen sc1
  s_mov_b64 exec, -1
L_nopush_o_h:
  s_mov_b32 s70, s76
  s_mov_b32 s71, s77
  s_cmp_lg_u32 s39, 15
  s_cbranch_scc1 L_job7
  v_mov_b32 v42, 152600
  s_mov_b32 s78, 0x100000
  s_nop 0
L_spin6:
  ds_read_b32 v43, v42
  s_waitcnt lgkmcnt(0)
  v_readfirstlane_b32 s79, v43
  s_nop 3
  s_cmp_eq_u32 s79, 4
  s_cbranch_scc1 L_spin6_ok
  s_sub_u32 s78, s78, 1
  s_cmp_lg_u32 s78, 0
  s_cbranch_scc1 L_spin6
L_spin6_ok:
  s_movk_i32 s72, 7
  s_mul_i32 s73, s72, 176128
  s_add_u32 m0, s64, 0
  s_nop 0
  buffer_load_dwordx4 v8, s[44:47], s73 offen lds
  buffer_load_dwordx4 v9, s[44:47], s73 offen offset:1024 lds
  buffer_load_dwordx4 v10, s[44:47], s73 offen offset:2048 lds
L_job7:
  v_lshrrev_b32 v48, 4, v0
  v_and_b32 v49, 15, v0
  s_lshl_b32 s72, s61, 2
  s_add_u32 s72, s72, s58
  s_lshl_b32 s72, s72, 4
  v_add_u32 v50, 0, v48
  v_xor_b32 v51, v50, v49
  v_add_u32 v50, s72, v50
  v_lshlrev_b32 v50, 5, v50
  v_lshrrev_b32 v42, 1, v51
  v_lshlrev_b32 v42, 16, v42
  v_and_b32 v51, 1, v51
  v_lshlrev_b32 v51, 4, v51
  v_add_u32 v42, v42, v51
  v_add_u32 v42, v42, v50
  v_add_u32 v42, 4096, v42
  v_add_u32 v50, 4, v48
  v_xor_b32 v51, v50, v49
  v_add_u32 v50, s72, v50
  v_lshlrev_b32 v50, 5, v50
  v_lshrrev_b32 v43, 1, v51
  v_lshlrev_b32 v43, 16, v43
  v_and_b32 v51, 1, v51
  v_lshlrev_b32 v51, 4, v51
  v_add_u32 v43, v43, v51
  v_add_u32 v43, v43, v50
  v_add_u32 v43, 3072, v43
  v_add_u32 v50, 8, v48
  v_xor_b32 v51, v50, v49
  v_add_u32 v50, s72, v50
  v_lshlrev_b32 v50, 5, v50
  v_lshrrev_b32 v44, 1, v51
  v_lshlrev_b32 v44, 16, v44
  v_and_b32 v51, 1, v51
  v_lshlrev_b32 v51, 4, v51
  v_add_u32 v44, v44, v51
  v_add_u32 v44, v44, v50
  v_add_u32 v44, 2048, v44
  v_add_u32 v50, 12, v48
  v_xor_b32 v51, v50, v49
  v_add_u32 v50, s72, v50
  v_lshlrev_b32 v50, 5, v50
  v_lshrrev_b32 v45, 1, v51
  v_lshlrev_b32 v45, 16, v45
  v_and_b32 v51, 1, v51
  v_lshlrev_b32 v51, 4, v51
  v_add_u32 v45, v45, v51
  v_add_u32 v45, v45, v50
  v_add_u32 v45, 1024, v45
  v_and_b32 v46, 31, v0
  v_lshlrev_b32 v46, 2, v46
  s_lshl_b32 s72, s2, 7
  s_add_u32 s68, s72, 0x1238000
  s_cmp_eq_u32 s39, 15
  s_cbranch_scc1 L_h3_idle
  s_add_u32 s40, s32, 0x600000
  s_addc_u32 s41, s33, 0
  s_mov_b32 s42, 0x200000
  s_mov_b32 s43, 0x20000
  v_mov_b32 v65, 64
  s_lshl_b32 s72, s2, 7
  s_add_u32 s66, s72, 0x1218000
  v_lshrrev_b32 v64, 4, v0
  v_lshlrev_b32 v64, 10, v64
  v_and_b32 v48, 15, v0
  v_lshlrev_b32 v48, 4, v48
  v_add_u32 v64, v64, v48
  s_lshl_b32 s72, s58, 8
  s_add_u32 s72, s72, 155648
  v_add_u32 v64, s72, v64
  s_barrier
  s_add_u32 s72, s38, 0
  s_and_b32 s72, s72, 7
  s_lshl_b32 s75, s72, 7
  s_add_u32 m0, s63, 0
  s_nop 0
  buffer_load_dwordx4 v4, s[40:43], s75 offen sc1 lds
  buffer_load_dwordx4 v5, s[40:43], s75 offen offset:1024 sc1 lds
  buffer_load_dwordx4 v6, s[40:43], s75 offen offset:2048 sc1 lds
  buffer_load_dwordx4 v7, s[40:43], s75 offen offset:3072 sc1 lds
  s_add_u32 s72, s38, 1
  s_and_b32 s72, s72, 7
  s_lshl_b32 s75, s72, 7
  s_add_u32 m0, s63, 16384
  s_nop 0
  buffer_load_dwordx4 v4, s[40:43], s75 offen sc1 lds
  buffer_load_dwordx4 v5, s[40:43], s75 offen offset:1024 sc1 lds
  buffer_load_dwordx4 v6, s[40:43], s75 offen offset:2048 sc1 lds
  buffer_load_dwordx4 v7, s[40:43], s75 offen offset:3072 sc1 lds
  s_waitcnt vmcnt(4)
  s_barrier
  s_add_u32 s72, s38, 2
  s_and_b32 s72, s72, 7
  s_lshl_b32 s75, s72, 7
  s_add_u32 m0, s63, 32768
  s_nop 0
  buffer_load_dwordx4 v4, s[40:43], s75 offen sc1 lds
  buffer_load_dwordx4 v5, s[40:43], s75 offen offset:1024 sc1 lds
  buffer_load_dwordx4 v6, s[40:43], s75 offen offset:2048 sc1 lds
  buffer_load_dwordx4 v7, s[40:43], s75 offen offset:3072 sc1 lds
  s_add_u32 s72, s38, 3
  s_and_b32 s72, s72, 7
  s_lshl_b32 s75, s72, 7
  s_add_u32 m0, s63, 49152
  s_nop 0
  buffer_load_dwordx4 v4, s[40:43], s75 offen sc1 lds
  buffer_load_dwordx4 v5, s[40:43], s75 offen offset:1024 sc1 lds
  buffer_load_dwordx4 v6, s[40:43], s75 offen offset:2048 sc1 lds
  buffer_load_dwordx4 v7, s[40:43], s75 offen offset:3072 sc1 lds
  s_waitcnt vmcnt(8)
  s_barrier
  s_add_u32 s72, s38, 4
  s_and_b32 s72, s72, 7
  s_lshl_b32 s75, s72, 7
  s_add_u32 m0, s63, 0
  s_nop 0
  buffer_load_dwordx4 v4, s[40:43], s75 offen sc1 lds
  buffer_load_dwordx4 v5, s[40:43], s75 offen offset:1024 sc1 lds
  buffer_load_dwordx4 v6, s[40:43], s75 offen offset:2048 sc1 lds
  buffer_load_dwordx4 v7, s[40:43], s75 offen offset:3072 sc1 lds
  s_mul_i32 s73, s72, 176128
  s_add_u32 m0, s64, 65536
  s_nop 0
  buffer_load_dwordx4 v8, s[44:47], s73 offen lds
  buffer_load_dwordx4 v9, s[44:47], s73 offen offset:1024 lds
  buffer_load_dwordx4 v10, s[44:47], s73 offen offset:2048 lds
  s_waitcnt vmcnt(11)
  s_barrier
  s_add_u32 s72, s38, 5
  s_and_b32 s72, s72, 7
  s_lshl_b32 s75, s72, 7
  s_add_u32 m0, s63, 16384
  s_nop 0
  buffer_load_dwordx4 v4, s[40:43], s75 offen sc1 lds
  buffer_load_dwordx4 v5, s[40:43], s75 offen offset:1024 sc1 lds
  buffer_load_dwordx4 v6, s[40:43], s75 offen offset:2048 sc1 lds
  buffer_load_dwordx4 v7, s[40:43], s75 offen offset:3072 sc1 lds
  s_mul_i32 s73, s72, 176128
  s_add_u32 m0, s64, 81920
  s_nop 0
  buffer_load_dwordx4 v8, s[44:47], s73 offen lds
  buffer_load_dwordx4 v9, s[44:47], s73 offen offset:1024 lds
  buffer_load_dwordx4 v10, s[44:47], s73 offen offset:2048 lds
  s_lshl_b32 s72, s38, 2
  s_add_u32 s72, s72, s58
  s_lshl_b32 s72, s72, 12
  s_add_u32 s72, s72, 0x1240000
  buffer_load_dwordx4 v[48:51], v32, s[48:51], s72 offen offset:0 sc1
  buffer_load_dwordx4 v[52:55], v32, s[48:51], s72 offen offset:1024 sc1
  buffer_load_dwordx4 v[56:59], v32, s[48:51], s72 offen offset:2048 sc1
  buffer_load_dwordx4 v[60:63], v32, s[48:51], s72 offen offset:3072 sc1
  s_waitcnt vmcnt(18)
  s_barrier
  s_add_u32 s72, s38, 6
  s_and_b32 s72, s72, 7
  s_lshl_b32 s75, s72, 7
  s_add_u32 m0, s63, 32768
  s_nop 0
  buffer_load_dwordx4 v4, s[40:43], s75 offen sc1 lds
  buffer_load_dwordx4 v5, s[40:43], s75 offen offset:1024 sc1 lds
  buffer_load_dwordx4 v6, s[40:43], s75 offen offset:2048 sc1 lds
  buffer_load_dwordx4 v7, s[40:43], s75 offen offset:3072 sc1 lds
  s_mul_i32 s73, s72, 176128
  s_add_u32 m0, s64, 98304
  s_nop 0
  buffer_load_dwordx4 v8, s[44:47], s73 offen lds
  buffer_load_dwordx4 v9, s[44:47], s73 offen offset:1024 lds
  buffer_load_dwordx4 v10, s[44:47], s73 offen offset:2048 lds
  buffer_load_dword v66, v65, s[48:51], s66 offen sc1
  s_waitcnt vmcnt(19)
  s_barrier
  s_add_u32 s72, s38, 7
  s_and_b32 s72, s72, 7
  s_lshl_b32 s75, s72, 7
  s_add_u32 m0, s63, 49152
  s_nop 0
  buffer_load_dwordx4 v4, s[40:43], s75 offen sc1 lds
  buffer_load_dwordx4 v5, s[40:43], s75 offen offset:1024 sc1 lds
  buffer_load_dwordx4 v6, s[40:43], s75 offen offset:2048 sc1 lds
  buffer_load_dwordx4 v7, s[40:43], s75 offen offset:3072 sc1 lds
  s_mul_i32 s73, s72, 176128
  s_add_u32 m0, s64, 114688
  s_nop 0
  buffer_load_dwordx4 v8, s[44:47], s73 offen lds
  buffer_load_dwordx4 v9, s[44:47], s73 offen offset:1024 lds
  buffer_load_dwordx4 v10, s[44:47], s73 offen offset:2048 lds
  buffer_load_dword v47, v46, s[48:51], s68 offen sc1
  s_waitcnt vmcnt(20)
  s_barrier
  s_waitcnt vmcnt(16)
  v_add_f32 v48, v48, v52
  v_add_f32 v49, v49, v53
  v_add_f32 v50, v50, v54
  v_add_f32 v51, v51, v55
  v_add_f32 v48, v48, v56
  v_add_f32 v49, v49, v57
  v_add_f32 v50, v50, v58
  v_add_f32 v51, v51, v59
  v_add_f32 v48, v48, v60
  v_add_f32 v49, v49, v61
  v_add_f32 v50, v50, v62
  v_add_f32 v51, v51, v63
  ds_write_b128 v64, v[48:51]
  s_waitcnt lgkmcnt(0)
  s_mov_b32 s52, s14
  s_mov_b32 s53, s15
  s_mov_b32 s54, 0x80000
  s_mov_b32 s55, 0x20000
  s_mov_b32 s72, 0x0
  s_add_u32 m0, s63, 65536
  s_nop 0
  buffer_load_dwordx4 v12, s[52:55], s72 offen lds
  buffer_load_dwordx4 v13, s[52:55], s72 offen offset:1024 lds
  buffer_load_dwordx4 v14, s[52:55], s72 offen offset:2048 lds
  buffer_load_dwordx4 v15, s[52:55], s72 offen offset:3072 lds
  s_waitcnt vmcnt(13)
  s_waitcnt vmcnt(12)
  s_cmp_lg_u32 s58, 0
  s_cbranch_scc1 L_h3_nocs
  s_mov_b32 s73, 0x40000
L_h3_cspoll:
  v_readfirstlane_b32 s74, v66
  s_nop 3
  s_cmp_eq_u32 s74, s34
  s_cbranch_scc1 L_h3_csok
  buffer_load_dword v66, v65, s[48:51], s66 offen sc1
  s_waitcnt vmcnt(0)
  s_sub_u32 s73, s73, 1
  s_cmp_lg_u32 s73, 0
  s_cbranch_scc1 L_h3_cspoll
L_h3_csok:
  s_mul_i32 s72, s39, 384
  s_add_u32 s72, s72, 0x1208000
  s_mov_b32 m0, 152064
  s_mov_b32 exec_lo, 0xffffff
  s_mov_b32 exec_hi, 0
  buffer_load_dwordx4 v32, s[48:51], s72 offen sc1 lds
  s_mov_b64 exec, -1
L_h3_nocs:
  s_barrier
  s_mov_b32 s72, 0x20000
  s_add_u32 m0, s63, 81920
  s_nop 0
  buffer_load_dwordx4 v12, s[52:55], s72 offen lds
  buffer_load_dwordx4 v13, s[52:55], s72 offen offset:1024 lds
  buffer_load_dwordx4 v14, s[52:55], s72 offen offset:2048 lds
  buffer_load_dwordx4 v15, s[52:55], s72 offen offset:3072 lds
  s_waitcnt vmcnt(9)
  s_barrier
  s_mov_b32 s72, 0x40000
  s_add_u32 m0, s63, 98304
  s_nop 0
  buffer_load_dwordx4 v12, s[52:55], s72 offen lds
  buffer_load_dwordx4 v13, s[52:55], s72 offen offset:1024 lds
  buffer_load_dwordx4 v14, s[52:55], s72 offen offset:2048 lds
  buffer_load_dwordx4 v15, s[52:55], s72 offen offset:3072 lds
  s_waitcnt vmcnt(8)
  s_barrier
  s_mov_b32 s72, 0x60000
  s_add_u32 m0, s63, 114688
  s_nop 0
  buffer_load_dwordx4 v12, s[52:55], s72 offen lds
  buffer_load_dwordx4 v13, s[52:55], s72 offen offset:1024 lds
  buffer_load_dwordx4 v14, s[52:55], s72 offen offset:2048 lds
  buffer_load_dwordx4 v15, s[52:55], s72 offen offset:3072 lds
  s_mov_b32 s73, 0x40000
L_op_w3:
  v_cmp_ne_u32 vcc, s34, v47
  s_nop 3
  s_cmp_eq_u64 vcc, 0
  s_cbranch_scc1 L_op_w3_ok
  buffer_load_dword v47, v46, s[48:51], s68 offen sc1
  s_waitcnt vmcnt(0)
  s_sub_u32 s73, s73, 1
  s_cmp_lg_u32 s73, 0
  s_cbranch_scc1 L_op_w3
L_op_w3_ok:
  s_add_u32 s40, s32, 0x7ff000
  s_addc_u32 s41, s33, 0
  s_mov_b32 s42, 0x201000
  s_mov_b32 s43, 0x20000
  s_mov_b32 s72, 0x0
  s_add_u32 m0, s63, 0
  s_nop 0
  buffer_load_dwordx4 v42, s[40:43], s72 offen sc1 lds
  buffer_load_dwordx4 v43, s[40:43], s72 offen offset:1024 sc1 lds
  buffer_load_dwordx4 v44, s[40:43], s72 offen offset:2048 sc1 lds
  buffer_load_dwordx4 v45, s[40:43], s72 offen offset:3072 sc1 lds
  s_mov_b32 s72, 0x80000
  s_add_u32 m0, s63, 16384
  s_nop 0
  buffer_load_dwordx4 v42, s[40:43], s72 offen sc1 lds
  buffer_load_dwordx4 v43, s[40:43], s72 offen offset:1024 sc1 lds
  buffer_load_dwordx4 v44, s[40:43], s72 offen offset:2048 sc1 lds
  buffer_load_dwordx4 v45, s[40:43], s72 offen offset:3072 sc1 lds
  s_mov_b32 s72, 0x100000
  s_add_u32 m0, s63, 32768
  s_nop 0
  buffer_load_dwordx4 v42, s[40:43], s72 offen sc1 lds
  buffer_load_dwordx4 v43, s[40:43], s72 offen offset:1024 sc1 lds
  buffer_load_dwordx4 v44, s[40:43], s72 offen offset:2048 sc1 lds
  buffer_load_dwordx4 v45, s[40:43], s72 offen offset:3072 sc1 lds
  s_mov_b32 s72, 0x180000
  s_add_u32 m0, s63, 49152
  s_nop 0
  buffer_load_dwordx4 v42, s[40:43], s72 offen sc1 lds
  buffer_load_dwordx4 v43, s[40:43], s72 offen offset:1024 sc1 lds
  buffer_load_dwordx4 v44, s[40:43], s72 offen offset:2048 sc1 lds
  buffer_load_dwordx4 v45, s[40:43], s72 offen offset:3072 sc1 lds
  s_branch L_h4_go
L_h3_idle:
  s_cmp_eq_u32 s38, 15
  s_cbranch_scc1 L_h3_nojob
  s_waitcnt vmcnt(0)
  s_barrier
  s_barrier
L_h3_nojob:
  buffer_load_dword v47, v46, s[48:51], s68 offen sc1
  s_waitcnt vmcnt(0)
  s_mov_b32 s73, 0x40000
L_op_idle:
  v_cmp_ne_u32 vcc, s34, v47
  s_nop 3
  s_cmp_eq_u64 vcc, 0
  s_cbranch_scc1 L_op_idle_ok
  buffer_load_dword v47, v46, s[48:51], s68 offen sc1
  s_waitcnt vmcnt(0)
  s_sub_u32 s73, s73, 1
  s_cmp_lg_u32 s73, 0
  s_cbranch_scc1 L_op_idle
L_op_idle_ok:
  s_mov_b32 s52, s14
  s_mov_b32 s53, s15
  s_mov_b32 s54, 0x80000
  s_mov_b32 s55, 0x20000
  s_mov_b32 s72, 0x0
  s_add_u32 m0, s63, 65536
  s_nop 0
  buffer_load_dwordx4 v12, s[52:55], s72 offen lds
  buffer_load_dwordx4 v13, s[52:55], s72 offen offset:1024 lds
  buffer_load_dwordx4 v14, s[52:55], s72 offen offset:2048 lds
  buffer_load_dwordx4 v15, s[52:55], s72 offen offset:3072 lds
  s_mov_b32 s72, 0x20000
  s_add_u32 m0, s63, 81920
  s_nop 0
  buffer_load_dwordx4 v12, s[52:55], s72 offen lds
  buffer_load_dwordx4 v13, s[52:55], s72 offen offset:1024 lds
  buffer_load_dwordx4 v14, s[52:55], s72 offen offset:2048 lds
  buffer_load_dwordx4 v15, s[52:55], s72 offen offset:3072 lds
  s_mov_b32 s72, 0x40000
  s_add_u32 m0, s63, 98304
  s_nop 0
  buffer_load_dwordx4 v12, s[52:55], s72 offen lds
  buffer_load_dwordx4 v13, s[52:55], s72 offen offset:1024 lds
  buffer_load_dwordx4 v14, s[52:55], s72 offen offset:2048 lds
  buffer_load_dwordx4 v15, s[52:55], s72 offen offset:3072 lds
  s_mov_b32 s72, 0x60000
  s_add_u32 m0, s63, 114688
  s_nop 0
  buffer_load_dwordx4 v12, s[52:55], s72 offen lds
  buffer_load_dwordx4 v13, s[52:55], s72 offen offset:1024 lds
  buffer_load_dwordx4 v14, s[52:55], s72 offen offset:2048 lds
  buffer_load_dwordx4 v15, s[52:55], s72 offen offset:3072 lds
  s_add_u32 s40, s32, 0x7ff000
  s_addc_u32 s41, s33, 0
  s_mov_b32 s42, 0x201000
  s_mov_b32 s43, 0x20000
  s_mov_b32 s72, 0x0
  s_add_u32 m0, s63, 0
  s_nop 0
  buffer_load_dwordx4 v42, s[40:43], s72 offen sc1 lds
  buffer_load_dwordx4 v43, s[40:43], s72 offen offset:1024 sc1 lds
  buffer_load_dwordx4 v44, s[40:43], s72 offen offset:2048 sc1 lds
  buffer_load_dwordx4 v45, s[40:43], s72 offen offset:3072 sc1 lds
  s_mov_b32 s72, 0x80000
  s_add_u32 m0, s63, 16384
  s_nop 0
  buffer_load_dwordx4 v42, s[40:43], s72 offen sc1 lds
  buffer_load_dwordx4 v43, s[40:43], s72 offen offset:1024 sc1 lds
  buffer_load_dwordx4 v44, s[40:43], s72 offen offset:2048 sc1 lds
  buffer_load_dwordx4 v45, s[40:43], s72 offen offset:3072 sc1 lds
  s_mov_b32 s72, 0x100000
  s_add_u32 m0, s63, 32768
  s_nop 0
  buffer_load_dwordx4 v42, s[40:43], s72 offen sc1 lds
  buffer_load_dwordx4 v43, s[40:43], s72 offen offset:1024 sc1 lds
  buffer_load_dwordx4 v44, s[40:43], s72 offen offset:2048 sc1 lds
  buffer_load_dwordx4 v45, s[40:43], s72 offen offset:3072 sc1 lds
  s_mov_b32 s72, 0x180000
  s_add_u32 m0, s63, 49152
  s_nop 0
  buffer_load_dwordx4 v42, s[40:43], s72 offen sc1 lds
  buffer_load_dwordx4 v43, s[40:43], s72 offen offset:1024 sc1 lds
  buffer_load_dwordx4 v44, s[40:43], s72 offen offset:2048 sc1 lds
  buffer_load_dwordx4 v45, s[40:43], s72 offen offset:3072 sc1 lds
L_h4_go:
  v_lshrrev_b32 v48, 4, v0
  s_lshl_b32 s72, s61, 6
  s_lshl_b32 s73, s58, 4
  s_add_u32 s72, s72, s73
  v_and_b32 v49, 15, v0
  s_mov_b32 s74, 2944
  v_add_u32 v50, 0, v48
  v_xor_b32 v51, v50, v49
  v_lshlrev_b32 v51, 4, v51
  v_add_u32 v50, s72, v50
  v_mul_lo_u32 v16, v50, s74
  v_add_u32 v16, v16, v51
  v_add_u32 v50, 4, v48
  v_xor_b32 v51, v50, v49
  v_lshlrev_b32 v51, 4, v51
  v_add_u32 v50, s72, v50
  v_mul_lo_u32 v17, v50, s74
  v_add_u32 v17, v17, v51
  v_add_u32 v17, 4294966272, v17
  v_add_u32 v50, 8, v48
  v_xor_b32 v51, v50, v49
  v_lshlrev_b32 v51, 4, v51
  v_add_u32 v50, s72, v50
  v_mul_lo_u32 v18, v50, s74
  v_add_u32 v18, v18, v51
  v_add_u32 v18, 4294965248, v18
  v_add_u32 v50, 12, v48
  v_xor_b32 v51, v50, v49
  v_lshlrev_b32 v51, 4, v51
  v_add_u32 v50, s72, v50
  v_mul_lo_u32 v19, v50, s74
  v_add_u32 v19, v19, v51
  v_add_u32 v19, 4294964224, v19
  s_waitcnt vmcnt(0)
  s_barrier
  s_mov_b32 s52, s24
  s_mov_b32 s53, s25
  s_mov_b32 s54, 0x158000
  s_mov_b32 s55, 0x20000
  s_barrier
  s_mov_b32 s72, 0x0
  s_add_u32 m0, s63, 65536
  s_nop 0
  buffer_load_dwordx4 v12, s[52:55], s72 offen lds
  buffer_load_dwordx4 v13, s[52:55], s72 offen offset:1024 lds
  buffer_load_dwordx4 v14, s[52:55], s72 offen offset:2048 lds
  buffer_load_dwordx4 v15, s[52:55], s72 offen offset:3072 lds
  s_barrier
  s_mov_b32 s72, 0x20000
  s_add_u32 m0, s63, 81920
  s_nop 0
  buffer_load_dwordx4 v12, s[52:55], s72 offen lds
  buffer_load_dwordx4 v13, s[52:55], s72 offen offset:1024 lds
  buffer_load_dwordx4 v14, s[52:55], s72 offen offset:2048 lds
  buffer_load_dwordx4 v15, s[52:55], s72 offen offset:3072 lds
  s_barrier
  s_mov_b32 s72, 0x40000
  s_add_u32 m0, s63, 98304
  s_nop 0
  buffer_load_dwordx4 v12, s[52:55], s72 offen lds
  buffer_load_dwordx4 v13, s[52:55], s72 offen offset:1024 lds
  buffer_load_dwordx4 v14, s[52:55], s72 offen offset:2048 lds
  buffer_load_dwordx4 v15, s[52:55], s72 offen offset:3072 lds
  s_add_u32 s40, s32, 0xa00000
  s_addc_u32 s41, s33, 0
  s_mov_b32 s42, 0x5c0000
  s_mov_b32 s43, 0x20000
  s_barrier
  s_mov_b32 s72, 0x60000
  s_add_u32 m0, s63, 114688
  s_nop 0
  buffer_load_dwordx4 v12, s[52:55], s72 offen lds
  buffer_load_dwordx4 v13, s[52:55], s72 offen offset:1024 lds
  buffer_load_dwordx4 v14, s[52:55], s72 offen offset:2048 lds
  buffer_load_dwordx4 v15, s[52:55], s72 offen offset:3072 lds
  s_mov_b32 s72, 0x80000
  s_add_u32 m0, s63, 49152
  s_nop 0
  buffer_load_dwordx4 v12, s[52:55], s72 offen lds
  buffer_load_dwordx4 v13, s[52:55], s72 offen offset:1024 lds
  buffer_load_dwordx4 v14, s[52:55], s72 offen offset:2048 lds
  buffer_load_dwordx4 v15, s[52:55], s72 offen offset:3072 lds
  s_barrier
  s_mov_b32 s72, 0
  s_add_u32 m0, s63, 0
  s_nop 0
  buffer_load_dwordx4 v16, s[40:43], s72 offen sc1 lds
  buffer_load_dwordx4 v17, s[40:43], s72 offen offset:1024 sc1 lds
  buffer_load_dwordx4 v18, s[40:43], s72 offen offset:2048 sc1 lds
  buffer_load_dwordx4 v19, s[40:43], s72 offen offset:3072 sc1 lds
  s_mov_b32 s72, 256
  s_add_u32 m0, s63, 16384
  s_nop 0
  buffer_load_dwordx4 v16, s[40:43], s72 offen sc1 lds
  buffer_load_dwordx4 v17, s[40:43], s72 offen offset:1024 sc1 lds
  buffer_load_dwordx4 v18, s[40:43], s72 offen offset:2048 sc1 lds
  buffer_load_dwordx4 v19, s[40:43], s72 offen offset:3072 sc1 lds
  s_waitcnt vmcnt(4)
  s_barrier
  s_mov_b32 s72, 512
  s_add_u32 m0, s63, 32768
  s_nop 0
  buffer_load_dwordx4 v16, s[40:43], s72 offen sc1 lds
  buffer_load_dwordx4 v17, s[40:43], s72 offen offset:1024 sc1 lds
  buffer_load_dwordx4 v18, s[40:43], s72 offen offset:2048 sc1 lds
  buffer_load_dwordx4 v19, s[40:43], s72 offen offset:3072 sc1 lds
  s_waitcnt vmcnt(4)
  s_barrier
  s_mov_b32 s72, 768
  s_add_u32 m0, s63, 0
  s_nop 0
  buffer_load_dwordx4 v16, s[40:43], s72 offen sc1 lds
  buffer_load_dwordx4 v17, s[40:43], s72 offen offset:1024 sc1 lds
  buffer_load_dwordx4 v18, s[40:43], s72 offen offset:2048 sc1 lds
  buffer_load_dwordx4 v19, s[40:43], s72 offen offset:3072 sc1 lds
  s_waitcnt vmcnt(4)
  s_barrier
  s_mov_b32 s72, 1024
  s_add_u32 m0, s63, 16384
  s_nop 0
  buffer_load_dwordx4 v16, s[40:43], s72 offen sc1 lds
  buffer_load_dwordx4 v17, s[40:43], s72 offen offset:1024 sc1 lds
  buffer_load_dwordx4 v18, s[40:43], s72 offen offset:2048 sc1 lds
  buffer_load_dwordx4 v19, s[40:43], s72 offen offset:3072 sc1 lds
  s_waitcnt vmcnt(4)
  s_barrier
  s_mov_b32 s72, 1280
  s_add_u32 m0, s63, 32768
  s_nop 0
  buffer_load_dwordx4 v16, s[40:43], s72 offen sc1 lds
  buffer_load_dwordx4 v17, s[40:43], s72 offen offset:1024 sc1 lds
  buffer_load_dwordx4 v18, s[40:43], s72 offen offset:2048 sc1 lds
  buffer_load_dwordx4 v19, s[40:43], s72 offen offset:3072 sc1 lds
  s_mov_b32 s72, 0xa0000
  s_add_u32 m0, s63, 65536
  s_nop 0
  buffer_load_dwordx4 v12, s[52:55], s72 offen lds
  buffer_load_dwordx4 v13, s[52:55], s72 offen offset:1024 lds
  buffer_load_dwordx4 v14, s[52:55], s72 offen offset:2048 lds
  buffer_load_dwordx4 v15, s[52:55], s72 offen offset:3072 lds
  s_waitcnt vmcnt(8)
  s_barrier
  s_mov_b32 s72, 1536
  s_add_u32 m0, s63, 0
  s_nop 0
  buffer_load_dwordx4 v16, s[40:43], s72 offen sc1 lds
  buffer_load_dwordx4 v17, s[40:43], s72 offen offset:1024 sc1 lds
  buffer_load_dwordx4 v18, s[40:43], s72 offen offset:2048 sc1 lds
  buffer_load_dwordx4 v19, s[40:43], s72 offen offset:3072 sc1 lds
  s_mov_b32 s72, 0xc0000
  s_add_u32 m0, s63, 81920
  s_nop 0
  buffer_load_dwordx4 v12, s[52:55], s72 offen lds
  buffer_load_dwordx4 v13, s[52:55], s72 offen offset:1024 lds
  buffer_load_dwordx4 v14, s[52:55], s72 offen offset:2048 lds
  buffer_load_dwordx4 v15, s[52:55], s72 offen offset:3072 lds
  s_waitcnt vmcnt(8)
  s_barrier
  s_mov_b32 s72, 1792
  s_add_u32 m0, s63, 16384
  s_nop 0
  buffer_load_dwordx4 v16, s[40:43], s72 offen sc1 lds
  buffer_load_dwordx4 v17, s[40:43], s72 offen offset:1024 sc1 lds
  buffer_load_dwordx4 v18, s[40:43], s72 offen offset:2048 sc1 lds
  buffer_load_dwordx4 v19, s[40:43], s72 offen offset:3072 sc1 lds
  s_mov_b32 s72, 0xe0000
  s_add_u32 m0, s63, 98304
  s_nop 0
  buffer_load_dwordx4 v12, s[52:55], s72 offen lds
  buffer_load_dwordx4 v13, s[52:55], s72 offen offset:1024 lds
  buffer_load_dwordx4 v14, s[52:55], s72 offen offset:2048 lds
  buffer_load_dwordx4 v15, s[52:55], s72 offen offset:3072 lds
  s_waitcnt vmcnt(8)
  s_barrier
  s_mov_b32 s72, 2048
  s_add_u32 m0, s63, 32768
  s_nop 0
  buffer_load_dwordx4 v16, s[40:43], s72 offen sc1 lds
  buffer_load_dwordx4 v17, s[40:43], s72 offen offset:1024 sc1 lds
  buffer_load_dwordx4 v18, s[40:43], s72 offen offset:2048 sc1 lds
  buffer_load_dwordx4 v19, s[40:43], s72 offen offset:3072 sc1 lds
  s_mov_b32 s72, 0x100000
  s_add_u32 m0, s63, 114688
  s_nop 0
  buffer_load_dwordx4 v12, s[52:55], s72 offen lds
  buffer_load_dwordx4 v13, s[52:55], s72 offen offset:1024 lds
  buffer_load_dwordx4 v14, s[52:55], s72 offen offset:2048 lds
  buffer_load_dwordx4 v15, s[52:55], s72 offen offset:3072 lds
  s_waitcnt vmcnt(8)
  s_barrier
  s_mov_b32 s72, 2304
  s_add_u32 m0, s63, 0
  s_nop 0
  buffer_load_dwordx4 v16, s[40:43], s72 offen sc1 lds
  buffer_load_dwordx4 v17, s[40:43], s72 offen offset:1024 sc1 lds
  buffer_load_dwordx4 v18, s[40:43], s72 offen offset:2048 sc1 lds
  buffer_load_dwordx4 v19, s[40:43], s72 offen offset:3072 sc1 lds
  s_mov_b32 s72, 0x120000
  s_add_u32 m0, s63, 49152
  s_nop 0
  buffer_load_dwordx4 v12, s[52:55], s72 offen lds
  buffer_load_dwordx4 v13, s[52:55], s72 offen offset:1024 lds
  buffer_load_dwordx4 v14, s[52:55], s72 offen offset:2048 lds
  buffer_load_dwordx4 v15, s[52:55], s72 offen offset:3072 lds
  s_waitcnt vmcnt(8)
  s_barrier
  s_mov_b32 s72, 2560
  s_add_u32 m0, s63, 16384
  s_nop 0
  buffer_load_dwordx4 v16, s[40:43], s72 offen sc1 lds
  buffer_load_dwordx4 v17, s[40:43], s72 offen offset:1024 sc1 lds
  buffer_load_dwordx4 v18, s[40:43], s72 offen offset:2048 sc1 lds
  buffer_load_dwordx4 v19, s[40:43], s72 offen offset:3072 sc1 lds
  s_mov_b32 s72, 0x140000
  s_add_u32 m0, s63, 65536
  s_nop 0
  buffer_load_dwordx4 v12, s[52:55], s72 offen lds
  buffer_load_dwordx4 v13, s[52:55], s72 offen offset:1024 lds
  buffer_load_dwordx4 v14, s[52:55], s72 offen offset:2048 lds
  buffer_load_dwordx4 v15, s[52:55], s72 offen offset:3072 lds
  s_waitcnt vmcnt(8)
  s_barrier
  s_waitcnt vmcnt(0)
  s_barrier
  s_branch L_end
L_compute:
  s_setprio 3
  s_cmp_lg_u32 s35, 0
  s_cbranch_scc1 L_nozero
  v_lshlrev_b32 v149, 2, v0
  v_add_u32 v149, 152576, v149
  v_mov_b32 v150, 0
  s_mov_b32 exec_lo, 0xffff
  s_mov_b32 exec_hi, 0
  ds_write_b32 v149, v150
  s_mov_b64 exec, -1
  s_waitcnt lgkmcnt(0)
L_nozero:
  s_waitcnt lgkmcnt(0)
  s_mov_b32 s48, s32
  s_mov_b32 s49, s33
  s_mov_b32 s50, 0x1400000
  s_mov_b32 s51, 0x20000
  s_add_u32 s72, s32, 0x1281000
  s_addc_u32 s73, s33, 0
  s_load_dword s34, s[72:73], 0
  s_cmp_ge_u32 s39, 8
  s_cbranch_scc1 L_c1_qw
  s_mov_b32 s60, 0
  s_mov_b32 s3, 0
  v_lshrrev_b32 v149, 5, v0
  v_bfe_u32 v150, v0, 1, 3
  v_xor_b32 v149, v149, v150
  v_lshlrev_b32 v149, 4, v149
  v_and_b32 v150, 31, v0
  v_lshlrev_b32 v150, 7, v150
  s_lshl_b32 s72, s56, 13
  v_add_u32 v150, s72, v150
  s_lshl_b32 s72, s3, 12
  s_xor_b32 s73, s72, 4096
  v_xor_b32 v151, 0, v149
  v_add_u32 v151, v150, v151
  v_add_u32 v14, s72, v151
  v_add_u32 v18, s73, v151
  v_xor_b32 v151, 32, v149
  v_add_u32 v151, v150, v151
  v_add_u32 v15, s72, v151
  v_add_u32 v19, s73, v151
  v_xor_b32 v151, 64, v149
  v_add_u32 v151, v150, v151
  v_add_u32 v16, s72, v151
  v_add_u32 v20, s73, v151
  v_xor_b32 v151, 96, v149
  v_add_u32 v151, v150, v151
  v_add_u32 v17, s72, v151
  v_add_u32 v21, s73, v151
  v_lshrrev_b32 v152, 5, v0
  v_lshlrev_b32 v152, 3, v152
  v_bfe_u32 v153, v0, 2, 2
  v_add_u32 v152, v152, v153
  v_lshlrev_b32 v152, 7, v152
  v_and_b32 v153, 1, v0
  v_lshlrev_b32 v153, 3, v153
  v_add_u32 v152, v152, v153
  v_bfe_u32 v153, v0, 4, 1
  v_lshlrev_b32 v153, 1, v153
  v_bfe_u32 v154, v0, 1, 1
  v_add_u32 v153, v153, v154
  s_lshl_b32 s72, s57, 2
  v_add_u32 v153, s72, v153
  v_bfe_u32 v154, v0, 3, 1
  v_lshlrev_b32 v154, 2, v154
  v_xor_b32 v153, v153, v154
  v_lshlrev_b32 v153, 4, v153
  v_add_u32 v149, v152, v153
  v_add_u32 v149, 0x10000, v149
  s_lshl_b32 s72, s60, 13
  s_xor_b32 s73, s72, 8192
  v_add_u32 v22, s72, v149
  v_add_u32 v23, s73, v149
  v_lshlrev_b32 v149, 3, v0
  v_add_u32 v149, s39, v149
  v_mov_b32 v150, s38
  v_lshlrev_b32 v12, 7, v149
  v_lshlrev_b32 v150, 2, v150
  v_add_u32 v12, v12, v150
  v_add_u32 v12, 0x1228000, v12
  s_mov_b32 s70, -1
  s_mov_b32 s71, 0
  v_mov_b32 v150, 0x3fb8aa3b
  v_mov_b32 v151, 0xbfb8aa3b
  v_bfe_u32 v240, v0, 2, 2
  v_lshrrev_b32 v241, 5, v0
  v_lshlrev_b32 v241, 2, v241
  v_add_u32 v240, v240, v241
  v_lshlrev_b32 v240, 5, v240
  v_and_b32 v241, 3, v0
  v_lshlrev_b32 v241, 3, v241
  v_add_u32 v240, v240, v241
  s_lshl_b32 s72, s57, 10
  s_add_u32 s72, s72, 147456
  v_add_u32 v186, s72, v240
  s_lshl_b32 s72, s35, 12
  s_add_u32 s72, s72, 131072
  v_lshrrev_b32 v241, 5, v0
  v_bfe_u32 v242, v0, 1, 3
  v_xor_b32 v241, v241, v242
  v_lshlrev_b32 v241, 3, v241
  v_and_b32 v242, 31, v0
  v_lshlrev_b32 v242, 6, v242
  v_add_u32 v242, s72, v242
  v_xor_b32 v243, 0, v241
  v_add_u32 v180, v242, v243
  v_xor_b32 v243, 16, v241
  v_add_u32 v181, v242, v243
  v_xor_b32 v243, 32, v241
  v_add_u32 v182, v242, v243
  v_xor_b32 v243, 48, v241
  v_add_u32 v183, v242, v243
  v_lshrrev_b32 v241, 5, v0
  v_bfe_u32 v242, v0, 2, 2
  v_lshlrev_b32 v243, 2, v241
  v_add_u32 v243, v243, v242
  v_lshlrev_b32 v243, 6, v243
  v_add_u32 v243, s72, v243
  v_lshlrev_b32 v241, 1, v241
  v_bfe_u32 v242, v0, 3, 1
  v_add_u32 v241, v241, v242
  v_bfe_u32 v242, v0, 4, 1
  v_lshlrev_b32 v242, 2, v242
  v_and_b32 v184, 3, v0
  v_add_u32 v242, v242, v184
  v_xor_b32 v241, v241, v242
  v_lshlrev_b32 v241, 3, v241
  v_add_u32 v184, v243, v241
  v_xor_b32 v241, 32, v241
  v_add_u32 v185, v243, v241
  v_lshlrev_b32 v240, 4, v0
  v_add_u32 v187, s72, v240
  s_lshl_b32 s73, s35, 12
  s_xor_b32 s73, s73, 8192
  s_add_u32 s73, s73, 131072
  v_add_u32 v188, s73, v240
  s_lshl_b32 s63, s39, 2
  s_lshl_b32 s73, s57, 1
  s_add_u32 s63, s63, s73
  s_add_u32 s63, s63, s56
  s_lshl_b32 s63, s63, 4
  s_add_u32 s63, s63, s38
  s_lshl_b32 s63, s63, 11
  s_add_u32 s63, s63, 0x400000
  s_waitcnt lgkmcnt(0)
  s_mul_i32 s34, s34, 0x9e3779b1
  s_add_u32 s34, s34, 0x7f4a7c15
  s_barrier
  ds_read_b64_tr_b16 v[40:41], v22 offset:0
  ds_read_b64_tr_b16 v[42:43], v22 offset:512
  ds_read_b128 v[24:27], v14 offset:0
  ds_read_b64_tr_b16 v[44:45], v23 offset:0
  ds_read_b64_tr_b16 v[46:47], v23 offset:512
  ds_read_b128 v[28:31], v18 offset:0
  s_waitcnt lgkmcnt(3)
  v_mfma_f32_32x32x16_bf16 v[56:71], v[40:43], v[24:27], 0
  ds_read_b64_tr_b16 v[48:49], v22 offset:2048
  ds_read_b64_tr_b16 v[50:51], v22 offset:2560
  s_waitcnt lgkmcnt(3)
  v_mfma_f32_32x32x16_bf16 v[72:87], v[24:27], v[44:47], 0
  ds_read_b128 v[32:35], v15 offset:0
  ds_read_b64_tr_b16 v[52:53], v23 offset:2048
  s_waitcnt lgkmcnt(4)
  v_mfma_f32_32x32x16_bf16 v[88:103], v[40:43], v[28:31], 0
  ds_read_b64_tr_b16 v[54:55], v23 offset:2560
  ds_read_b128 v[36:39], v19 offset:0
  v_mfma_f32_32x32x16_bf16 v[104:119], v[28:31], v[44:47], 0
  s_waitcnt lgkmcnt(3)
  v_mfma_f32_32x32x16_bf16 v[56:71], v[48:51], v[32:35], v[56:71]
  ds_read_b64_tr_b16 v[40:41], v22 offset:4096
  ds_read_b64_tr_b16 v[42:43], v22 offset:4608
  s_waitcnt lgkmcnt(3)
  v_mfma_f32_32x32x16_bf16 v[72:87], v[32:35], v[52:55], v[72:87]
  ds_read_b128 v[24:27], v16 offset:0
  ds_read_b64_tr_b16 v[44:45], v23 offset:4096
  s_waitcnt lgkmcnt(4)
  v_mfma_f32_32x32x16_bf16 v[88:103], v[48:51], v[36:39], v[88:103]
  ds_read_b64_tr_b16 v[46:47], v23 offset:4608
  ds_read_b128 v[28:31], v20 offset:0
  v_mfma_f32_32x32x16_bf16 v[104:119], v[36:39], v[52:55], v[104:119]
  s_waitcnt lgkmcnt(3)
  v_mfma_f32_32x32x16_bf16 v[56:71], v[40:43], v[24:27], v[56:71]
  ds_read_b64_tr_b16 v[48:49], v22 offset:6144
  ds_read_b64_tr_b16 v[50:51], v22 offset:6656
  s_waitcnt lgkmcnt(3)
  v_mfma_f32_32x32x16_bf16 v[72:87], v[24:27], v[44:47], v[72:87]
  ds_read_b128 v[32:35], v17 offset:0
  ds_read_b64_tr_b16 v[52:53], v23 offset:6144
  s_waitcnt lgkmcnt(4)
  v_mfma_f32_32x32x16_bf16 v[88:103], v[40:43], v[28:31], v[88:103]
  ds_read_b64_tr_b16 v[54:55], v23 offset:6656
  ds_read_b128 v[36:39], v21 offset:0
  v_mfma_f32_32x32x16_bf16 v[104:119], v[28:31], v[44:47], v[104:119]
  s_waitcnt lgkmcnt(0)
  s_barrier
  v_mfma_f32_32x32x16_bf16 v[56:71], v[48:51], v[32:35], v[56:71]
  ds_read_b64_tr_b16 v[40:41], v22 offset:16384
  ds_read_b64_tr_b16 v[42:43], v22 offset:16896
  v_mfma_f32_32x32x16_bf16 v[72:87], v[32:35], v[52:55], v[72:87]
  ds_read_b128 v[24:27], v14 offset:16384
  ds_read_b64_tr_b16 v[44:45], v23 offset:16384
  v_mfma_f32_32x32x16_bf16 v[88:103], v[48:51], v[36:39], v[88:103]
  ds_read_b64_tr_b16 v[46:47], v23 offset:16896
  ds_read_b128 v[28:31], v18 offset:16384
  v_mfma_f32_32x32x16_bf16 v[104:119], v[36:39], v[52:55], v[104:119]
  s_waitcnt lgkmcnt(3)
  v_mfma_f32_32x32x16_bf16 v[56:71], v[40:43], v[24:27], v[56:71]
  ds_read_b64_tr_b16 v[48:49], v22 offset:18432
  ds_read_b64_tr_b16 v[50:51], v22 offset:18944
  s_waitcnt lgkmcnt(3)
  v_mfma_f32_32x32x16_bf16 v[72:87], v[24:27], v[44:47], v[72:87]
  ds_read_b128 v[32:35], v15 offset:16384
  ds_read_b64_tr_b16 v[52:53], v23 offset:18432
  s_waitcnt lgkmcnt(4)
  v_mfma_f32_32x32x16_bf16 v[88:103], v[40:43], v[28:31], v[88:103]
  ds_read_b64_tr_b16 v[54:55], v23 offset:18944
  ds_read_b128 v[36:39], v19 offset:16384
  v_mfma_f32_32x32x16_bf16 v[104:119], v[28:31], v[44:47], v[104:119]
  s_waitcnt lgkmcnt(3)
  v_mfma_f32_32x32x16_bf16 v[56:71], v[48:51], v[32:35], v[56:71]
  ds_read_b64_tr_b16 v[40:41], v22 offset:20480
  ds_read_b64_tr_b16 v[42:43], v22 offset:20992
  s_waitcnt lgkmcnt(3)
  v_mfma_f32_32x32x16_bf16 v[72:87], v[32:35], v[52:55], v[72:87]
  ds_read_b128 v[24:27], v16 offset:16384
  ds_read_b64_tr_b16 v[44:45], v23 offset:20480
  s_waitcnt lgkmcnt(4)
  v_mfma_f32_32x32x16_bf16 v[88:103], v[48:51], v[36:39], v[88:103]
  ds_read_b64_tr_b16 v[46:47], v23 offset:20992
  ds_read_b128 v[28:31], v20 offset:16384
  v_mfma_f32_32x32x16_bf16 v[104:119], v[36:39], v[52:55], v[104:119]
  s_waitcnt lgkmcnt(3)
  v_mfma_f32_32x32x16_bf16 v[56:71], v[40:43], v[24:27], v[56:71]
  ds_read_b64_tr_b16 v[48:49], v22 offset:22528
  ds_read_b64_tr_b16 v[50:51], v22 offset:23040
  s_waitcnt lgkmcnt(3)
  v_mfma_f32_32x32x16_bf16 v[72:87], v[24:27], v[44:47], v[72:87]
  ds_read_b128 v[32:35], v17 offset:16384
  ds_read_b64_tr_b16 v[52:53], v23 offset:22528
  s_waitcnt lgkmcnt(4)
  v_mfma_f32_32x32x16_bf16 v[88:103], v[40:43], v[28:31], v[88:103]
  ds_read_b64_tr_b16 v[54:55], v23 offset:23040
  ds_read_b128 v[36:39], v21 offset:16384
  v_mfma_f32_32x32x16_bf16 v[104:119], v[28:31], v[44:47], v[104:119]
  s_waitcnt lgkmcnt(0)
  s_barrier
  v_mfma_f32_32x32x16_bf16 v[56:71], v[48:51], v[32:35], v[56:71]
  ds_read_b64_tr_b16 v[40:41], v22 offset:32768
  ds_read_b64_tr_b16 v[42:43], v22 offset:33280
  v_mfma_f32_32x32x16_bf16 v[72:87], v[32:35], v[52:55], v[72:87]
  ds_read_b128 v[24:27], v14 offset:32768
  ds_read_b64_tr_b16 v[44:45], v23 offset:32768
  v_mfma_f32_32x32x16_bf16 v[88:103], v[48:51], v[36:39], v[88:103]
  ds_read_b64_tr_b16 v[46:47], v23 offset:33280
  ds_read_b128 v[28:31], v18 offset:32768
  v_mfma_f32_32x32x16_bf16 v[104:119], v[36:39], v[52:55], v[104:119]
  s_waitcnt lgkmcnt(3)
  v_mfma_f32_32x32x16_bf16 v[56:71], v[40:43], v[24:27], v[56:71]
  ds_read_b64_tr_b16 v[48:49], v22 offset:34816
  ds_read_b64_tr_b16 v[50:51], v22 offset:35328
  s_waitcnt lgkmcnt(3)
  v_mfma_f32_32x32x16_bf16 v[72:87], v[24:27], v[44:47], v[72:87]
  ds_read_b128 v[32:35], v15 offset:32768
  ds_read_b64_tr_b16 v[52:53], v23 offset:34816
  s_waitcnt lgkmcnt(4)
  v_mfma_f32_32x32x16_bf16 v[88:103], v[40:43], v[28:31], v[88:103]
  ds_read_b64_tr_b16 v[54:55], v23 offset:35328
  ds_read_b128 v[36:39], v19 offset:32768
  v_mfma_f32_32x32x16_bf16 v[104:119], v[28:31], v[44:47], v[104:119]
  s_waitcnt lgkmcnt(3)
  v_mfma_f32_32x32x16_bf16 v[56:71], v[48:51], v[32:35], v[56:71]
  ds_read_b64_tr_b16 v[40:41], v22 offset:36864
  ds_read_b64_tr_b16 v[42:43], v22 offset:37376
  s_waitcnt lgkmcnt(3)
  v_mfma_f32_32x32x16_bf16 v[72:87], v[32:35], v[52:55], v[72:87]
  ds_read_b128 v[24:27], v16 offset:32768
  ds_read_b64_tr_b16 v[44:45], v23 offset:36864
  s_waitcnt lgkmcnt(4)
  v_mfma_f32_32x32x16_bf16 v[88:103], v[48:51], v[36:39], v[88:103]
  ds_read_b64_tr_b16 v[46:47], v23 offset:37376
  ds_read_b128 v[28:31], v20 offset:32768
  v_mfma_f32_32x32x16_bf16 v[104:119], v[36:39], v[52:55], v[104:119]
  s_waitcnt lgkmcnt(3)
  v_mfma_f32_32x32x16_bf16 v[56:71], v[40:43], v[24:27], v[56:71]
  ds_read_b64_tr_b16 v[48:49], v22 offset:38912
  ds_read_b64_tr_b16 v[50:51], v22 offset:39424
  s_waitcnt lgkmcnt(3)
  v_mfma_f32_32x32x16_bf16 v[72:87], v[24:27], v[44:47], v[72:87]
  ds_read_b128 v[32:35], v17 offset:32768
  ds_read_b64_tr_b16 v[52:53], v23 offset:38912
  s_waitcnt lgkmcnt(4)
  v_mfma_f32_32x32x16_bf16 v[88:103], v[40:43], v[28:31], v[88:103]
  ds_read_b64_tr_b16 v[54:55], v23 offset:39424
  ds_read_b128 v[36:39], v21 offset:32768
  v_mfma_f32_32x32x16_bf16 v[104:119], v[28:31], v[44:47], v[104:119]
  s_waitcnt lgkmcnt(0)
  s_barrier
  v_mfma_f32_32x32x16_bf16 v[56:71], v[48:51], v[32:35], v[56:71]
  ds_read_b64_tr_b16 v[40:41], v22 offset:49152
  ds_read_b64_tr_b16 v[42:43], v22 offset:49664
  v_mfma_f32_32x32x16_bf16 v[72:87], v[32:35], v[52:55], v[72:87]
  ds_read_b128 v[24:27], v14 offset:49152
  ds_read_b64_tr_b16 v[44:45], v23 offset:49152
  v_mfma_f32_32x32x16_bf16 v[88:103], v[48:51], v[36:39], v[88:103]
  ds_read_b64_tr_b16 v[46:47], v23 offset:49664
  ds_read_b128 v[28:31], v18 offset:49152
  v_mfma_f32_32x32x16_bf16 v[104:119], v[36:39], v[52:55], v[104:119]
  s_waitcnt lgkmcnt(3)
  v_mfma_f32_32x32x16_bf16 v[56:71], v[40:43], v[24:27], v[56:71]
  ds_read_b64_tr_b16 v[48:49], v22 offset:51200
  ds_read_b64_tr_b16 v[50:51], v22 offset:51712
  s_waitcnt lgkmcnt(3)
  v_mfma_f32_32x32x16_bf16 v[72:87], v[24:27], v[44:47], v[72:87]
  ds_read_b128 v[32:35], v15 offset:49152
  ds_read_b64_tr_b16 v[52:53], v23 offset:51200
  s_waitcnt lgkmcnt(4)
  v_mfma_f32_32x32x16_bf16 v[88:103], v[40:43], v[28:31], v[88:103]
  ds_read_b64_tr_b16 v[54:55], v23 offset:51712
  ds_read_b128 v[36:39], v19 offset:49152
  v_mfma_f32_32x32x16_bf16 v[104:119], v[28:31], v[44:47], v[104:119]
  s_waitcnt lgkmcnt(3)
  v_mfma_f32_32x32x16_bf16 v[56:71], v[48:51], v[32:35], v[56:71]
  ds_read_b64_tr_b16 v[40:41], v22 offset:53248
  ds_read_b64_tr_b16 v[42:43], v22 offset:53760
  s_waitcnt lgkmcnt(3)
  v_mfma_f32_32x32x16_bf16 v[72:87], v[32:35], v[52:55], v[72:87]
  ds_read_b128 v[24:27], v16 offset:49152
  ds_read_b64_tr_b16 v[44:45], v23 offset:53248
  s_waitcnt lgkmcnt(4)
  v_mfma_f32_32x32x16_bf16 v[88:103], v[48:51], v[36:39], v[88:103]
  ds_read_b64_tr_b16 v[46:47], v23 offset:53760
  ds_read_b128 v[28:31], v20 offset:49152
  v_mfma_f32_32x32x16_bf16 v[104:119], v[36:39], v[52:55], v[104:119]
  s_waitcnt lgkmcnt(3)
  v_mfma_f32_32x32x16_bf16 v[56:71], v[40:43], v[24:27], v[56:71]
  ds_read_b64_tr_b16 v[48:49], v22 offset:55296
  ds_read_b64_tr_b16 v[50:51], v22 offset:55808
  s_waitcnt lgkmcnt(3)
  v_mfma_f32_32x32x16_bf16 v[72:87], v[24:27], v[44:47], v[72:87]
  ds_read_b128 v[32:35], v17 offset:49152
  ds_read_b64_tr_b16 v[52:53], v23 offset:55296
  s_waitcnt lgkmcnt(4)
  v_mfma_f32_32x32x16_bf16 v[88:103], v[40:43], v[28:31], v[88:103]
  ds_read_b64_tr_b16 v[54:55], v23 offset:55808
  ds_read_b128 v[36:39], v21 offset:49152
  v_mfma_f32_32x32x16_bf16 v[104:119], v[28:31], v[44:47], v[104:119]
  s_waitcnt lgkmcnt(0)
  s_barrier
  v_mfma_f32_32x32x16_bf16 v[56:71], v[48:51], v[32:35], v[56:71]
  ds_read_b64_tr_b16 v[40:41], v22 offset:0
  ds_read_b64_tr_b16 v[42:43], v22 offset:512
  v_mfma_f32_32x32x16_bf16 v[72:87], v[32:35], v[52:55], v[72:87]
  ds_read_b128 v[24:27], v14 offset:0
  ds_read_b64_tr_b16 v[44:45], v23 offset:0
  v_mfma_f32_32x32x16_bf16 v[88:103], v[48:51], v[36:39], v[88:103]
  ds_read_b64_tr_b16 v[46:47], v23 offset:512
  ds_read_b128 v[28:31], v18 offset:0
  v_mfma_f32_32x32x16_bf16 v[104:119], v[36:39], v[52:55], v[104:119]
  s_waitcnt lgkmcnt(3)
  v_mfma_f32_32x32x16_bf16 v[56:71], v[40:43], v[24:27], v[56:71]
  ds_read_b64_tr_b16 v[48:49], v22 offset:2048
  ds_read_b64_tr_b16 v[50:51], v22 offset:2560
  s_waitcnt lgkmcnt(3)
  v_mfma_f32_32x32x16_bf16 v[72:87], v[24:27], v[44:47], v[72:87]
  ds_read_b128 v[32:35], v15 offset:0
  ds_read_b64_tr_b16 v[52:53], v23 offset:2048
  s_waitcnt lgkmcnt(4)
  v_mfma_f32_32x32x16_bf16 v[88:103], v[40:43], v[28:31], v[88:103]
  ds_read_b64_tr_b16 v[54:55], v23 offset:2560
  ds_read_b128 v[36:39], v19 offset:0
  v_mfma_f32_32x32x16_bf16 v[104:119], v[28:31], v[44:47], v[104:119]
  s_waitcnt lgkmcnt(3)
  v_mfma_f32_32x32x16_bf16 v[56:71], v[48:51], v[32:35], v[56:71]
  ds_read_b64_tr_b16 v[40:41], v22 offset:4096
  ds_read_b64_tr_b16 v[42:43], v22 offset:4608
  s_waitcnt lgkmcnt(3)
  v_mfma_f32_32x32x16_bf16 v[72:87], v[32:35], v[52:55], v[72:87]
  ds_read_b128 v[24:27], v16 offset:0
  ds_read_b64_tr_b16 v[44:45], v23 offset:4096
  s_waitcnt lgkmcnt(4)
  v_mfma_f32_32x32x16_bf16 v[88:103], v[48:51], v[36:39], v[88:103]
  ds_read_b64_tr_b16 v[46:47], v23 offset:4608
  ds_read_b128 v[28:31], v20 offset:0
  v_mfma_f32_32x32x16_bf16 v[104:119], v[36:39], v[52:55], v[104:119]
  s_waitcnt lgkmcnt(3)
  v_mfma_f32_32x32x16_bf16 v[56:71], v[40:43], v[24:27], v[56:71]
  ds_read_b64_tr_b16 v[48:49], v22 offset:6144
  ds_read_b64_tr_b16 v[50:51], v22 offset:6656
  s_waitcnt lgkmcnt(3)
  v_mfma_f32_32x32x16_bf16 v[72:87], v[24:27], v[44:47], v[72:87]
  ds_read_b128 v[32:35], v17 offset:0
  ds_read_b64_tr_b16 v[52:53], v23 offset:6144
  s_waitcnt lgkmcnt(4)
  v_mfma_f32_32x32x16_bf16 v[88:103], v[40:43], v[28:31], v[88:103]
  ds_read_b64_tr_b16 v[54:55], v23 offset:6656
  ds_read_b128 v[36:39], v21 offset:0
  v_mfma_f32_32x32x16_bf16 v[104:119], v[28:31], v[44:47], v[104:119]
  s_waitcnt lgkmcnt(0)
  s_barrier
  v_mfma_f32_32x32x16_bf16 v[56:71], v[48:51], v[32:35], v[56:71]
  ds_read_b64_tr_b16 v[40:41], v22 offset:16384
  ds_read_b64_tr_b16 v[42:43], v22 offset:16896
  v_mfma_f32_32x32x16_bf16 v[72:87], v[32:35], v[52:55], v[72:87]
  ds_read_b128 v[24:27], v14 offset:16384
  ds_read_b64_tr_b16 v[44:45], v23 offset:16384
  v_mfma_f32_32x32x16_bf16 v[88:103], v[48:51], v[36:39], v[88:103]
  ds_read_b64_tr_b16 v[46:47], v23 offset:16896
  ds_read_b128 v[28:31], v18 offset:16384
  v_mfma_f32_32x32x16_bf16 v[104:119], v[36:39], v[52:55], v[104:119]
  s_waitcnt lgkmcnt(3)
  v_mfma_f32_32x32x16_bf16 v[56:71], v[40:43], v[24:27], v[56:71]
  ds_read_b64_tr_b16 v[48:49], v22 offset:18432
  ds_read_b64_tr_b16 v[50:51], v22 offset:18944
  s_waitcnt lgkmcnt(3)
  v_mfma_f32_32x32x16_bf16 v[72:87], v[24:27], v[44:47], v[72:87]
  ds_read_b128 v[32:35], v15 offset:16384
  ds_read_b64_tr_b16 v[52:53], v23 offset:18432
  s_waitcnt lgkmcnt(4)
  v_mfma_f32_32x32x16_bf16 v[88:103], v[40:43], v[28:31], v[88:103]
  ds_read_b64_tr_b16 v[54:55], v23 offset:18944
  ds_read_b128 v[36:39], v19 offset:16384
  v_mfma_f32_32x32x16_bf16 v[104:119], v[28:31], v[44:47], v[104:119]
  s_waitcnt lgkmcnt(3)
  v_mfma_f32_32x32x16_bf16 v[56:71], v[48:51], v[32:35], v[56:71]
  ds_read_b64_tr_b16 v[40:41], v22 offset:20480
  ds_read_b64_tr_b16 v[42:43], v22 offset:20992
  s_waitcnt lgkmcnt(3)
  v_mfma_f32_32x32x16_bf16 v[72:87], v[32:35], v[52:55], v[72:87]
  ds_read_b128 v[24:27], v16 offset:16384
  ds_read_b64_tr_b16 v[44:45], v23 offset:20480
  s_waitcnt lgkmcnt(4)
  v_mfma_f32_32x32x16_bf16 v[88:103], v[48:51], v[36:39], v[88:103]
  ds_read_b64_tr_b16 v[46:47], v23 offset:20992
  ds_read_b128 v[28:31], v20 offset:16384
  v_mfma_f32_32x32x16_bf16 v[104:119], v[36:39], v[52:55], v[104:119]
  s_waitcnt lgkmcnt(3)
  v_mfma_f32_32x32x16_bf16 v[56:71], v[40:43], v[24:27], v[56:71]
  ds_read_b64_tr_b16 v[48:49], v22 offset:22528
  ds_read_b64_tr_b16 v[50:51], v22 offset:23040
  s_waitcnt lgkmcnt(3)
  v_mfma_f32_32x32x16_bf16 v[72:87], v[24:27], v[44:47], v[72:87]
  ds_read_b128 v[32:35], v17 offset:16384
  ds_read_b64_tr_b16 v[52:53], v23 offset:22528
  s_waitcnt lgkmcnt(4)
  v_mfma_f32_32x32x16_bf16 v[88:103], v[40:43], v[28:31], v[88:103]
  ds_read_b64_tr_b16 v[54:55], v23 offset:23040
  ds_read_b128 v[36:39], v21 offset:16384
  v_mfma_f32_32x32x16_bf16 v[104:119], v[28:31], v[44:47], v[104:119]
  s_waitcnt lgkmcnt(0)
  s_barrier
  v_mfma_f32_32x32x16_bf16 v[56:71], v[48:51], v[32:35], v[56:71]
  ds_read_b64_tr_b16 v[40:41], v22 offset:32768
  ds_read_b64_tr_b16 v[42:43], v22 offset:33280
  v_mfma_f32_32x32x16_bf16 v[72:87], v[32:35], v[52:55], v[72:87]
  ds_read_b128 v[24:27], v14 offset:32768
  ds_read_b64_tr_b16 v[44:45], v23 offset:32768
  v_mfma_f32_32x32x16_bf16 v[88:103], v[48:51], v[36:39], v[88:103]
  ds_read_b64_tr_b16 v[46:47], v23 offset:33280
  ds_read_b128 v[28:31], v18 offset:32768
  v_mfma_f32_32x32x16_bf16 v[104:119], v[36:39], v[52:55], v[104:119]
  s_waitcnt lgkmcnt(3)
  v_mfma_f32_32x32x16_bf16 v[56:71], v[40:43], v[24:27], v[56:71]
  ds_read_b64_tr_b16 v[48:49], v22 offset:34816
  ds_read_b64_tr_b16 v[50:51], v22 offset:35328
  s_waitcnt lgkmcnt(3)
  v_mfma_f32_32x32x16_bf16 v[72:87], v[24:27], v[44:47], v[72:87]
  ds_read_b128 v[32:35], v15 offset:32768
  ds_read_b64_tr_b16 v[52:53], v23 offset:34816
  s_waitcnt lgkmcnt(4)
  v_mfma_f32_32x32x16_bf16 v[88:103], v[40:43], v[28:31], v[88:103]
  ds_read_b64_tr_b16 v[54:55], v23 offset:35328
  ds_read_b128 v[36:39], v19 offset:32768
  v_mfma_f32_32x32x16_bf16 v[104:119], v[28:31], v[44:47], v[104:119]
  s_waitcnt lgkmcnt(3)
  v_mfma_f32_32x32x16_bf16 v[56:71], v[48:51], v[32:35], v[56:71]
  ds_read_b64_tr_b16 v[40:41], v22 offset:36864
  ds_read_b64_tr_b16 v[42:43], v22 offset:37376
  s_waitcnt lgkmcnt(3)
  v_mfma_f32_32x32x16_bf16 v[72:87], v[32:35], v[52:55], v[72:87]
  ds_read_b128 v[24:27], v16 offset:32768
  ds_read_b64_tr_b16 v[44:45], v23 offset:36864
  s_waitcnt lgkmcnt(4)
  v_mfma_f32_32x32x16_bf16 v[88:103], v[48:51], v[36:39], v[88:103]
  ds_read_b64_tr_b16 v[46:47], v23 offset:37376
  ds_read_b128 v[28:31], v20 offset:32768
  v_mfma_f32_32x32x16_bf16 v[104:119], v[36:39], v[52:55], v[104:119]
  s_waitcnt lgkmcnt(3)
  v_mfma_f32_32x32x16_bf16 v[56:71], v[40:43], v[24:27], v[56:71]
  ds_read_b64_tr_b16 v[48:49], v22 offset:38912
  ds_read_b64_tr_b16 v[50:51], v22 offset:39424
  s_waitcnt lgkmcnt(3)
  v_mfma_f32_32x32x16_bf16 v[72:87], v[24:27], v[44:47], v[72:87]
  ds_read_b128 v[32:35], v17 offset:32768
  ds_read_b64_tr_b16 v[52:53], v23 offset:38912
  s_waitcnt lgkmcnt(4)
  v_mfma_f32_32x32x16_bf16 v[88:103], v[40:43], v[28:31], v[88:103]
  ds_read_b64_tr_b16 v[54:55], v23 offset:39424
  ds_read_b128 v[36:39], v21 offset:32768
  v_mfma_f32_32x32x16_bf16 v[104:119], v[28:31], v[44:47], v[104:119]
  s_waitcnt lgkmcnt(0)
  s_barrier
  v_mfma_f32_32x32x16_bf16 v[56:71], v[48:51], v[32:35], v[56:71]
  ds_read_b64_tr_b16 v[40:41], v22 offset:49152
  ds_read_b64_tr_b16 v[42:43], v22 offset:49664
  v_mfma_f32_32x32x16_bf16 v[72:87], v[32:35], v[52:55], v[72:87]
  ds_read_b128 v[24:27], v14 offset:49152
  ds_read_b64_tr_b16 v[44:45], v23 offset:49152
  v_mfma_f32_32x32x16_bf16 v[88:103], v[48:51], v[36:39], v[88:103]
  ds_read_b64_tr_b16 v[46:47], v23 offset:49664
  ds_read_b128 v[28:31], v18 offset:49152
  v_mfma_f32_32x32x16_bf16 v[104:119], v[36:39], v[52:55], v[104:119]
  s_waitcnt lgkmcnt(3)
  v_mfma_f32_32x32x16_bf16 v[56:71], v[40:43], v[24:27], v[56:71]
  ds_read_b64_tr_b16 v[48:49], v22 offset:51200
  ds_read_b64_tr_b16 v[50:51], v22 offset:51712
  s_waitcnt lgkmcnt(3)
  v_mfma_f32_32x32x16_bf16 v[72:87], v[24:27], v[44:47], v[72:87]
  ds_read_b128 v[32:35], v15 offset:49152
  ds_read_b64_tr_b16 v[52:53], v23 offset:51200
  s_waitcnt lgkmcnt(4)
  v_mfma_f32_32x32x16_bf16 v[88:103], v[40:43], v[28:31], v[88:103]
  ds_read_b64_tr_b16 v[54:55], v23 offset:51712
  ds_read_b128 v[36:39], v19 offset:49152
  v_mfma_f32_32x32x16_bf16 v[104:119], v[28:31], v[44:47], v[104:119]
  s_waitcnt lgkmcnt(3)
  v_mfma_f32_32x32x16_bf16 v[56:71], v[48:51], v[32:35], v[56:71]
  ds_read_b64_tr_b16 v[40:41], v22 offset:53248
  ds_read_b64_tr_b16 v[42:43], v22 offset:53760
  s_waitcnt lgkmcnt(3)
  v_mfma_f32_32x32x16_bf16 v[72:87], v[32:35], v[52:55], v[72:87]
  ds_read_b128 v[24:27], v16 offset:49152
  ds_read_b64_tr_b16 v[44:45], v23 offset:53248
  s_waitcnt lgkmcnt(4)
  v_mfma_f32_32x32x16_bf16 v[88:103], v[48:51], v[36:39], v[88:103]
  ds_read_b64_tr_b16 v[46:47], v23 offset:53760
  ds_read_b128 v[28:31], v20 offset:49152
  v_mfma_f32_32x32x16_bf16 v[104:119], v[36:39], v[52:55], v[104:119]
  s_waitcnt lgkmcnt(3)
  v_mfma_f32_32x32x16_bf16 v[56:71], v[40:43], v[24:27], v[56:71]
  ds_read_b64_tr_b16 v[48:49], v22 offset:55296
  ds_read_b64_tr_b16 v[50:51], v22 offset:55808
  s_waitcnt lgkmcnt(3)
  v_mfma_f32_32x32x16_bf16 v[72:87], v[24:27], v[44:47], v[72:87]
  ds_read_b128 v[32:35], v17 offset:49152
  ds_read_b64_tr_b16 v[52:53], v23 offset:55296
  s_waitcnt lgkmcnt(4)
  v_mfma_f32_32x32x16_bf16 v[88:103], v[40:43], v[28:31], v[88:103]
  ds_read_b64_tr_b16 v[54:55], v23 offset:55808
  ds_read_b128 v[36:39], v21 offset:49152
  v_mfma_f32_32x32x16_bf16 v[104:119], v[28:31], v[44:47], v[104:119]
  s_waitcnt lgkmcnt(3)
  v_mfma_f32_32x32x16_bf16 v[56:71], v[48:51], v[32:35], v[56:71]
  s_waitcnt lgkmcnt(1)
  v_mfma_f32_32x32x16_bf16 v[72:87], v[32:35], v[52:55], v[72:87]
  s_waitcnt lgkmcnt(0)
  v_mfma_f32_32x32x16_bf16 v[88:103], v[48:51], v[36:39], v[88:103]
  v_mfma_f32_32x32x16_bf16 v[104:119], v[36:39], v[52:55], v[104:119]
  ds_read_b64_tr_b16 v[152:153], v186
  ds_read_b64_tr_b16 v[154:155], v186 offset:256
  ds_read_b64_tr_b16 v[156:157], v186 offset:512
  ds_read_b64_tr_b16 v[158:159], v186 offset:768
  s_barrier
  s_waitcnt lgkmcnt(0)
  s_mov_b32 exec_lo, 0xffff0000
  s_mov_b32 exec_hi, 0xffff0000
  v_mov_b32 v152, 0
  v_mov_b32 v153, 0
  v_mov_b32 v154, 0
  v_mov_b32 v155, 0
  s_mov_b32 exec_lo, 0x0000ffff
  s_mov_b32 exec_hi, 0x0000ffff
  v_mov_b32 v156, 0
  v_mov_b32 v157, 0
  v_mov_b32 v158, 0
  v_mov_b32 v159, 0
  s_mov_b64 exec, -1
  v_cvt_pk_bf16_f32 v24, v56, v57
  v_cvt_pk_bf16_f32 v25, v58, v59
  v_cvt_pk_bf16_f32 v26, v60, v61
  v_cvt_pk_bf16_f32 v27, v62, v63
  v_cvt_pk_bf16_f32 v28, v64, v65
  v_cvt_pk_bf16_f32 v29, v66, v67
  v_cvt_pk_bf16_f32 v30, v68, v69
  v_cvt_pk_bf16_f32 v31, v70, v71
  v_mfma_f32_32x32x16_bf16 v[224:239], v[152:155], v[24:27], 0
  s_nop 0
  v_mfma_f32_32x32x16_bf16 v[224:239], v[156:159], v[28:31], v[224:239]
  v_cvt_pk_bf16_f32 v32, v72, v73
  v_cvt_pk_bf16_f32 v33, v74, v75
  v_cvt_pk_bf16_f32 v34, v76, v77
  v_cvt_pk_bf16_f32 v35, v78, v79
  v_cvt_pk_bf16_f32 v36, v80, v81
  v_cvt_pk_bf16_f32 v37, v82, v83
  v_cvt_pk_bf16_f32 v38, v84, v85
  v_cvt_pk_bf16_f32 v39, v86, v87
  v_mov_b32 v40, 0x3f803f80
  v_mov_b32 v41, 0x3f803f80
  v_mov_b32 v42, 0x3f803f80
  v_mov_b32 v43, 0x3f803f80
  v_mov_b32 v44, 0x3f803f80
  v_mov_b32 v45, 0x3f803f80
  v_mov_b32 v46, 0x3f803f80
  v_mov_b32 v47, 0x3f803f80
  v_permlane16_swap_b32 v32, v40
  v_permlane16_swap_b32 v33, v41
  v_permlane16_swap_b32 v34, v42
  v_permlane16_swap_b32 v35, v43
  v_permlane16_swap_b32 v36, v44
  v_permlane16_swap_b32 v37, v45
  v_permlane16_swap_b32 v38, v46
  v_permlane16_swap_b32 v39, v47
  v_max3_f32 v176, v224, v225, v226
  v_max3_f32 v177, -v224, -v225, -v226
  v_max3_f32 v176, v176, v227, v228
  v_max3_f32 v177, v177, -v227, -v228
  v_max3_f32 v176, v176, v229, v230
  v_max3_f32 v177, v177, -v229, -v230
  v_max_f32 v176, v176, v231
  v_max_f32 v177, v177, -v231
  s_nop 1
  v_permlane32_swap_b32 v176, v177
  v_max_f32 v176, v176, v177
  v_mov_b32 v177, v176
  s_nop 1
  v_permlane32_swap_b32 v176, v177
  v_pk_mul_f32 v[176:177], v[176:177], v[150:151] op_sel:[0,1] op_sel_hi:[1,1]
  v_pk_fma_f32 v[160:161], v[224:225], v[150:151], v[176:177] op_sel:[0,0,0] op_sel_hi:[1,0,0]
  v_pk_fma_f32 v[162:163], v[226:227], v[150:151], v[176:177] op_sel:[0,0,0] op_sel_hi:[1,0,0]
  v_pk_fma_f32 v[164:165], v[228:229], v[150:151], v[176:177] op_sel:[0,0,0] op_sel_hi:[1,0,0]
  v_pk_fma_f32 v[166:167], v[230:231], v[150:151], v[176:177] op_sel:[0,0,0] op_sel_hi:[1,0,0]
  v_pk_fma_f32 v[168:169], v[224:225], v[150:151], v[176:177] op_sel:[0,1,1] op_sel_hi:[1,1,1]
  v_pk_fma_f32 v[170:171], v[226:227], v[150:151], v[176:177] op_sel:[0,1,1] op_sel_hi:[1,1,1]
  v_pk_fma_f32 v[172:173], v[228:229], v[150:151], v[176:177] op_sel:[0,1,1] op_sel_hi:[1,1,1]
  v_pk_fma_f32 v[174:175], v[230:231], v[150:151], v[176:177] op_sel:[0,1,1] op_sel_hi:[1,1,1]
  v_exp_f32 v160, v160
  v_exp_f32 v161, v161
  v_exp_f32 v162, v162
  v_exp_f32 v163, v163
  v_exp_f32 v164, v164
  v_exp_f32 v165, v165
  v_exp_f32 v166, v166
  v_exp_f32 v167, v167
  v_exp_f32 v168, v168
  v_exp_f32 v169, v169
  v_exp_f32 v170, v170
  v_exp_f32 v171, v171
  v_exp_f32 v172, v172
  v_exp_f32 v173, v173
  v_exp_f32 v174, v174
  v_exp_f32 v175, v175
  v_pk_add_f32 v[48:49], v[160:161], v[162:163]
  v_pk_add_f32 v[50:51], v[164:165], v[166:167]
  v_pk_add_f32 v[52:53], v[168:169], v[170:171]
  v_pk_add_f32 v[54:55], v[172:173], v[174:175]
  v_pk_add_f32 v[48:49], v[48:49], v[50:51]
  v_pk_add_f32 v[52:53], v[52:53], v[54:55]
  v_add_f32 v178, v48, v49
  v_add_f32 v179, v52, v53
  s_nop 1
  v_permlane32_swap_b32 v178, v179
  v_add_f32 v178, v178, v179
  v_mov_b32 v179, v178
  s_nop 1
  v_permlane32_swap_b32 v178, v179
  v_rcp_f32 v178, v178
  v_rcp_f32 v179, v179
  s_nop 0
  v_pk_mul_f32 v[160:161], v[160:161], v[178:179] op_sel:[0,0] op_sel_hi:[1,0]
  v_pk_mul_f32 v[162:163], v[162:163], v[178:179] op_sel:[0,0] op_sel_hi:[1,0]
  v_pk_mul_f32 v[164:165], v[164:165], v[178:179] op_sel:[0,0] op_sel_hi:[1,0]
  v_pk_mul_f32 v[166:167], v[166:167], v[178:179] op_sel:[0,0] op_sel_hi:[1,0]
  v_pk_mul_f32 v[168:169], v[168:169], v[178:179] op_sel:[0,1] op_sel_hi:[1,1]
  v_pk_mul_f32 v[170:171], v[170:171], v[178:179] op_sel:[0,1] op_sel_hi:[1,1]
  v_pk_mul_f32 v[172:173], v[172:173], v[178:179] op_sel:[0,1] op_sel_hi:[1,1]
  v_pk_mul_f32 v[174:175], v[174:175], v[178:179] op_sel:[0,1] op_sel_hi:[1,1]
  v_cvt_pk_bf16_f32 v48, v160, v161
  v_cvt_pk_bf16_f32 v49, v162, v163
  v_cvt_pk_bf16_f32 v50, v164, v165
  v_cvt_pk_bf16_f32 v51, v166, v167
  v_cvt_pk_bf16_f32 v52, v168, v169
  v_cvt_pk_bf16_f32 v53, v170, v171
  v_cvt_pk_bf16_f32 v54, v172, v173
  v_cvt_pk_bf16_f32 v55, v174, v175
  ds_write_b64 v180, v[48:49] offset:0
  ds_write_b64 v181, v[50:51] offset:0
  ds_write_b64 v182, v[52:53] offset:0
  ds_write_b64 v183, v[54:55] offset:0
  ds_read_b64_tr_b16 v[132:133], v184 offset:0
  ds_read_b64_tr_b16 v[134:135], v185 offset:512
  ds_read_b64_tr_b16 v[136:137], v184 offset:1024
  ds_read_b64_tr_b16 v[138:139], v185 offset:1536
  v_max3_f32 v176, v232, v233, v234
  v_max3_f32 v177, -v232, -v233, -v234
  v_max3_f32 v176, v176, v235, v236
  v_max3_f32 v177, v177, -v235, -v236
  v_max3_f32 v176, v176, v237, v238
  v_max3_f32 v177, v177, -v237, -v238
  v_max_f32 v176, v176, v239
  v_max_f32 v177, v177, -v239
  s_nop 1
  v_permlane32_swap_b32 v176, v177
  v_max_f32 v176, v176, v177
  v_mov_b32 v177, v176
  s_nop 1
  v_permlane32_swap_b32 v176, v177
  v_pk_mul_f32 v[176:177], v[176:177], v[150:151] op_sel:[0,1] op_sel_hi:[1,1]
  v_pk_fma_f32 v[160:161], v[232:233], v[150:151], v[176:177] op_sel:[0,0,0] op_sel_hi:[1,0,0]
  v_pk_fma_f32 v[162:163], v[234:235], v[150:151], v[176:177] op_sel:[0,0,0] op_sel_hi:[1,0,0]
  v_pk_fma_f32 v[164:165], v[236:237], v[150:151], v[176:177] op_sel:[0,0,0] op_sel_hi:[1,0,0]
  v_pk_fma_f32 v[166:167], v[238:239], v[150:151], v[176:177] op_sel:[0,0,0] op_sel_hi:[1,0,0]
  v_pk_fma_f32 v[168:169], v[232:233], v[150:151], v[176:177] op_sel:[0,1,1] op_sel_hi:[1,1,1]
  v_pk_fma_f32 v[170:171], v[234:235], v[150:151], v[176:177] op_sel:[0,1,1] op_sel_hi:[1,1,1]
  v_pk_fma_f32 v[172:173], v[236:237], v[150:151], v[176:177] op_sel:[0,1,1] op_sel_hi:[1,1,1]
  v_pk_fma_f32 v[174:175], v[238:239], v[150:151], v[176:177] op_sel:[0,1,1] op_sel_hi:[1,1,1]
  v_exp_f32 v160, v160
  v_exp_f32 v161, v161
  v_exp_f32 v162, v162
  v_exp_f32 v163, v163
  v_exp_f32 v164, v164
  v_exp_f32 v165, v165
  v_exp_f32 v166, v166
  v_exp_f32 v167, v167
  v_exp_f32 v168, v168
  v_exp_f32 v169, v169
  v_exp_f32 v170, v170
  v_exp_f32 v171, v171
  v_exp_f32 v172, v172
  v_exp_f32 v173, v173
  v_exp_f32 v174, v174
  v_exp_f32 v175, v175
  v_pk_add_f32 v[48:49], v[160:161], v[162:163]
  v_pk_add_f32 v[50:51], v[164:165], v[166:167]
  v_pk_add_f32 v[52:53], v[168:169], v[170:171]
  v_pk_add_f32 v[54:55], v[172:173], v[174:175]
  v_pk_add_f32 v[48:49], v[48:49], v[50:51]
  v_pk_add_f32 v[52:53], v[52:53], v[54:55]
  v_add_f32 v178, v48, v49
  v_add_f32 v179, v52, v53
  s_nop 1
  v_permlane32_swap_b32 v178, v179
  v_add_f32 v178, v178, v179
  v_mov_b32 v179, v178
  s_nop 1
  v_permlane32_swap_b32 v178, v179
  v_rcp_f32 v178, v178
  v_rcp_f32 v179, v179
  s_nop 0
  v_pk_mul_f32 v[160:161], v[160:161], v[178:179] op_sel:[0,0] op_sel_hi:[1,0]
  v_pk_mul_f32 v[162:163], v[162:163], v[178:179] op_sel:[0,0] op_sel_hi:[1,0]
  v_pk_mul_f32 v[164:165], v[164:165], v[178:179] op_sel:[0,0] op_sel_hi:[1,0]
  v_pk_mul_f32 v[166:167], v[166:167], v[178:179] op_sel:[0,0] op_sel_hi:[1,0]
  v_pk_mul_f32 v[168:169], v[168:169], v[178:179] op_sel:[0,1] op_sel_hi:[1,1]
  v_pk_mul_f32 v[170:171], v[170:171], v[178:179] op_sel:[0,1] op_sel_hi:[1,1]
  v_pk_mul_f32 v[172:173], v[172:173], v[178:179] op_sel:[0,1] op_sel_hi:[1,1]
  v_pk_mul_f32 v[174:175], v[174:175], v[178:179] op_sel:[0,1] op_sel_hi:[1,1]
  v_cvt_pk_bf16_f32 v48, v160, v161
  v_cvt_pk_bf16_f32 v49, v162, v163
  v_cvt_pk_bf16_f32 v50, v164, v165
  v_cvt_pk_bf16_f32 v51, v166, v167
  v_cvt_pk_bf16_f32 v52, v168, v169
  v_cvt_pk_bf16_f32 v53, v170, v171
  v_cvt_pk_bf16_f32 v54, v172, v173
  v_cvt_pk_bf16_f32 v55, v174, v175
  ds_write_b64 v180, v[48:49] offset:2048
  ds_write_b64 v181, v[50:51] offset:2048
  ds_write_b64 v182, v[52:53] offset:2048
  ds_write_b64 v183, v[54:55] offset:2048
  s_waitcnt lgkmcnt(4)
  v_mfma_f32_32x32x16_bf16 v[192:207], v[132:135], v[32:35], 0
  v_mfma_f32_32x32x16_bf16 v[192:207], v[136:139], v[36:39], v[192:207]
  ds_read_b64_tr_b16 v[160:161], v184 offset:2048
  ds_read_b64_tr_b16 v[162:163], v185 offset:2560
  ds_read_b64_tr_b16 v[164:165], v184 offset:3072
  ds_read_b64_tr_b16 v[166:167], v185 offset:3584
  s_waitcnt lgkmcnt(0)
  v_mfma_f32_32x32x16_bf16 v[208:223], v[160:163], v[40:43], 0
  v_mfma_f32_32x32x16_bf16 v[208:223], v[164:167], v[44:47], v[208:223]
  v_cvt_pk_bf16_f32 v24, v88, v89
  v_cvt_pk_bf16_f32 v25, v90, v91
  v_cvt_pk_bf16_f32 v26, v92, v93
  v_cvt_pk_bf16_f32 v27, v94, v95
  v_cvt_pk_bf16_f32 v28, v96, v97
  v_cvt_pk_bf16_f32 v29, v98, v99
  v_cvt_pk_bf16_f32 v30, v100, v101
  v_cvt_pk_bf16_f32 v31, v102, v103
  v_mfma_f32_32x32x16_bf16 v[224:239], v[152:155], v[24:27], 0
  s_nop 0
  v_mfma_f32_32x32x16_bf16 v[224:239], v[156:159], v[28:31], v[224:239]
  v_cvt_pk_bf16_f32 v32, v104, v105
  v_cvt_pk_bf16_f32 v33, v106, v107
  v_cvt_pk_bf16_f32 v34, v108, v109
  v_cvt_pk_bf16_f32 v35, v110, v111
  v_cvt_pk_bf16_f32 v36, v112, v113
  v_cvt_pk_bf16_f32 v37, v114, v115
  v_cvt_pk_bf16_f32 v38, v116, v117
  v_cvt_pk_bf16_f32 v39, v118, v119
  v_mov_b32 v40, 0x3f803f80
  v_mov_b32 v41, 0x3f803f80
  v_mov_b32 v42, 0x3f803f80
  v_mov_b32 v43, 0x3f803f80
  v_mov_b32 v44, 0x3f803f80
  v_mov_b32 v45, 0x3f803f80
  v_mov_b32 v46, 0x3f803f80
  v_mov_b32 v47, 0x3f803f80
  v_permlane16_swap_b32 v32, v40
  v_permlane16_swap_b32 v33, v41
  v_permlane16_swap_b32 v34, v42
  v_permlane16_swap_b32 v35, v43
  v_permlane16_swap_b32 v36, v44
  v_permlane16_swap_b32 v37, v45
  v_permlane16_swap_b32 v38, v46
  v_permlane16_swap_b32 v39, v47
  v_max3_f32 v176, v224, v225, v226
  v_max3_f32 v177, -v224, -v225, -v226
  v_max3_f32 v176, v176, v227, v228
  v_max3_f32 v177, v177, -v227, -v228
  v_max3_f32 v176, v176, v229, v230
  v_max3_f32 v177, v177, -v229, -v230
  v_max_f32 v176, v176, v231
  v_max_f32 v177, v177, -v231
  s_nop 1
  v_permlane32_swap_b32 v176, v177
  v_max_f32 v176, v176, v177
  v_mov_b32 v177, v176
  s_nop 1
  v_permlane32_swap_b32 v176, v177
  v_pk_mul_f32 v[176:177], v[176:177], v[150:151] op_sel:[0,1] op_sel_hi:[1,1]
  v_pk_fma_f32 v[160:161], v[224:225], v[150:151], v[176:177] op_sel:[0,0,0] op_sel_hi:[1,0,0]
  v_pk_fma_f32 v[162:163], v[226:227], v[150:151], v[176:177] op_sel:[0,0,0] op_sel_hi:[1,0,0]
  v_pk_fma_f32 v[164:165], v[228:229], v[150:151], v[176:177] op_sel:[0,0,0] op_sel_hi:[1,0,0]
  v_pk_fma_f32 v[166:167], v[230:231], v[150:151], v[176:177] op_sel:[0,0,0] op_sel_hi:[1,0,0]
  v_pk_fma_f32 v[168:169], v[224:225], v[150:151], v[176:177] op_sel:[0,1,1] op_sel_hi:[1,1,1]
  v_pk_fma_f32 v[170:171], v[226:227], v[150:151], v[176:177] op_sel:[0,1,1] op_sel_hi:[1,1,1]
  v_pk_fma_f32 v[172:173], v[228:229], v[150:151], v[176:177] op_sel:[0,1,1] op_sel_hi:[1,1,1]
  v_pk_fma_f32 v[174:175], v[230:231], v[150:151], v[176:177] op_sel:[0,1,1] op_sel_hi:[1,1,1]
  v_exp_f32 v160, v160
  v_exp_f32 v161, v161
  v_exp_f32 v162, v162
  v_exp_f32 v163, v163
  v_exp_f32 v164, v164
  v_exp_f32 v165, v165
  v_exp_f32 v166, v166
  v_exp_f32 v167, v167
  v_exp_f32 v168, v168
  v_exp_f32 v169, v169
  v_exp_f32 v170, v170
  v_exp_f32 v171, v171
  v_exp_f32 v172, v172
  v_exp_f32 v173, v173
  v_exp_f32 v174, v174
  v_exp_f32 v175, v175
  v_pk_add_f32 v[48:49], v[160:161], v[162:163]
  v_pk_add_f32 v[50:51], v[164:165], v[166:167]
  v_pk_add_f32 v[52:53], v[168:169], v[170:171]
  v_pk_add_f32 v[54:55], v[172:173], v[174:175]
  v_pk_add_f32 v[48:49], v[48:49], v[50:51]
  v_pk_add_f32 v[52:53], v[52:53], v[54:55]
  v_add_f32 v178, v48, v49
  v_add_f32 v179, v52, v53
  s_nop 1
  v_permlane32_swap_b32 v178, v179
  v_add_f32 v178, v178, v179
  v_mov_b32 v179, v178
  s_nop 1
  v_permlane32_swap_b32 v178, v179
  v_rcp_f32 v178, v178
  v_rcp_f32 v179, v179
  s_nop 0
  v_pk_mul_f32 v[160:161], v[160:161], v[178:179] op_sel:[0,0] op_sel_hi:[1,0]
  v_pk_mul_f32 v[162:163], v[162:163], v[178:179] op_sel:[0,0] op_sel_hi:[1,0]
  v_pk_mul_f32 v[164:165], v[164:165], v[178:179] op_sel:[0,0] op_sel_hi:[1,0]
  v_pk_mul_f32 v[166:167], v[166:167], v[178:179] op_sel:[0,0] op_sel_hi:[1,0]
  v_pk_mul_f32 v[168:169], v[168:169], v[178:179] op_sel:[0,1] op_sel_hi:[1,1]
  v_pk_mul_f32 v[170:171], v[170:171], v[178:179] op_sel:[0,1] op_sel_hi:[1,1]
  v_pk_mul_f32 v[172:173], v[172:173], v[178:179] op_sel:[0,1] op_sel_hi:[1,1]
  v_pk_mul_f32 v[174:175], v[174:175], v[178:179] op_sel:[0,1] op_sel_hi:[1,1]
  v_cvt_pk_bf16_f32 v48, v160, v161
  v_cvt_pk_bf16_f32 v49, v162, v163
  v_cvt_pk_bf16_f32 v50, v164, v165
  v_cvt_pk_bf16_f32 v51, v166, v167
  v_cvt_pk_bf16_f32 v52, v168, v169
  v_cvt_pk_bf16_f32 v53, v170, v171
  v_cvt_pk_bf16_f32 v54, v172, v173
  v_cvt_pk_bf16_f32 v55, v174, v175
  ds_write_b64 v180, v[48:49] offset:0
  ds_write_b64 v181, v[50:51] offset:0
  ds_write_b64 v182, v[52:53] offset:0
  ds_write_b64 v183, v[54:55] offset:0
  ds_read_b64_tr_b16 v[132:133], v184 offset:0
  ds_read_b64_tr_b16 v[134:135], v185 offset:512
  ds_read_b64_tr_b16 v[136:137], v184 offset:1024
  ds_read_b64_tr_b16 v[138:139], v185 offset:1536
  v_max3_f32 v176, v232, v233, v234
  v_max3_f32 v177, -v232, -v233, -v234
  v_max3_f32 v176, v176, v235, v236
  v_max3_f32 v177, v177, -v235, -v236
  v_max3_f32 v176, v176, v237, v238
  v_max3_f32 v177, v177, -v237, -v238
  v_max_f32 v176, v176, v239
  v_max_f32 v177, v177, -v239
  s_nop 1
  v_permlane32_swap_b32 v176, v177
  v_max_f32 v176, v176, v177
  v_mov_b32 v177, v176
  s_nop 1
  v_permlane32_swap_b32 v176, v177
  v_pk_mul_f32 v[176:177], v[176:177], v[150:151] op_sel:[0,1] op_sel_hi:[1,1]
  v_pk_fma_f32 v[160:161], v[232:233], v[150:151], v[176:177] op_sel:[0,0,0] op_sel_hi:[1,0,0]
  v_pk_fma_f32 v[162:163], v[234:235], v[150:151], v[176:177] op_sel:[0,0,0] op_sel_hi:[1,0,0]
  v_pk_fma_f32 v[164:165], v[236:237], v[150:151], v[176:177] op_sel:[0,0,0] op_sel_hi:[1,0,0]
  v_pk_fma_f32 v[166:167], v[238:239], v[150:151], v[176:177] op_sel:[0,0,0] op_sel_hi:[1,0,0]
  v_pk_fma_f32 v[168:169], v[232:233], v[150:151], v[176:177] op_sel:[0,1,1] op_sel_hi:[1,1,1]
  v_pk_fma_f32 v[170:171], v[234:235], v[150:151], v[176:177] op_sel:[0,1,1] op_sel_hi:[1,1,1]
  v_pk_fma_f32 v[172:173], v[236:237], v[150:151], v[176:177] op_sel:[0,1,1] op_sel_hi:[1,1,1]
  v_pk_fma_f32 v[174:175], v[238:239], v[150:151], v[176:177] op_sel:[0,1,1] op_sel_hi:[1,1,1]
  v_exp_f32 v160, v160
  v_exp_f32 v161, v161
  v_exp_f32 v162, v162
  v_exp_f32 v163, v163
  v_exp_f32 v164, v164
  v_exp_f32 v165, v165
  v_exp_f32 v166, v166
  v_exp_f32 v167, v167
  v_exp_f32 v168, v168
  v_exp_f32 v169, v169
  v_exp_f32 v170, v170
  v_exp_f32 v171, v171
  v_exp_f32 v172, v172
  v_exp_f32 v173, v173
  v_exp_f32 v174, v174
  v_exp_f32 v175, v175
  v_pk_add_f32 v[48:49], v[160:161], v[162:163]
  v_pk_add_f32 v[50:51], v[164:165], v[166:167]
  v_pk_add_f32 v[52:53], v[168:169], v[170:171]
  v_pk_add_f32 v[54:55], v[172:173], v[174:175]
  v_pk_add_f32 v[48:49], v[48:49], v[50:51]
  v_pk_add_f32 v[52:53], v[52:53], v[54:55]
  v_add_f32 v178, v48, v49
  v_add_f32 v179, v52, v53
  s_nop 1
  v_permlane32_swap_b32 v178, v179
  v_add_f32 v178, v178, v179
  v_mov_b32 v179, v178
  s_nop 1
  v_permlane32_swap_b32 v178, v179
  v_rcp_f32 v178, v178
  v_rcp_f32 v179, v179
  s_nop 0
  v_pk_mul_f32 v[160:161], v[160:161], v[178:179] op_sel:[0,0] op_sel_hi:[1,0]
  v_pk_mul_f32 v[162:163], v[162:163], v[178:179] op_sel:[0,0] op_sel_hi:[1,0]
  v_pk_mul_f32 v[164:165], v[164:165], v[178:179] op_sel:[0,0] op_sel_hi:[1,0]
  v_pk_mul_f32 v[166:167], v[166:167], v[178:179] op_sel:[0,0] op_sel_hi:[1,0]
  v_pk_mul_f32 v[168:169], v[168:169], v[178:179] op_sel:[0,1] op_sel_hi:[1,1]
  v_pk_mul_f32 v[170:171], v[170:171], v[178:179] op_sel:[0,1] op_sel_hi:[1,1]
  v_pk_mul_f32 v[172:173], v[172:173], v[178:179] op_sel:[0,1] op_sel_hi:[1,1]
  v_pk_mul_f32 v[174:175], v[174:175], v[178:179] op_sel:[0,1] op_sel_hi:[1,1]
  v_cvt_pk_bf16_f32 v48, v160, v161
  v_cvt_pk_bf16_f32 v49, v162, v163
  v_cvt_pk_bf16_f32 v50, v164, v165
  v_cvt_pk_bf16_f32 v51, v166, v167
  v_cvt_pk_bf16_f32 v52, v168, v169
  v_cvt_pk_bf16_f32 v53, v170, v171
  v_cvt_pk_bf16_f32 v54, v172, v173
  v_cvt_pk_bf16_f32 v55, v174, v175
  ds_write_b64 v180, v[48:49] offset:2048
  ds_write_b64 v181, v[50:51] offset:2048
  ds_write_b64 v182, v[52:53] offset:2048
  ds_write_b64 v183, v[54:55] offset:2048
  s_waitcnt lgkmcnt(4)
  v_mfma_f32_32x32x16_bf16 v[192:207], v[132:135], v[32:35], v[192:207]
  v_mfma_f32_32x32x16_bf16 v[192:207], v[136:139], v[36:39], v[192:207]
  ds_read_b64_tr_b16 v[160:161], v184 offset:2048
  ds_read_b64_tr_b16 v[162:163], v185 offset:2560
  ds_read_b64_tr_b16 v[164:165], v184 offset:3072
  ds_read_b64_tr_b16 v[166:167], v185 offset:3584
  s_waitcnt lgkmcnt(0)
  v_mfma_f32_32x32x16_bf16 v[208:223], v[160:163], v[40:43], v[208:223]
  v_mfma_f32_32x32x16_bf16 v[208:223], v[164:167], v[44:47], v[208:223]
  s_cmp_eq_u32 s56, 0
  s_nop 10
  s_cbranch_scc1 L_kvx7
  ds_write_b128 v187, v[192:195] offset:0
  ds_write_b128 v187, v[196:199] offset:1024
  ds_write_b128 v187, v[200:203] offset:2048
  ds_write_b128 v187, v[204:207] offset:3072
  v_mov_b32 v192, v208
  v_mov_b32 v193, v209
  v_mov_b32 v194, v210
  v_mov_b32 v195, v211
  v_mov_b32 v196, v212
  v_mov_b32 v197, v213
  v_mov_b32 v198, v214
  v_mov_b32 v199, v215
  v_mov_b32 v200, v216
  v_mov_b32 v201, v217
  v_mov_b32 v202, v218
  v_mov_b32 v203, v219
  v_mov_b32 v204, v220
  v_mov_b32 v205, v221
  v_mov_b32 v206, v222
  v_mov_b32 v207, v223
  s_nop 1
  s_branch L_kvx7b
L_kvx7:
  ds_write_b128 v187, v[208:211] offset:0
  ds_write_b128 v187, v[212:215] offset:1024
  ds_write_b128 v187, v[216:219] offset:2048
  ds_write_b128 v187, v[220:223] offset:3072
L_kvx7b:
  s_waitcnt lgkmcnt(0)
  s_lshl_b32 s72, s35, 2
  s_add_u32 s73, s72, 152608
  v_mov_b32 v244, s73
  v_mov_b32 v245, 1
  s_mov_b64 exec, 1
  ds_write_b32 v244, v245
  s_mov_b64 exec, -1
  s_xor_b32 s72, s72, 8
  s_add_u32 s73, s72, 152608
  v_mov_b32 v244, s73
  s_mov_b32 s78, 0x100000
  s_nop 0
L_spin8:
  ds_read_b32 v245, v244
  s_waitcnt lgkmcnt(0)
  v_readfirstlane_b32 s79, v245
  s_nop 3
  s_cmp_eq_u32 s79, 1
  s_cbranch_scc1 L_spin8_ok
  s_sub_u32 s78, s78, 1
  s_cmp_lg_u32 s78, 0
  s_cbranch_scc1 L_spin8
L_spin8_ok:
  ds_read_b128 v[224:227], v188 offset:0
  ds_read_b128 v[228:231], v188 offset:1024
  ds_read_b128 v[232:235], v188 offset:2048
  ds_read_b128 v[236:239], v188 offset:3072
  s_waitcnt lgkmcnt(0)
  v_pk_add_f32 v[192:193], v[192:193], v[224:225]
  v_pk_add_f32 v[194:195], v[194:195], v[226:227]
  v_pk_add_f32 v[196:197], v[196:197], v[228:229]
  v_pk_add_f32 v[198:199], v[198:199], v[230:231]
  v_pk_add_f32 v[200:201], v[200:201], v[232:233]
  v_pk_add_f32 v[202:203], v[202:203], v[234:235]
  v_pk_add_f32 v[204:205], v[204:205], v[236:237]
  v_pk_add_f32 v[206:207], v[206:207], v[238:239]
  v_cvt_pk_bf16_f32 v32, v192, v193
  v_cvt_pk_bf16_f32 v33, v194, v195
  v_cvt_pk_bf16_f32 v34, v196, v197
  v_cvt_pk_bf16_f32 v35, v198, v199
  v_cvt_pk_bf16_f32 v36, v200, v201
  v_cvt_pk_bf16_f32 v37, v202, v203
  v_cvt_pk_bf16_f32 v38, v204, v205
  v_cvt_pk_bf16_f32 v39, v206, v207
  v_lshlrev_b32 v240, 4, v0
  buffer_store_dwordx4 v[32:35], v240, s[48:51], s63 offen sc1
  buffer_store_dwordx4 v[36:39], v240, s[48:51], s63 offen offset:1024 sc1
  s_nop 1
  s_branch L_c1_done
L_c1_qw:
  s_mov_b32 s60, 0
  s_mov_b32 s3, 0
  v_lshlrev_b32 v185, 4, v0
  s_mov_b32 s52, s8
  s_mov_b32 s53, s9
  s_mov_b32 s54, 0x200000
  s_mov_b32 s55, 0x20000
  s_sub_u32 s72, s39, 8
  s_lshl_b32 s72, s72, 2
  s_add_u32 s72, s72, s35
  s_lshl_b32 s72, s72, 2
  s_lshl_b32 s73, s38, 7
  s_add_u32 s68, s72, s73
  s_lshl_b32 s72, s68, 10
  buffer_load_dwordx4 v[152:155], v185, s[52:55], s72 offen offset:0
  buffer_load_dwordx4 v[156:159], v185, s[52:55], s72 offen offset:1024
  buffer_load_dwordx4 v[160:163], v185, s[52:55], s72 offen offset:2048
  buffer_load_dwordx4 v[164:167], v185, s[52:55], s72 offen offset:3072
  s_mov_b32 s52, s26
  s_mov_b32 s53, s27
  s_mov_b32 s54, 0x400
  s_mov_b32 s55, 0x20000
  buffer_load_dwordx4 v[168:171], v185, s[52:55], 0 offen
  v_mov_b32 v184, 0x3f803f80
  v_mov_b32 v172, 0
  v_mov_b32 v173, 0
  v_mov_b32 v174, 0
  v_mov_b32 v175, 0
  v_mov_b32 v176, 0
  v_mov_b32 v177, 0
  v_mov_b32 v178, 0
  v_mov_b32 v179, 0
  v_mov_b32 v180, 0
  v_mov_b32 v181, 0
  v_mov_b32 v182, 0
  v_mov_b32 v183, 0
  v_mov_b32 v188, s38
  v_add_u32 v189, 8, v0
  v_and_b32 v190, 3, v189
  v_lshlrev_b32 v190, 3, v190
  v_and_b32 v191, 7, v188
  v_add_u32 v190, v190, v191
  v_lshlrev_b32 v190, 3, v190
  v_lshrrev_b32 v191, 2, v189
  v_lshlrev_b32 v191, 1, v191
  v_add_u32 v190, v190, v191
  v_lshrrev_b32 v191, 3, v188
  v_add_u32 v190, v190, v191
  s_sub_u32 s72, s39, 8
  v_mov_b32 v188, s72
  v_lshlrev_b32 v186, 7, v190
  v_lshlrev_b32 v188, 2, v188
  v_add_u32 v186, v186, v188
  v_add_u32 v186, 0x1230000, v186
  v_lshrrev_b32 v192, 5, v0
  v_bfe_u32 v193, v0, 1, 3
  v_xor_b32 v192, v192, v193
  v_lshlrev_b32 v192, 4, v192
  v_and_b32 v193, 31, v0
  v_lshlrev_b32 v193, 7, v193
  s_lshl_b32 s72, s56, 13
  v_add_u32 v193, s72, v193
  s_lshl_b32 s72, s3, 12
  s_xor_b32 s73, s72, 4096
  v_xor_b32 v194, 0, v192
  v_add_u32 v194, v193, v194
  v_add_u32 v14, s72, v194
  v_add_u32 v18, s73, v194
  v_xor_b32 v194, 32, v192
  v_add_u32 v194, v193, v194
  v_add_u32 v15, s72, v194
  v_add_u32 v19, s73, v194
  v_xor_b32 v194, 64, v192
  v_add_u32 v194, v193, v194
  v_add_u32 v16, s72, v194
  v_add_u32 v20, s73, v194
  v_xor_b32 v194, 96, v192
  v_add_u32 v194, v193, v194
  v_add_u32 v17, s72, v194
  v_add_u32 v21, s73, v194
  v_lshrrev_b32 v195, 5, v0
  v_lshlrev_b32 v195, 3, v195
  v_bfe_u32 v196, v0, 2, 2
  v_add_u32 v195, v195, v196
  v_lshlrev_b32 v195, 7, v195
  v_and_b32 v196, 1, v0
  v_lshlrev_b32 v196, 3, v196
  v_add_u32 v195, v195, v196
  v_bfe_u32 v196, v0, 4, 1
  v_lshlrev_b32 v196, 1, v196
  v_bfe_u32 v197, v0, 1, 1
  v_add_u32 v196, v196, v197
  s_lshl_b32 s72, s57, 2
  v_add_u32 v196, s72, v196
  v_bfe_u32 v197, v0, 3, 1
  v_lshlrev_b32 v197, 2, v197
  v_xor_b32 v196, v196, v197
  v_lshlrev_b32 v196, 4, v196
  v_add_u32 v192, v195, v196
  v_add_u32 v192, 0x10000, v192
  s_lshl_b32 s72, s60, 13
  s_xor_b32 s73, s72, 8192
  v_add_u32 v22, s72, v192
  v_add_u32 v23, s73, v192
  v_and_b32 v192, 15, v0
  v_bfe_u32 v193, v0, 4, 1
  v_cmp_eq_u32 vcc, v192, v193
  v_mov_b32 v194, 0x3f803f80
  s_nop 0
  v_cndmask_b32 v124, 0, v194, vcc
  v_mov_b32 v125, v124
  v_mov_b32 v126, v124
  v_mov_b32 v127, v124
  s_lshl_b32 s72, s35, 12
  s_add_u32 s72, s72, 131072
  v_and_b32 v192, 31, v0
  v_lshlrev_b32 v192, 6, v192
  v_lshrrev_b32 v193, 5, v0
  v_lshlrev_b32 v193, 3, v193
  v_add_u32 v192, v192, v193
  v_add_u32 v192, s72, v192
  v_bfe_u32 v193, v0, 1, 2
  v_lshlrev_b32 v193, 4, v193
  v_add_u32 v192, v192, v193
  v_xor_b32 v142, 0, v192
  v_xor_b32 v143, 16, v192
  v_xor_b32 v144, 32, v192
  v_xor_b32 v145, 48, v192
  v_lshrrev_b32 v192, 2, v0
  v_lshlrev_b32 v192, 6, v192
  v_bfe_u32 v193, v0, 3, 2
  v_and_b32 v146, 3, v0
  v_xor_b32 v193, v193, v146
  v_lshlrev_b32 v193, 4, v193
  v_add_u32 v192, v192, v193
  v_add_u32 v146, s72, v192
  v_lshrrev_b32 v192, 1, v0
  v_lshlrev_b32 v192, 6, v192
  v_bfe_u32 v193, v0, 2, 2
  v_and_b32 v147, 1, v0
  v_xor_b32 v193, v193, v147
  v_lshlrev_b32 v193, 4, v193
  v_add_u32 v192, v192, v193
  v_add_u32 v147, s72, v192
  v_xor_b32 v148, 32, v147
  s_waitcnt lgkmcnt(0)
  s_mul_i32 s34, s34, 0x9e3779b1
  s_add_u32 s34, s34, 0x7f4a7c15
  s_waitcnt vmcnt(0)
  v_dot2_f32_bf16 v172, v152, v184, v172
  v_dot2_f32_bf16 v176, v152, v152, v176
  v_dot2_f32_bf16 v180, v152, v168, v180
  v_dot2_f32_bf16 v172, v153, v184, v172
  v_dot2_f32_bf16 v176, v153, v153, v176
  v_dot2_f32_bf16 v180, v153, v169, v180
  v_dot2_f32_bf16 v172, v154, v184, v172
  v_dot2_f32_bf16 v176, v154, v154, v176
  v_dot2_f32_bf16 v180, v154, v170, v180
  v_dot2_f32_bf16 v172, v155, v184, v172
  v_dot2_f32_bf16 v176, v155, v155, v176
  v_dot2_f32_bf16 v180, v155, v171, v180
  v_dot2_f32_bf16 v173, v156, v184, v173
  v_dot2_f32_bf16 v177, v156, v156, v177
  v_dot2_f32_bf16 v181, v156, v168, v181
  v_dot2_f32_bf16 v173, v157, v184, v173
  v_dot2_f32_bf16 v177, v157, v157, v177
  v_dot2_f32_bf16 v181, v157, v169, v181
  v_dot2_f32_bf16 v173, v158, v184, v173
  v_dot2_f32_bf16 v177, v158, v158, v177
  v_dot2_f32_bf16 v181, v158, v170, v181
  v_dot2_f32_bf16 v173, v159, v184, v173
  v_dot2_f32_bf16 v177, v159, v159, v177
  v_dot2_f32_bf16 v181, v159, v171, v181
  v_dot2_f32_bf16 v174, v160, v184, v174
  v_dot2_f32_bf16 v178, v160, v160, v178
  v_dot2_f32_bf16 v182, v160, v168, v182
  v_dot2_f32_bf16 v174, v161, v184, v174
  v_dot2_f32_bf16 v178, v161, v161, v178
  v_dot2_f32_bf16 v182, v161, v169, v182
  v_dot2_f32_bf16 v174, v162, v184, v174
  v_dot2_f32_bf16 v178, v162, v162, v178
  v_dot2_f32_bf16 v182, v162, v170, v182
  v_dot2_f32_bf16 v174, v163, v184, v174
  v_dot2_f32_bf16 v178, v163, v163, v178
  v_dot2_f32_bf16 v182, v163, v171, v182
  v_dot2_f32_bf16 v175, v164, v184, v175
  v_dot2_f32_bf16 v179, v164, v164, v179
  v_dot2_f32_bf16 v183, v164, v168, v183
  v_dot2_f32_bf16 v175, v165, v184, v175
  v_dot2_f32_bf16 v179, v165, v165, v179
  v_dot2_f32_bf16 v183, v165, v169, v183
  v_dot2_f32_bf16 v175, v166, v184, v175
  v_dot2_f32_bf16 v179, v166, v166, v179
  v_dot2_f32_bf16 v183, v166, v170, v183
  v_dot2_f32_bf16 v175, v167, v184, v175
  v_dot2_f32_bf16 v179, v167, v167, v179
  v_dot2_f32_bf16 v183, v167, v171, v183
  v_permlane32_swap_b32 v172, v174
  v_permlane32_swap_b32 v173, v175
  v_permlane32_swap_b32 v176, v178
  v_permlane32_swap_b32 v177, v179
  v_permlane32_swap_b32 v180, v182
  v_permlane32_swap_b32 v181, v183
  v_add_f32 v172, v172, v174
  v_add_f32 v173, v173, v175
  v_add_f32 v176, v176, v178
  v_add_f32 v177, v177, v179
  v_add_f32 v180, v180, v182
  v_add_f32 v181, v181, v183
  v_permlane16_swap_b32 v172, v173
  v_permlane16_swap_b32 v176, v177
  v_permlane16_swap_b32 v180, v181
  v_add_f32 v172, v172, v173
  v_add_f32 v176, v176, v177
  v_add_f32 v180, v180, v181
  v_add_f32_dpp v172, v172, v172 quad_perm:[1,0,3,2] row_mask:0xf bank_mask:0xf
  v_add_f32_dpp v176, v176, v176 quad_perm:[1,0,3,2] row_mask:0xf bank_mask:0xf
  v_add_f32_dpp v180, v180, v180 quad_perm:[1,0,3,2] row_mask:0xf bank_mask:0xf
  v_add_f32_dpp v172, v172, v172 quad_perm:[2,3,0,1] row_mask:0xf bank_mask:0xf
  v_add_f32_dpp v176, v176, v176 quad_perm:[2,3,0,1] row_mask:0xf bank_mask:0xf
  v_add_f32_dpp v180, v180, v180 quad_perm:[2,3,0,1] row_mask:0xf bank_mask:0xf
  v_add_f32_dpp v172, v172, v172 row_half_mirror row_mask:0xf bank_mask:0xf
  v_add_f32_dpp v176, v176, v176 row_half_mirror row_mask:0xf bank_mask:0xf
  v_add_f32_dpp v180, v180, v180 row_half_mirror row_mask:0xf bank_mask:0xf
  v_add_f32_dpp v172, v172, v172 row_mirror row_mask:0xf bank_mask:0xf
  v_add_f32_dpp v176, v176, v176 row_mirror row_mask:0xf bank_mask:0xf
  v_add_f32_dpp v180, v180, v180 row_mirror row_mask:0xf bank_mask:0xf
  v_mul_f32 v180, 0xbfb8aa3b, v180
  v_exp_f32 v180, v180
  s_nop 0
  v_add_f32 v180, 1.0, v180
  v_rcp_f32 v180, v180
  v_mov_b32 v188, v172
  v_mov_b32 v189, v176
  v_lshrrev_b32 v152, 4, v0
  v_lshlrev_b32 v153, 3, v152
  v_lshlrev_b32 v152, 2, v152
  s_lshl_b32 s72, s68, 3
  s_add_u32 s72, s72, 0x1204000
  s_lshl_b32 s73, s68, 2
  s_add_u32 s73, s73, 0x1200000
  s_mov_b32 exec_lo, 0x00010001
  s_mov_b32 exec_hi, 0x00010001
  buffer_store_dwordx2 v[188:189], v153, s[48:51], s72 offen sc1
  buffer_store_dword v180, v152, s[48:51], s73 offen sc1
  s_mov_b64 exec, -1
  v_mov_b32 v192, v186
  s_lshl_b32 s72, s38, 1
  s_sub_u32 s72, s72, 1
  v_bfe_u32 v195, v0, 3, 2
  v_add_u32 v195, s72, v195
  v_and_b32 v196, 7, v0
  v_lshlrev_b32 v193, 2, v196
  v_and_b32 v194, 3, v195
  v_or_b32 v193, v193, v194
  v_lshlrev_b32 v193, 3, v193
  v_lshrrev_b32 v194, 2, v195
  v_add_u32 v193, v193, v194
  v_lshrrev_b32 v196, 1, v195
  s_sub_u32 s72, s39, 8
  s_add_u32 s73, s72, 8
  v_mov_b32 v194, s73
  v_mov_b32 v197, s72
  v_cmp_eq_u32 vcc, s38, v196
  s_nop 1
  v_cndmask_b32 v194, v194, v197, vcc
  v_cmp_gt_u32 vcc, 32, v195
  s_nop 3
  s_and_b32 s70, vcc_lo, -1
  s_mov_b32 s71, 0xf
  v_lshlrev_b32 v12, 7, v193
  v_lshlrev_b32 v194, 2, v194
  v_add_u32 v12, v12, v194
  v_add_u32 v12, 0x1210000, v12
  s_lshl_b32 s72, s72, 2
  v_and_b32 v195, 3, v0
  v_add_u32 v195, s72, v195
  s_lshr_b32 s72, s38, 1
  v_mov_b32 v196, s72
  v_lshlrev_b32 v193, 2, v196
  v_and_b32 v194, 3, v195
  v_or_b32 v193, v193, v194
  v_lshlrev_b32 v193, 3, v193
  v_lshrrev_b32 v194, 2, v195
  v_add_u32 v193, v193, v194
  s_and_b32 s72, s38, 1
  s_add_u32 s72, s72, 16
  v_mov_b32 v194, s72
  v_lshlrev_b32 v196, 7, v193
  v_lshlrev_b32 v194, 2, v194
  v_add_u32 v196, v196, v194
  v_add_u32 v196, 0x1228000, v196
  v_cmp_lt_u32 vcc, 31, v0
  s_nop 1
  v_cndmask_b32 v12, v12, v196, vcc
  s_mov_b32 s65, s70
  s_mov_b32 s66, s71
  v_lshrrev_b32 v199, 2, v0
  v_mul_u32_u24 v199, 1024, v199
  v_and_b32 v193, 3, v0
  v_lshlrev_b32 v193, 4, v193
  v_add_u32 v193, v193, v199
  v_lshlrev_b32 v194, 4, v0
  s_lshl_b32 s74, s35, 7
  s_add_u32 s74, s74, 152064
  v_and_b32 v195, 1, v0
  v_lshlrev_b32 v195, 6, v195
  v_lshrrev_b32 v196, 4, v0
  v_lshlrev_b32 v196, 4, v196
  v_add_u32 v195, v195, v196
  v_add_u32 v195, s74, v195
  v_lshrrev_b32 v197, 5, v0
  v_lshlrev_b32 v197, 4, v197
  v_add_u32 v197, s74, v197
  v_and_b32 v198, 31, v0
  v_lshlrev_b32 v198, 3, v198
  s_lshl_b32 s72, s56, 9
  s_add_u32 s72, s72, 150528
  v_add_u32 v198, s72, v198
  s_lshl_b32 s64, s38, 1
  s_add_u32 s64, s64, s56
  s_lshl_b32 s64, s64, 6
  s_lshl_b32 s63, s64, 10
  s_sub_u32 s72, s39, 8
  s_lshl_b32 s73, s72, 7
  s_add_u32 s63, s63, s73
  s_lshl_b32 s73, s57, 6
  s_add_u32 s63, s63, s73
  s_lshl_b32 s64, s64, 5
  s_lshl_b32 s72, s72, 2
  s_lshl_b32 s73, s57, 1
  s_add_u32 s72, s72, s73
  s_lshl_b32 s72, s72, 16
  s_add_u32 s64, s64, s72
  s_add_u32 s64, s64, 0x200000
  s_barrier
  ds_read_b64_tr_b16 v[40:41], v22 offset:0
  ds_read_b64_tr_b16 v[42:43], v22 offset:512
  ds_read_b128 v[24:27], v14 offset:0
  ds_read_b64_tr_b16 v[44:45], v23 offset:0
  ds_read_b64_tr_b16 v[46:47], v23 offset:512
  ds_read_b128 v[28:31], v18 offset:0
  s_waitcnt lgkmcnt(3)
  v_mfma_f32_32x32x16_bf16 v[56:71], v[40:43], v[24:27], 0
  ds_read_b64_tr_b16 v[48:49], v22 offset:2048
  ds_read_b64_tr_b16 v[50:51], v22 offset:2560
  s_waitcnt lgkmcnt(3)
  v_mfma_f32_32x32x16_bf16 v[72:87], v[44:47], v[24:27], 0
  ds_read_b128 v[32:35], v15 offset:0
  ds_read_b64_tr_b16 v[52:53], v23 offset:2048
  v_mfma_f32_16x16x32_bf16 v[120:123], v[44:47], v[124:127], 0
  s_waitcnt lgkmcnt(4)
  v_mfma_f32_32x32x16_bf16 v[88:103], v[40:43], v[28:31], 0
  ds_read_b64_tr_b16 v[54:55], v23 offset:2560
  ds_read_b128 v[36:39], v19 offset:0
  v_mfma_f32_32x32x16_bf16 v[104:119], v[44:47], v[28:31], 0
  s_waitcnt lgkmcnt(3)
  v_mfma_f32_32x32x16_bf16 v[56:71], v[48:51], v[32:35], v[56:71]
  ds_read_b64_tr_b16 v[40:41], v22 offset:4096
  ds_read_b64_tr_b16 v[42:43], v22 offset:4608
  s_waitcnt lgkmcnt(3)
  v_mfma_f32_32x32x16_bf16 v[72:87], v[52:55], v[32:35], v[72:87]
  ds_read_b128 v[24:27], v16 offset:0
  ds_read_b64_tr_b16 v[44:45], v23 offset:4096
  v_mfma_f32_16x16x32_bf16 v[120:123], v[52:55], v[124:127], v[120:123]
  s_waitcnt lgkmcnt(4)
  v_mfma_f32_32x32x16_bf16 v[88:103], v[48:51], v[36:39], v[88:103]
  ds_read_b64_tr_b16 v[46:47], v23 offset:4608
  ds_read_b128 v[28:31], v20 offset:0
  v_mfma_f32_32x32x16_bf16 v[104:119], v[52:55], v[36:39], v[104:119]
  s_waitcnt lgkmcnt(3)
  v_mfma_f32_32x32x16_bf16 v[56:71], v[40:43], v[24:27], v[56:71]
  ds_read_b64_tr_b16 v[48:49], v22 offset:6144
  ds_read_b64_tr_b16 v[50:51], v22 offset:6656
  s_waitcnt lgkmcnt(3)
  v_mfma_f32_32x32x16_bf16 v[72:87], v[44:47], v[24:27], v[72:87]
  ds_read_b128 v[32:35], v17 offset:0
  ds_read_b64_tr_b16 v[52:53], v23 offset:6144
  v_mfma_f32_16x16x32_bf16 v[120:123], v[44:47], v[124:127], v[120:123]
  s_waitcnt lgkmcnt(4)
  v_mfma_f32_32x32x16_bf16 v[88:103], v[40:43], v[28:31], v[88:103]
  ds_read_b64_tr_b16 v[54:55], v23 offset:6656
  ds_read_b128 v[36:39], v21 offset:0
  v_mfma_f32_32x32x16_bf16 v[104:119], v[44:47], v[28:31], v[104:119]
  s_waitcnt lgkmcnt(0)
  s_barrier
  v_mfma_f32_32x32x16_bf16 v[56:71], v[48:51], v[32:35], v[56:71]
  ds_read_b64_tr_b16 v[40:41], v22 offset:16384
  ds_read_b64_tr_b16 v[42:43], v22 offset:16896
  v_mfma_f32_32x32x16_bf16 v[72:87], v[52:55], v[32:35], v[72:87]
  ds_read_b128 v[24:27], v14 offset:16384
  ds_read_b64_tr_b16 v[44:45], v23 offset:16384
  v_mfma_f32_16x16x32_bf16 v[120:123], v[52:55], v[124:127], v[120:123]
  v_mfma_f32_32x32x16_bf16 v[88:103], v[48:51], v[36:39], v[88:103]
  ds_read_b64_tr_b16 v[46:47], v23 offset:16896
  ds_read_b128 v[28:31], v18 offset:16384
  v_mfma_f32_32x32x16_bf16 v[104:119], v[52:55], v[36:39], v[104:119]
  s_waitcnt lgkmcnt(3)
  v_mfma_f32_32x32x16_bf16 v[56:71], v[40:43], v[24:27], v[56:71]
  ds_read_b64_tr_b16 v[48:49], v22 offset:18432
  ds_read_b64_tr_b16 v[50:51], v22 offset:18944
  s_waitcnt lgkmcnt(3)
  v_mfma_f32_32x32x16_bf16 v[72:87], v[44:47], v[24:27], v[72:87]
  ds_read_b128 v[32:35], v15 offset:16384
  ds_read_b64_tr_b16 v[52:53], v23 offset:18432
  v_mfma_f32_16x16x32_bf16 v[120:123], v[44:47], v[124:127], v[120:123]
  s_waitcnt lgkmcnt(4)
  v_mfma_f32_32x32x16_bf16 v[88:103], v[40:43], v[28:31], v[88:103]
  ds_read_b64_tr_b16 v[54:55], v23 offset:18944
  ds_read_b128 v[36:39], v19 offset:16384
  v_mfma_f32_32x32x16_bf16 v[104:119], v[44:47], v[28:31], v[104:119]
  s_waitcnt lgkmcnt(3)
  v_mfma_f32_32x32x16_bf16 v[56:71], v[48:51], v[32:35], v[56:71]
  ds_read_b64_tr_b16 v[40:41], v22 offset:20480
  ds_read_b64_tr_b16 v[42:43], v22 offset:20992
  s_waitcnt lgkmcnt(3)
  v_mfma_f32_32x32x16_bf16 v[72:87], v[52:55], v[32:35], v[72:87]
  ds_read_b128 v[24:27], v16 offset:16384
  ds_read_b64_tr_b16 v[44:45], v23 offset:20480
  v_mfma_f32_16x16x32_bf16 v[120:123], v[52:55], v[124:127], v[120:123]
  s_waitcnt lgkmcnt(4)
  v_mfma_f32_32x32x16_bf16 v[88:103], v[48:51], v[36:39], v[88:103]
  ds_read_b64_tr_b16 v[46:47], v23 offset:20992
  ds_read_b128 v[28:31], v20 offset:16384
  v_mfma_f32_32x32x16_bf16 v[104:119], v[52:55], v[36:39], v[104:119]
  s_waitcnt lgkmcnt(3)
  v_mfma_f32_32x32x16_bf16 v[56:71], v[40:43], v[24:27], v[56:71]
  ds_read_b64_tr_b16 v[48:49], v22 offset:22528
  ds_read_b64_tr_b16 v[50:51], v22 offset:23040
  s_waitcnt lgkmcnt(3)
  v_mfma_f32_32x32x16_bf16 v[72:87], v[44:47], v[24:27], v[72:87]
  ds_read_b128 v[32:35], v17 offset:16384
  ds_read_b64_tr_b16 v[52:53], v23 offset:22528
  v_mfma_f32_16x16x32_bf16 v[120:123], v[44:47], v[124:127], v[120:123]
  s_waitcnt lgkmcnt(4)
  v_mfma_f32_32x32x16_bf16 v[88:103], v[40:43], v[28:31], v[88:103]
  ds_read_b64_tr_b16 v[54:55], v23 offset:23040
  ds_read_b128 v[36:39], v21 offset:16384
  v_mfma_f32_32x32x16_bf16 v[104:119], v[44:47], v[28:31], v[104:119]
  s_waitcnt lgkmcnt(0)
  s_barrier
  s_mov_b32 s70, 0xff
  s_mov_b32 s71, 0
  s_waitcnt vmcnt(0)
  v_mov_b32 v199, 152596
  v_mov_b32 v200, 1
  s_mov_b64 exec, 1
  ds_add_rtn_u32 v200, v199, v200
  s_waitcnt lgkmcnt(0)
  v_readfirstlane_b32 s72, v200
  s_mov_b64 exec, -1
  s_nop 2
  s_cmp_lg_u32 s72, 3
  s_cbranch_scc1 L_nopush_xst
  v_mov_b32 v200, s34
  s_mov_b64 exec, s[70:71]
  buffer_store_dword v200, v192, s[48:51], 0 offen sc1
  s_mov_b64 exec, -1
L_nopush_xst:
  s_mov_b32 s70, s65
  s_mov_b32 s71, s66
  v_mfma_f32_32x32x16_bf16 v[56:71], v[48:51], v[32:35], v[56:71]
  ds_read_b64_tr_b16 v[40:41], v22 offset:32768
  ds_read_b64_tr_b16 v[42:43], v22 offset:33280
  v_mfma_f32_32x32x16_bf16 v[72:87], v[52:55], v[32:35], v[72:87]
  ds_read_b128 v[24:27], v14 offset:32768
  ds_read_b64_tr_b16 v[44:45], v23 offset:32768
  v_mfma_f32_16x16x32_bf16 v[120:123], v[52:55], v[124:127], v[120:123]
  v_mfma_f32_32x32x16_bf16 v[88:103], v[48:51], v[36:39], v[88:103]
  ds_read_b64_tr_b16 v[46:47], v23 offset:33280
  ds_read_b128 v[28:31], v18 offset:32768
  v_mfma_f32_32x32x16_bf16 v[104:119], v[52:55], v[36:39], v[104:119]
  s_waitcnt lgkmcnt(3)
  v_mfma_f32_32x32x16_bf16 v[56:71], v[40:43], v[24:27], v[56:71]
  ds_read_b64_tr_b16 v[48:49], v22 offset:34816
  ds_read_b64_tr_b16 v[50:51], v22 offset:35328
  s_waitcnt lgkmcnt(3)
  v_mfma_f32_32x32x16_bf16 v[72:87], v[44:47], v[24:27], v[72:87]
  ds_read_b128 v[32:35], v15 offset:32768
  ds_read_b64_tr_b16 v[52:53], v23 offset:34816
  v_mfma_f32_16x16x32_bf16 v[120:123], v[44:47], v[124:127], v[120:123]
  s_waitcnt lgkmcnt(4)
  v_mfma_f32_32x32x16_bf16 v[88:103], v[40:43], v[28:31], v[88:103]
  ds_read_b64_tr_b16 v[54:55], v23 offset:35328
  ds_read_b128 v[36:39], v19 offset:32768
  v_mfma_f32_32x32x16_bf16 v[104:119], v[44:47], v[28:31], v[104:119]
  s_waitcnt lgkmcnt(3)
  v_mfma_f32_32x32x16_bf16 v[56:71], v[48:51], v[32:35], v[56:71]
  ds_read_b64_tr_b16 v[40:41], v22 offset:36864
  ds_read_b64_tr_b16 v[42:43], v22 offset:37376
  s_waitcnt lgkmcnt(3)
  v_mfma_f32_32x32x16_bf16 v[72:87], v[52:55], v[32:35], v[72:87]
  ds_read_b128 v[24:27], v16 offset:32768
  ds_read_b64_tr_b16 v[44:45], v23 offset:36864
  v_mfma_f32_16x16x32_bf16 v[120:123], v[52:55], v[124:127], v[120:123]
  s_waitcnt lgkmcnt(4)
  v_mfma_f32_32x32x16_bf16 v[88:103], v[48:51], v[36:39], v[88:103]
  ds_read_b64_tr_b16 v[46:47], v23 offset:37376
  ds_read_b128 v[28:31], v20 offset:32768
  v_mfma_f32_32x32x16_bf16 v[104:119], v[52:55], v[36:39], v[104:119]
  s_waitcnt lgkmcnt(3)
  v_mfma_f32_32x32x16_bf16 v[56:71], v[40:43], v[24:27], v[56:71]
  ds_read_b64_tr_b16 v[48:49], v22 offset:38912
  ds_read_b64_tr_b16 v[50:51], v22 offset:39424
  s_waitcnt lgkmcnt(3)
  v_mfma_f32_32x32x16_bf16 v[72:87], v[44:47], v[24:27], v[72:87]
  ds_read_b128 v[32:35], v17 offset:32768
  ds_read_b64_tr_b16 v[52:53], v23 offset:38912
  v_mfma_f32_16x16x32_bf16 v[120:123], v[44:47], v[124:127], v[120:123]
  s_waitcnt lgkmcnt(4)
  v_mfma_f32_32x32x16_bf16 v[88:103], v[40:43], v[28:31], v[88:103]
  ds_read_b64_tr_b16 v[54:55], v23 offset:39424
  ds_read_b128 v[36:39], v21 offset:32768
  v_mfma_f32_32x32x16_bf16 v[104:119], v[44:47], v[28:31], v[104:119]
  s_waitcnt lgkmcnt(0)
  s_barrier
  v_mfma_f32_32x32x16_bf16 v[56:71], v[48:51], v[32:35], v[56:71]
  ds_read_b64_tr_b16 v[40:41], v22 offset:49152
  ds_read_b64_tr_b16 v[42:43], v22 offset:49664
  v_mfma_f32_32x32x16_bf16 v[72:87], v[52:55], v[32:35], v[72:87]
  ds_read_b128 v[24:27], v14 offset:49152
  ds_read_b64_tr_b16 v[44:45], v23 offset:49152
  v_mfma_f32_16x16x32_bf16 v[120:123], v[52:55], v[124:127], v[120:123]
  v_mfma_f32_32x32x16_bf16 v[88:103], v[48:51], v[36:39], v[88:103]
  ds_read_b64_tr_b16 v[46:47], v23 offset:49664
  ds_read_b128 v[28:31], v18 offset:49152
  v_mfma_f32_32x32x16_bf16 v[104:119], v[52:55], v[36:39], v[104:119]
  s_waitcnt lgkmcnt(3)
  v_mfma_f32_32x32x16_bf16 v[56:71], v[40:43], v[24:27], v[56:71]
  ds_read_b64_tr_b16 v[48:49], v22 offset:51200
  ds_read_b64_tr_b16 v[50:51], v22 offset:51712
  s_waitcnt lgkmcnt(3)
  v_mfma_f32_32x32x16_bf16 v[72:87], v[44:47], v[24:27], v[72:87]
  ds_read_b128 v[32:35], v15 offset:49152
  ds_read_b64_tr_b16 v[52:53], v23 offset:51200
  v_mfma_f32_16x16x32_bf16 v[120:123], v[44:47], v[124:127], v[120:123]
  s_waitcnt lgkmcnt(4)
  v_mfma_f32_32x32x16_bf16 v[88:103], v[40:43], v[28:31], v[88:103]
  ds_read_b64_tr_b16 v[54:55], v23 offset:51712
  ds_read_b128 v[36:39], v19 offset:49152
  v_mfma_f32_32x32x16_bf16 v[104:119], v[44:47], v[28:31], v[104:119]
  s_waitcnt lgkmcnt(3)
  v_mfma_f32_32x32x16_bf16 v[56:71], v[48:51], v[32:35], v[56:71]
  ds_read_b64_tr_b16 v[40:41], v22 offset:53248
  ds_read_b64_tr_b16 v[42:43], v22 offset:53760
  s_waitcnt lgkmcnt(3)
  v_mfma_f32_32x32x16_bf16 v[72:87], v[52:55], v[32:35], v[72:87]
  ds_read_b128 v[24:27], v16 offset:49152
  ds_read_b64_tr_b16 v[44:45], v23 offset:53248
  v_mfma_f32_16x16x32_bf16 v[120:123], v[52:55], v[124:127], v[120:123]
  s_waitcnt lgkmcnt(4)
  v_mfma_f32_32x32x16_bf16 v[88:103], v[48:51], v[36:39], v[88:103]
  ds_read_b64_tr_b16 v[46:47], v23 offset:53760
  ds_read_b128 v[28:31], v20 offset:49152
  v_mfma_f32_32x32x16_bf16 v[104:119], v[52:55], v[36:39], v[104:119]
  s_waitcnt lgkmcnt(3)
  v_mfma_f32_32x32x16_bf16 v[56:71], v[40:43], v[24:27], v[56:71]
  ds_read_b64_tr_b16 v[48:49], v22 offset:55296
  ds_read_b64_tr_b16 v[50:51], v22 offset:55808
  s_waitcnt lgkmcnt(3)
  v_mfma_f32_32x32x16_bf16 v[72:87], v[44:47], v[24:27], v[72:87]
  ds_read_b128 v[32:35], v17 offset:49152
  ds_read_b64_tr_b16 v[52:53], v23 offset:55296
  v_mfma_f32_16x16x32_bf16 v[120:123], v[44:47], v[124:127], v[120:123]
  s_waitcnt lgkmcnt(4)
  v_mfma_f32_32x32x16_bf16 v[88:103], v[40:43], v[28:31], v[88:103]
  ds_read_b64_tr_b16 v[54:55], v23 offset:55808
  ds_read_b128 v[36:39], v21 offset:49152
  v_mfma_f32_32x32x16_bf16 v[104:119], v[44:47], v[28:31], v[104:119]
  s_waitcnt lgkmcnt(0)
  s_barrier
  v_mfma_f32_32x32x16_bf16 v[56:71], v[48:51], v[32:35], v[56:71]
  ds_read_b64_tr_b16 v[40:41], v22 offset:0
  ds_read_b64_tr_b16 v[42:43], v22 offset:512
  v_mfma_f32_32x32x16_bf16 v[72:87], v[52:55], v[32:35], v[72:87]
  ds_read_b128 v[24:27], v14 offset:0
  ds_read_b64_tr_b16 v[44:45], v23 offset:0
  v_mfma_f32_16x16x32_bf16 v[120:123], v[52:55], v[124:127], v[120:123]
  v_mfma_f32_32x32x16_bf16 v[88:103], v[48:51], v[36:39], v[88:103]
  ds_read_b64_tr_b16 v[46:47], v23 offset:512
  ds_read_b128 v[28:31], v18 offset:0
  v_mfma_f32_32x32x16_bf16 v[104:119], v[52:55], v[36:39], v[104:119]
  s_waitcnt lgkmcnt(3)
  v_mfma_f32_32x32x16_bf16 v[56:71], v[40:43], v[24:27], v[56:71]
  ds_read_b64_tr_b16 v[48:49], v22 offset:2048
  ds_read_b64_tr_b16 v[50:51], v22 offset:2560
  s_waitcnt lgkmcnt(3)
  v_mfma_f32_32x32x16_bf16 v[72:87], v[44:47], v[24:27], v[72:87]
  ds_read_b128 v[32:35], v15 offset:0
  ds_read_b64_tr_b16 v[52:53], v23 offset:2048
  v_mfma_f32_16x16x32_bf16 v[120:123], v[44:47], v[124:127], v[120:123]
  s_waitcnt lgkmcnt(4)
  v_mfma_f32_32x32x16_bf16 v[88:103], v[40:43], v[28:31], v[88:103]
  ds_read_b64_tr_b16 v[54:55], v23 offset:2560
  ds_read_b128 v[36:39], v19 offset:0
  v_mfma_f32_32x32x16_bf16 v[104:119], v[44:47], v[28:31], v[104:119]
  s_waitcnt lgkmcnt(3)
  v_mfma_f32_32x32x16_bf16 v[56:71], v[48:51], v[32:35], v[56:71]
  ds_read_b64_tr_b16 v[40:41], v22 offset:4096
  ds_read_b64_tr_b16 v[42:43], v22 offset:4608
  s_waitcnt lgkmcnt(3)
  v_mfma_f32_32x32x16_bf16 v[72:87], v[52:55], v[32:35], v[72:87]
  ds_read_b128 v[24:27], v16 offset:0
  ds_read_b64_tr_b16 v[44:45], v23 offset:4096
  v_mfma_f32_16x16x32_bf16 v[120:123], v[52:55], v[124:127], v[120:123]
  s_waitcnt lgkmcnt(4)
  v_mfma_f32_32x32x16_bf16 v[88:103], v[48:51], v[36:39], v[88:103]
  ds_read_b64_tr_b16 v[46:47], v23 offset:4608
  ds_read_b128 v[28:31], v20 offset:0
  v_mfma_f32_32x32x16_bf16 v[104:119], v[52:55], v[36:39], v[104:119]
  s_waitcnt lgkmcnt(3)
  v_mfma_f32_32x32x16_bf16 v[56:71], v[40:43], v[24:27], v[56:71]
  ds_read_b64_tr_b16 v[48:49], v22 offset:6144
  ds_read_b64_tr_b16 v[50:51], v22 offset:6656
  s_waitcnt lgkmcnt(3)
  v_mfma_f32_32x32x16_bf16 v[72:87], v[44:47], v[24:27], v[72:87]
  ds_read_b128 v[32:35], v17 offset:0
  ds_read_b64_tr_b16 v[52:53], v23 offset:6144
  v_mfma_f32_16x16x32_bf16 v[120:123], v[44:47], v[124:127], v[120:123]
  s_waitcnt lgkmcnt(4)
  v_mfma_f32_32x32x16_bf16 v[88:103], v[40:43], v[28:31], v[88:103]
  ds_read_b64_tr_b16 v[54:55], v23 offset:6656
  ds_read_b128 v[36:39], v21 offset:0
  v_mfma_f32_32x32x16_bf16 v[104:119], v[44:47], v[28:31], v[104:119]
  s_waitcnt lgkmcnt(0)
  s_barrier
  v_mfma_f32_32x32x16_bf16 v[56:71], v[48:51], v[32:35], v[56:71]
  ds_read_b64_tr_b16 v[40:41], v22 offset:16384
  ds_read_b64_tr_b16 v[42:43], v22 offset:16896
  v_mfma_f32_32x32x16_bf16 v[72:87], v[52:55], v[32:35], v[72:87]
  ds_read_b128 v[24:27], v14 offset:16384
  ds_read_b64_tr_b16 v[44:45], v23 offset:16384
  v_mfma_f32_16x16x32_bf16 v[120:123], v[52:55], v[124:127], v[120:123]
  v_mfma_f32_32x32x16_bf16 v[88:103], v[48:51], v[36:39], v[88:103]
  ds_read_b64_tr_b16 v[46:47], v23 offset:16896
  ds_read_b128 v[28:31], v18 offset:16384
  v_mfma_f32_32x32x16_bf16 v[104:119], v[52:55], v[36:39], v[104:119]
  s_waitcnt lgkmcnt(3)
  v_mfma_f32_32x32x16_bf16 v[56:71], v[40:43], v[24:27], v[56:71]
  ds_read_b64_tr_b16 v[48:49], v22 offset:18432
  ds_read_b64_tr_b16 v[50:51], v22 offset:18944
  s_waitcnt lgkmcnt(3)
  v_mfma_f32_32x32x16_bf16 v[72:87], v[44:47], v[24:27], v[72:87]
  ds_read_b128 v[32:35], v15 offset:16384
  ds_read_b64_tr_b16 v[52:53], v23 offset:18432
  v_mfma_f32_16x16x32_bf16 v[120:123], v[44:47], v[124:127], v[120:123]
  s_waitcnt lgkmcnt(4)
  v_mfma_f32_32x32x16_bf16 v[88:103], v[40:43], v[28:31], v[88:103]
  ds_read_b64_tr_b16 v[54:55], v23 offset:18944
  ds_read_b128 v[36:39], v19 offset:16384
  v_mfma_f32_32x32x16_bf16 v[104:119], v[44:47], v[28:31], v[104:119]
  s_waitcnt lgkmcnt(3)
  v_mfma_f32_32x32x16_bf16 v[56:71], v[48:51], v[32:35], v[56:71]
  ds_read_b64_tr_b16 v[40:41], v22 offset:20480
  ds_read_b64_tr_b16 v[42:43], v22 offset:20992
  s_waitcnt lgkmcnt(3)
  v_mfma_f32_32x32x16_bf16 v[72:87], v[52:55], v[32:35], v[72:87]
  ds_read_b128 v[24:27], v16 offset:16384
  ds_read_b64_tr_b16 v[44:45], v23 offset:20480
  v_mfma_f32_16x16x32_bf16 v[120:123], v[52:55], v[124:127], v[120:123]
  s_waitcnt lgkmcnt(4)
  v_mfma_f32_32x32x16_bf16 v[88:103], v[48:51], v[36:39], v[88:103]
  ds_read_b64_tr_b16 v[46:47], v23 offset:20992
  ds_read_b128 v[28:31], v20 offset:16384
  v_mfma_f32_32x32x16_bf16 v[104:119], v[52:55], v[36:39], v[104:119]
  s_waitcnt lgkmcnt(3)
  v_mfma_f32_32x32x16_bf16 v[56:71], v[40:43], v[24:27], v[56:71]
  ds_read_b64_tr_b16 v[48:49], v22 offset:22528
  ds_read_b64_tr_b16 v[50:51], v22 offset:23040
  s_waitcnt lgkmcnt(3)
  v_mfma_f32_32x32x16_bf16 v[72:87], v[44:47], v[24:27], v[72:87]
  ds_read_b128 v[32:35], v17 offset:16384
  ds_read_b64_tr_b16 v[52:53], v23 offset:22528
  v_mfma_f32_16x16x32_bf16 v[120:123], v[44:47], v[124:127], v[120:123]
  s_waitcnt lgkmcnt(4)
  v_mfma_f32_32x32x16_bf16 v[88:103], v[40:43], v[28:31], v[88:103]
  ds_read_b64_tr_b16 v[54:55], v23 offset:23040
  ds_read_b128 v[36:39], v21 offset:16384
  v_mfma_f32_32x32x16_bf16 v[104:119], v[44:47], v[28:31], v[104:119]
  s_waitcnt lgkmcnt(0)
  s_barrier
  v_mfma_f32_32x32x16_bf16 v[56:71], v[48:51], v[32:35], v[56:71]
  ds_read_b64_tr_b16 v[40:41], v22 offset:32768
  ds_read_b64_tr_b16 v[42:43], v22 offset:33280
  v_mfma_f32_32x32x16_bf16 v[72:87], v[52:55], v[32:35], v[72:87]
  ds_read_b128 v[24:27], v14 offset:32768
  ds_read_b64_tr_b16 v[44:45], v23 offset:32768
  v_mfma_f32_16x16x32_bf16 v[120:123], v[52:55], v[124:127], v[120:123]
  v_mfma_f32_32x32x16_bf16 v[88:103], v[48:51], v[36:39], v[88:103]
  ds_read_b64_tr_b16 v[46:47], v23 offset:33280
  ds_read_b128 v[28:31], v18 offset:32768
  v_mfma_f32_32x32x16_bf16 v[104:119], v[52:55], v[36:39], v[104:119]
  s_waitcnt lgkmcnt(3)
  v_mfma_f32_32x32x16_bf16 v[56:71], v[40:43], v[24:27], v[56:71]
  ds_read_b64_tr_b16 v[48:49], v22 offset:34816
  ds_read_b64_tr_b16 v[50:51], v22 offset:35328
  s_waitcnt lgkmcnt(3)
  v_mfma_f32_32x32x16_bf16 v[72:87], v[44:47], v[24:27], v[72:87]
  ds_read_b128 v[32:35], v15 offset:32768
  ds_read_b64_tr_b16 v[52:53], v23 offset:34816
  v_mfma_f32_16x16x32_bf16 v[120:123], v[44:47], v[124:127], v[120:123]
  s_waitcnt lgkmcnt(4)
  v_mfma_f32_32x32x16_bf16 v[88:103], v[40:43], v[28:31], v[88:103]
  ds_read_b64_tr_b16 v[54:55], v23 offset:35328
  ds_read_b128 v[36:39], v19 offset:32768
  v_mfma_f32_32x32x16_bf16 v[104:119], v[44:47], v[28:31], v[104:119]
  s_waitcnt lgkmcnt(3)
  v_mfma_f32_32x32x16_bf16 v[56:71], v[48:51], v[32:35], v[56:71]
  ds_read_b64_tr_b16 v[40:41], v22 offset:36864
  ds_read_b64_tr_b16 v[42:43], v22 offset:37376
  s_waitcnt lgkmcnt(3)
  v_mfma_f32_32x32x16_bf16 v[72:87], v[52:55], v[32:35], v[72:87]
  ds_read_b128 v[24:27], v16 offset:32768
  ds_read_b64_tr_b16 v[44:45], v23 offset:36864
  v_mfma_f32_16x16x32_bf16 v[120:123], v[52:55], v[124:127], v[120:123]
  s_waitcnt lgkmcnt(4)
  v_mfma_f32_32x32x16_bf16 v[88:103], v[48:51], v[36:39], v[88:103]
  ds_read_b64_tr_b16 v[46:47], v23 offset:37376
  ds_read_b128 v[28:31], v20 offset:32768
  v_mfma_f32_32x32x16_bf16 v[104:119], v[52:55], v[36:39], v[104:119]
  s_waitcnt lgkmcnt(3)
  v_mfma_f32_32x32x16_bf16 v[56:71], v[40:43], v[24:27], v[56:71]
  ds_read_b64_tr_b16 v[48:49], v22 offset:38912
  ds_read_b64_tr_b16 v[50:51], v22 offset:39424
  s_waitcnt lgkmcnt(3)
  v_mfma_f32_32x32x16_bf16 v[72:87], v[44:47], v[24:27], v[72:87]
  ds_read_b128 v[32:35], v17 offset:32768
  ds_read_b64_tr_b16 v[52:53], v23 offset:38912
  v_mfma_f32_16x16x32_bf16 v[120:123], v[44:47], v[124:127], v[120:123]
  s_waitcnt lgkmcnt(4)
  v_mfma_f32_32x32x16_bf16 v[88:103], v[40:43], v[28:31], v[88:103]
  ds_read_b64_tr_b16 v[54:55], v23 offset:39424
  ds_read_b128 v[36:39], v21 offset:32768
  v_mfma_f32_32x32x16_bf16 v[104:119], v[44:47], v[28:31], v[104:119]
  s_waitcnt lgkmcnt(0)
  s_barrier
  v_mfma_f32_32x32x16_bf16 v[56:71], v[48:51], v[32:35], v[56:71]
  ds_read_b64_tr_b16 v[40:41], v22 offset:49152
  ds_read_b64_tr_b16 v[42:43], v22 offset:49664
  v_mfma_f32_32x32x16_bf16 v[72:87], v[52:55], v[32:35], v[72:87]
  ds_read_b128 v[24:27], v14 offset:49152
  ds_read_b64_tr_b16 v[44:45], v23 offset:49152
  v_mfma_f32_16x16x32_bf16 v[120:123], v[52:55], v[124:127], v[120:123]
  v_mfma_f32_32x32x16_bf16 v[88:103], v[48:51], v[36:39], v[88:103]
  ds_read_b64_tr_b16 v[46:47], v23 offset:49664
  ds_read_b128 v[28:31], v18 offset:49152
  v_mfma_f32_32x32x16_bf16 v[104:119], v[52:55], v[36:39], v[104:119]
  s_waitcnt lgkmcnt(3)
  v_mfma_f32_32x32x16_bf16 v[56:71], v[40:43], v[24:27], v[56:71]
  ds_read_b64_tr_b16 v[48:49], v22 offset:51200
  ds_read_b64_tr_b16 v[50:51], v22 offset:51712
  s_waitcnt lgkmcnt(3)
  v_mfma_f32_32x32x16_bf16 v[72:87], v[44:47], v[24:27], v[72:87]
  ds_read_b128 v[32:35], v15 offset:49152
  ds_read_b64_tr_b16 v[52:53], v23 offset:51200
  v_mfma_f32_16x16x32_bf16 v[120:123], v[44:47], v[124:127], v[120:123]
  s_waitcnt lgkmcnt(4)
  v_mfma_f32_32x32x16_bf16 v[88:103], v[40:43], v[28:31], v[88:103]
  ds_read_b64_tr_b16 v[54:55], v23 offset:51712
  ds_read_b128 v[36:39], v19 offset:49152
  v_mfma_f32_32x32x16_bf16 v[104:119], v[44:47], v[28:31], v[104:119]
  s_waitcnt lgkmcnt(3)
  v_mfma_f32_32x32x16_bf16 v[56:71], v[48:51], v[32:35], v[56:71]
  ds_read_b64_tr_b16 v[40:41], v22 offset:53248
  ds_read_b64_tr_b16 v[42:43], v22 offset:53760
  s_waitcnt lgkmcnt(3)
  v_mfma_f32_32x32x16_bf16 v[72:87], v[52:55], v[32:35], v[72:87]
  ds_read_b128 v[24:27], v16 offset:49152
  ds_read_b64_tr_b16 v[44:45], v23 offset:53248
  v_mfma_f32_16x16x32_bf16 v[120:123], v[52:55], v[124:127], v[120:123]
  s_waitcnt lgkmcnt(4)
  v_mfma_f32_32x32x16_bf16 v[88:103], v[48:51], v[36:39], v[88:103]
  ds_read_b64_tr_b16 v[46:47], v23 offset:53760
  ds_read_b128 v[28:31], v20 offset:49152
  v_mfma_f32_32x32x16_bf16 v[104:119], v[52:55], v[36:39], v[104:119]
  s_waitcnt lgkmcnt(3)
  v_mfma_f32_32x32x16_bf16 v[56:71], v[40:43], v[24:27], v[56:71]
  ds_read_b64_tr_b16 v[48:49], v22 offset:55296
  ds_read_b64_tr_b16 v[50:51], v22 offset:55808
  s_waitcnt lgkmcnt(3)
  v_mfma_f32_32x32x16_bf16 v[72:87], v[44:47], v[24:27], v[72:87]
  ds_read_b128 v[32:35], v17 offset:49152
  ds_read_b64_tr_b16 v[52:53], v23 offset:55296
  v_mfma_f32_16x16x32_bf16 v[120:123], v[44:47], v[124:127], v[120:123]
  s_waitcnt lgkmcnt(4)
  v_mfma_f32_32x32x16_bf16 v[88:103], v[40:43], v[28:31], v[88:103]
  ds_read_b64_tr_b16 v[54:55], v23 offset:55808
  ds_read_b128 v[36:39], v21 offset:49152
  v_mfma_f32_32x32x16_bf16 v[104:119], v[44:47], v[28:31], v[104:119]
  s_waitcnt lgkmcnt(3)
  v_mfma_f32_32x32x16_bf16 v[56:71], v[48:51], v[32:35], v[56:71]
  s_waitcnt lgkmcnt(1)
  v_mfma_f32_32x32x16_bf16 v[72:87], v[52:55], v[32:35], v[72:87]
  v_mfma_f32_16x16x32_bf16 v[120:123], v[52:55], v[124:127], v[120:123]
  s_waitcnt lgkmcnt(0)
  v_mfma_f32_32x32x16_bf16 v[88:103], v[48:51], v[36:39], v[88:103]
  v_mfma_f32_32x32x16_bf16 v[104:119], v[52:55], v[36:39], v[104:119]
  s_mov_b32 exec_lo, 0x30003
  s_mov_b32 exec_hi, 0x30003
  s_nop 2
  ds_write_b128 v195, v[120:123]
  s_mov_b64 exec, -1
  ds_read_b128 v[24:27], v197 offset:0
  ds_read_b128 v[28:31], v197 offset:32
  ds_read_b128 v[32:35], v197 offset:64
  ds_read_b128 v[36:39], v197 offset:96
  s_barrier
  ds_read_b64 v[200:201], v198 offset:0
  ds_read_b64 v[202:203], v198 offset:256
  s_waitcnt lgkmcnt(0)
  v_mul_f32 v204, 0xbb000000, v200
  v_mul_f32 v236, 0x3b000000, v201
  v_fma_f32 v236, -v204, v204, v236
  v_max_f32 v236, 0, v236
  v_add_f32 v236, 0x3727c5ac, v236
  v_rsq_f32 v237, v236
  v_sqrt_f32 v207, v236
  v_mul_f32 v206, 0xc0135761, v237
  v_mul_f32 v236, v237, v237
  v_mul_f32 v236, v236, v237
  v_mul_f32 v205, 0xbdd2d3e8, v236
  v_mul_f32 v208, 0xbb000000, v202
  v_mul_f32 v236, 0x3b000000, v203
  v_fma_f32 v236, -v208, v208, v236
  v_max_f32 v236, 0, v236
  v_add_f32 v236, 0x3727c5ac, v236
  v_rsq_f32 v237, v236
  v_sqrt_f32 v211, v236
  v_mul_f32 v210, 0xc0135761, v237
  v_mul_f32 v236, v237, v237
  v_mul_f32 v236, v236, v237
  v_mul_f32 v209, 0xbdd2d3e8, v236
  v_pk_fma_f32 v[72:73], v[24:25], v[204:205], v[72:73] op_sel:[0,0,0] op_sel_hi:[1,0,1]
  v_pk_fma_f32 v[74:75], v[26:27], v[204:205], v[74:75] op_sel:[0,0,0] op_sel_hi:[1,0,1]
  v_pk_fma_f32 v[76:77], v[28:29], v[204:205], v[76:77] op_sel:[0,0,0] op_sel_hi:[1,0,1]
  v_pk_fma_f32 v[78:79], v[30:31], v[204:205], v[78:79] op_sel:[0,0,0] op_sel_hi:[1,0,1]
  v_pk_fma_f32 v[80:81], v[32:33], v[204:205], v[80:81] op_sel:[0,0,0] op_sel_hi:[1,0,1]
  v_pk_fma_f32 v[82:83], v[34:35], v[204:205], v[82:83] op_sel:[0,0,0] op_sel_hi:[1,0,1]
  v_pk_fma_f32 v[84:85], v[36:37], v[204:205], v[84:85] op_sel:[0,0,0] op_sel_hi:[1,0,1]
  v_pk_fma_f32 v[86:87], v[38:39], v[204:205], v[86:87] op_sel:[0,0,0] op_sel_hi:[1,0,1]
  v_pk_mul_f32 v[40:41], v[72:73], v[72:73]
  v_pk_mul_f32 v[42:43], v[74:75], v[74:75]
  v_pk_mul_f32 v[44:45], v[76:77], v[76:77]
  v_pk_mul_f32 v[46:47], v[78:79], v[78:79]
  v_pk_mul_f32 v[48:49], v[80:81], v[80:81]
  v_pk_mul_f32 v[50:51], v[82:83], v[82:83]
  v_pk_mul_f32 v[52:53], v[84:85], v[84:85]
  v_pk_mul_f32 v[54:55], v[86:87], v[86:87]
  v_pk_fma_f32 v[40:41], v[40:41], v[204:205], v[206:207] op_sel:[0,1,0] op_sel_hi:[1,1,0]
  v_pk_fma_f32 v[42:43], v[42:43], v[204:205], v[206:207] op_sel:[0,1,0] op_sel_hi:[1,1,0]
  v_pk_fma_f32 v[44:45], v[44:45], v[204:205], v[206:207] op_sel:[0,1,0] op_sel_hi:[1,1,0]
  v_pk_fma_f32 v[46:47], v[46:47], v[204:205], v[206:207] op_sel:[0,1,0] op_sel_hi:[1,1,0]
  v_pk_fma_f32 v[48:49], v[48:49], v[204:205], v[206:207] op_sel:[0,1,0] op_sel_hi:[1,1,0]
  v_pk_fma_f32 v[50:51], v[50:51], v[204:205], v[206:207] op_sel:[0,1,0] op_sel_hi:[1,1,0]
  v_pk_fma_f32 v[52:53], v[52:53], v[204:205], v[206:207] op_sel:[0,1,0] op_sel_hi:[1,1,0]
  v_pk_fma_f32 v[54:55], v[54:55], v[204:205], v[206:207] op_sel:[0,1,0] op_sel_hi:[1,1,0]
  v_pk_mul_f32 v[40:41], v[40:41], v[72:73]
  v_pk_mul_f32 v[42:43], v[42:43], v[74:75]
  v_pk_mul_f32 v[44:45], v[44:45], v[76:77]
  v_pk_mul_f32 v[46:47], v[46:47], v[78:79]
  v_pk_mul_f32 v[48:49], v[48:49], v[80:81]
  v_pk_mul_f32 v[50:51], v[50:51], v[82:83]
  v_pk_mul_f32 v[52:53], v[52:53], v[84:85]
  v_pk_mul_f32 v[54:55], v[54:55], v[86:87]
  v_exp_f32 v40, v40
  v_exp_f32 v41, v41
  v_exp_f32 v42, v42
  v_exp_f32 v43, v43
  v_exp_f32 v44, v44
  v_exp_f32 v45, v45
  v_exp_f32 v46, v46
  v_exp_f32 v47, v47
  v_exp_f32 v48, v48
  v_exp_f32 v49, v49
  v_exp_f32 v50, v50
  v_exp_f32 v51, v51
  v_exp_f32 v52, v52
  v_exp_f32 v53, v53
  v_exp_f32 v54, v54
  v_exp_f32 v55, v55
  v_pk_fma_f32 v[40:41], v[40:41], v[206:207], v[206:207] op_sel:[0,1,1] op_sel_hi:[1,1,1]
  v_pk_fma_f32 v[42:43], v[42:43], v[206:207], v[206:207] op_sel:[0,1,1] op_sel_hi:[1,1,1]
  v_pk_fma_f32 v[44:45], v[44:45], v[206:207], v[206:207] op_sel:[0,1,1] op_sel_hi:[1,1,1]
  v_pk_fma_f32 v[46:47], v[46:47], v[206:207], v[206:207] op_sel:[0,1,1] op_sel_hi:[1,1,1]
  v_pk_fma_f32 v[48:49], v[48:49], v[206:207], v[206:207] op_sel:[0,1,1] op_sel_hi:[1,1,1]
  v_pk_fma_f32 v[50:51], v[50:51], v[206:207], v[206:207] op_sel:[0,1,1] op_sel_hi:[1,1,1]
  v_pk_fma_f32 v[52:53], v[52:53], v[206:207], v[206:207] op_sel:[0,1,1] op_sel_hi:[1,1,1]
  v_pk_fma_f32 v[54:55], v[54:55], v[206:207], v[206:207] op_sel:[0,1,1] op_sel_hi:[1,1,1]
  v_rcp_f32 v40, v40
  v_rcp_f32 v41, v41
  v_rcp_f32 v42, v42
  v_rcp_f32 v43, v43
  v_rcp_f32 v44, v44
  v_rcp_f32 v45, v45
  v_rcp_f32 v46, v46
  v_rcp_f32 v47, v47
  v_rcp_f32 v48, v48
  v_rcp_f32 v49, v49
  v_rcp_f32 v50, v50
  v_rcp_f32 v51, v51
  v_rcp_f32 v52, v52
  v_rcp_f32 v53, v53
  v_rcp_f32 v54, v54
  v_rcp_f32 v55, v55
  v_pk_mul_f32 v[72:73], v[72:73], v[40:41]
  v_pk_mul_f32 v[74:75], v[74:75], v[42:43]
  v_pk_mul_f32 v[76:77], v[76:77], v[44:45]
  v_pk_mul_f32 v[78:79], v[78:79], v[46:47]
  v_pk_mul_f32 v[80:81], v[80:81], v[48:49]
  v_pk_mul_f32 v[82:83], v[82:83], v[50:51]
  v_pk_mul_f32 v[84:85], v[84:85], v[52:53]
  v_pk_mul_f32 v[86:87], v[86:87], v[54:55]
  v_cvt_pk_bf16_f32 v212, v72, v73
  v_cvt_pk_bf16_f32 v213, v74, v75
  v_cvt_pk_bf16_f32 v214, v76, v77
  v_cvt_pk_bf16_f32 v215, v78, v79
  v_cvt_pk_bf16_f32 v216, v80, v81
  v_cvt_pk_bf16_f32 v217, v82, v83
  v_cvt_pk_bf16_f32 v218, v84, v85
  v_cvt_pk_bf16_f32 v219, v86, v87
  ds_write_b64 v142, v[212:213] offset:0
  ds_write_b64 v143, v[214:215] offset:0
  ds_write_b64 v144, v[216:217] offset:0
  ds_write_b64 v145, v[218:219] offset:0
  ds_read_b128 v[220:223], v146 offset:0
  ds_read_b128 v[224:227], v146 offset:1024
  v_pk_fma_f32 v[104:105], v[24:25], v[208:209], v[104:105] op_sel:[0,0,0] op_sel_hi:[1,0,1]
  v_pk_fma_f32 v[106:107], v[26:27], v[208:209], v[106:107] op_sel:[0,0,0] op_sel_hi:[1,0,1]
  v_pk_fma_f32 v[108:109], v[28:29], v[208:209], v[108:109] op_sel:[0,0,0] op_sel_hi:[1,0,1]
  v_pk_fma_f32 v[110:111], v[30:31], v[208:209], v[110:111] op_sel:[0,0,0] op_sel_hi:[1,0,1]
  v_pk_fma_f32 v[112:113], v[32:33], v[208:209], v[112:113] op_sel:[0,0,0] op_sel_hi:[1,0,1]
  v_pk_fma_f32 v[114:115], v[34:35], v[208:209], v[114:115] op_sel:[0,0,0] op_sel_hi:[1,0,1]
  v_pk_fma_f32 v[116:117], v[36:37], v[208:209], v[116:117] op_sel:[0,0,0] op_sel_hi:[1,0,1]
  v_pk_fma_f32 v[118:119], v[38:39], v[208:209], v[118:119] op_sel:[0,0,0] op_sel_hi:[1,0,1]
  v_pk_mul_f32 v[40:41], v[104:105], v[104:105]
  v_pk_mul_f32 v[42:43], v[106:107], v[106:107]
  v_pk_mul_f32 v[44:45], v[108:109], v[108:109]
  v_pk_mul_f32 v[46:47], v[110:111], v[110:111]
  v_pk_mul_f32 v[48:49], v[112:113], v[112:113]
  v_pk_mul_f32 v[50:51], v[114:115], v[114:115]
  v_pk_mul_f32 v[52:53], v[116:117], v[116:117]
  v_pk_mul_f32 v[54:55], v[118:119], v[118:119]
  v_pk_fma_f32 v[40:41], v[40:41], v[208:209], v[210:211] op_sel:[0,1,0] op_sel_hi:[1,1,0]
  v_pk_fma_f32 v[42:43], v[42:43], v[208:209], v[210:211] op_sel:[0,1,0] op_sel_hi:[1,1,0]
  v_pk_fma_f32 v[44:45], v[44:45], v[208:209], v[210:211] op_sel:[0,1,0] op_sel_hi:[1,1,0]
  v_pk_fma_f32 v[46:47], v[46:47], v[208:209], v[210:211] op_sel:[0,1,0] op_sel_hi:[1,1,0]
  v_pk_fma_f32 v[48:49], v[48:49], v[208:209], v[210:211] op_sel:[0,1,0] op_sel_hi:[1,1,0]
  v_pk_fma_f32 v[50:51], v[50:51], v[208:209], v[210:211] op_sel:[0,1,0] op_sel_hi:[1,1,0]
  v_pk_fma_f32 v[52:53], v[52:53], v[208:209], v[210:211] op_sel:[0,1,0] op_sel_hi:[1,1,0]
  v_pk_fma_f32 v[54:55], v[54:55], v[208:209], v[210:211] op_sel:[0,1,0] op_sel_hi:[1,1,0]
  v_pk_mul_f32 v[40:41], v[40:41], v[104:105]
  v_pk_mul_f32 v[42:43], v[42:43], v[106:107]
  v_pk_mul_f32 v[44:45], v[44:45], v[108:109]
  v_pk_mul_f32 v[46:47], v[46:47], v[110:111]
  v_pk_mul_f32 v[48:49], v[48:49], v[112:113]
  v_pk_mul_f32 v[50:51], v[50:51], v[114:115]
  v_pk_mul_f32 v[52:53], v[52:53], v[116:117]
  v_pk_mul_f32 v[54:55], v[54:55], v[118:119]
  v_exp_f32 v40, v40
  v_exp_f32 v41, v41
  v_exp_f32 v42, v42
  v_exp_f32 v43, v43
  v_exp_f32 v44, v44
  v_exp_f32 v45, v45
  v_exp_f32 v46, v46
  v_exp_f32 v47, v47
  v_exp_f32 v48, v48
  v_exp_f32 v49, v49
  v_exp_f32 v50, v50
  v_exp_f32 v51, v51
  v_exp_f32 v52, v52
  v_exp_f32 v53, v53
  v_exp_f32 v54, v54
  v_exp_f32 v55, v55
  v_pk_fma_f32 v[40:41], v[40:41], v[210:211], v[210:211] op_sel:[0,1,1] op_sel_hi:[1,1,1]
  v_pk_fma_f32 v[42:43], v[42:43], v[210:211], v[210:211] op_sel:[0,1,1] op_sel_hi:[1,1,1]
  v_pk_fma_f32 v[44:45], v[44:45], v[210:211], v[210:211] op_sel:[0,1,1] op_sel_hi:[1,1,1]
  v_pk_fma_f32 v[46:47], v[46:47], v[210:211], v[210:211] op_sel:[0,1,1] op_sel_hi:[1,1,1]
  v_pk_fma_f32 v[48:49], v[48:49], v[210:211], v[210:211] op_sel:[0,1,1] op_sel_hi:[1,1,1]
  v_pk_fma_f32 v[50:51], v[50:51], v[210:211], v[210:211] op_sel:[0,1,1] op_sel_hi:[1,1,1]
  v_pk_fma_f32 v[52:53], v[52:53], v[210:211], v[210:211] op_sel:[0,1,1] op_sel_hi:[1,1,1]
  v_pk_fma_f32 v[54:55], v[54:55], v[210:211], v[210:211] op_sel:[0,1,1] op_sel_hi:[1,1,1]
  v_rcp_f32 v40, v40
  v_rcp_f32 v41, v41
  v_rcp_f32 v42, v42
  v_rcp_f32 v43, v43
  v_rcp_f32 v44, v44
  v_rcp_f32 v45, v45
  v_rcp_f32 v46, v46
  v_rcp_f32 v47, v47
  v_rcp_f32 v48, v48
  v_rcp_f32 v49, v49
  v_rcp_f32 v50, v50
  v_rcp_f32 v51, v51
  v_rcp_f32 v52, v52
  v_rcp_f32 v53, v53
  v_rcp_f32 v54, v54
  v_rcp_f32 v55, v55
  v_pk_mul_f32 v[104:105], v[104:105], v[40:41]
  v_pk_mul_f32 v[106:107], v[106:107], v[42:43]
  v_pk_mul_f32 v[108:109], v[108:109], v[44:45]
  v_pk_mul_f32 v[110:111], v[110:111], v[46:47]
  v_pk_mul_f32 v[112:113], v[112:113], v[48:49]
  v_pk_mul_f32 v[114:115], v[114:115], v[50:51]
  v_pk_mul_f32 v[116:117], v[116:117], v[52:53]
  v_pk_mul_f32 v[118:119], v[118:119], v[54:55]
  v_cvt_pk_bf16_f32 v212, v104, v105
  v_cvt_pk_bf16_f32 v213, v106, v107
  v_cvt_pk_bf16_f32 v214, v108, v109
  v_cvt_pk_bf16_f32 v215, v110, v111
  v_cvt_pk_bf16_f32 v216, v112, v113
  v_cvt_pk_bf16_f32 v217, v114, v115
  v_cvt_pk_bf16_f32 v218, v116, v117
  v_cvt_pk_bf16_f32 v219, v118, v119
  ds_write_b64 v142, v[212:213] offset:2048
  ds_write_b64 v143, v[214:215] offset:2048
  ds_write_b64 v144, v[216:217] offset:2048
  ds_write_b64 v145, v[218:219] offset:2048
  ds_read_b128 v[228:231], v146 offset:2048
  ds_read_b128 v[232:235], v146 offset:3072
  s_waitcnt lgkmcnt(6)
  s_add_u32 s72, s63, 0
  buffer_store_dwordx4 v[220:223], v193, s[48:51], s72 offen sc1
  s_add_u32 s72, s63, 16384
  buffer_store_dwordx4 v[224:227], v193, s[48:51], s72 offen sc1
  v_cvt_pk_bf16_f32 v212, v56, v57
  v_cvt_pk_bf16_f32 v213, v58, v59
  v_cvt_pk_bf16_f32 v214, v60, v61
  v_cvt_pk_bf16_f32 v215, v62, v63
  v_cvt_pk_bf16_f32 v216, v64, v65
  v_cvt_pk_bf16_f32 v217, v66, v67
  v_cvt_pk_bf16_f32 v218, v68, v69
  v_cvt_pk_bf16_f32 v219, v70, v71
  ds_write_b64 v142, v[212:213] offset:0
  ds_write_b64 v143, v[214:215] offset:0
  ds_write_b64 v144, v[216:217] offset:0
  ds_write_b64 v145, v[218:219] offset:0
  ds_read_b128 v[220:223], v147 offset:0
  ds_read_b128 v[224:227], v148 offset:0
  s_waitcnt lgkmcnt(6)
  s_add_u32 s72, s63, 32768
  buffer_store_dwordx4 v[228:231], v193, s[48:51], s72 offen sc1
  s_add_u32 s72, s63, 49152
  buffer_store_dwordx4 v[232:235], v193, s[48:51], s72 offen sc1
  v_cvt_pk_bf16_f32 v212, v88, v89
  v_cvt_pk_bf16_f32 v213, v90, v91
  v_cvt_pk_bf16_f32 v214, v92, v93
  v_cvt_pk_bf16_f32 v215, v94, v95
  v_cvt_pk_bf16_f32 v216, v96, v97
  v_cvt_pk_bf16_f32 v217, v98, v99
  v_cvt_pk_bf16_f32 v218, v100, v101
  v_cvt_pk_bf16_f32 v219, v102, v103
  ds_write_b64 v142, v[212:213] offset:2048
  ds_write_b64 v143, v[214:215] offset:2048
  ds_write_b64 v144, v[216:217] offset:2048
  ds_write_b64 v145, v[218:219] offset:2048
  ds_read_b128 v[228:231], v147 offset:2048
  ds_read_b128 v[232:235], v148 offset:2048
  s_waitcnt lgkmcnt(6)
  s_add_u32 s72, s64, 0
  buffer_store_dwordx4 v[220:223], v194, s[48:51], s72 offen sc1
  s_add_u32 s72, s64, 65536
  buffer_store_dwordx4 v[224:227], v194, s[48:51], s72 offen sc1
  s_waitcnt lgkmcnt(0)
  s_add_u32 s72, s64, 1024
  buffer_store_dwordx4 v[228:231], v194, s[48:51], s72 offen sc1
  s_add_u32 s72, s64, 66560
  buffer_store_dwordx4 v[232:235], v194, s[48:51], s72 offen sc1
  s_waitcnt vmcnt(4)
  s_mov_b32 s76, s71
  s_mov_b32 s71, 0
  v_mov_b32 v236, 152628
  v_mov_b32 v237, 1
  s_mov_b64 exec, 1
  ds_add_rtn_u32 v237, v236, v237
  s_waitcnt lgkmcnt(0)
  v_readfirstlane_b32 s72, v237
  s_mov_b64 exec, -1
  s_nop 2
  s_cmp_lg_u32 s72, 3
  s_cbranch_scc1 L_nopush_p1h
  v_mov_b32 v237, s34
  s_mov_b64 exec, s[70:71]
  buffer_store_dword v237, v12, s[48:51], 0 offen sc1
  s_mov_b64 exec, -1
L_nopush_p1h:
  s_mov_b32 s70, 0
  s_mov_b32 s71, s76
L_c1_done:
  s_waitcnt vmcnt(0)
  v_mov_b32 v149, 152576
  v_mov_b32 v150, 1
  s_mov_b64 exec, 1
  ds_add_rtn_u32 v150, v149, v150
  s_waitcnt lgkmcnt(0)
  v_readfirstlane_b32 s72, v150
  s_mov_b64 exec, -1
  s_nop 2
  s_cmp_lg_u32 s72, 3
  s_cbranch_scc1 L_nopush_p1
  v_mov_b32 v150, s34
  s_mov_b64 exec, s[70:71]
  buffer_store_dword v150, v12, s[48:51], 0 offen sc1
  s_lshl_b32 s72, s2, 2
  s_add_u32 s72, s72, 0x1280000
  s_mov_b64 exec, 1
  v_mov_b32 v149, 0
  v_mov_b32 v150, s34
  buffer_store_dword v150, v149, s[48:51], s72 offen sc1
  s_mov_b64 exec, -1
L_nopush_p1:
  s_lshl_b32 s61, s36, 2
  s_and_b32 s72, s37, 3
  s_add_u32 s61, s61, s72
  s_lshr_b32 s62, s37, 2
  v_lshrrev_b32 v117, 5, v0
  v_and_b32 v118, 15, v0
  v_xor_b32 v117, v117, v118
  v_lshlrev_b32 v117, 4, v117
  v_and_b32 v118, 31, v0
  v_lshlrev_b32 v118, 8, v118
  s_lshl_b32 s72, s56, 13
  v_add_u32 v118, s72, v118
  v_xor_b32 v119, 0, v117
  v_add_u32 v35, v118, v119
  v_xor_b32 v119, 32, v117
  v_add_u32 v36, v118, v119
  v_xor_b32 v119, 64, v117
  v_add_u32 v37, v118, v119
  v_xor_b32 v119, 96, v117
  v_add_u32 v38, v118, v119
  v_xor_b32 v119, 128, v117
  v_add_u32 v39, v118, v119
  v_xor_b32 v119, 160, v117
  v_add_u32 v40, v118, v119
  v_xor_b32 v119, 192, v117
  v_add_u32 v41, v118, v119
  v_xor_b32 v119, 224, v117
  v_add_u32 v42, v118, v119
  v_lshrrev_b32 v120, 5, v0
  v_lshlrev_b32 v120, 3, v120
  v_bfe_u32 v121, v0, 2, 2
  v_add_u32 v120, v120, v121
  v_lshlrev_b32 v120, 7, v120
  v_and_b32 v121, 1, v0
  v_lshlrev_b32 v121, 3, v121
  v_add_u32 v120, v120, v121
  v_bfe_u32 v121, v0, 4, 1
  v_lshlrev_b32 v121, 1, v121
  v_bfe_u32 v122, v0, 1, 1
  v_add_u32 v121, v121, v122
  s_lshl_b32 s72, s57, 2
  v_add_u32 v121, s72, v121
  v_bfe_u32 v122, v0, 3, 1
  v_lshlrev_b32 v122, 2, v122
  v_xor_b32 v121, v121, v122
  v_lshlrev_b32 v121, 4, v121
  v_add_u32 v43, v120, v121
  v_add_u32 v43, 0x10000, v43
  v_add_u32 v44, 0xffff0000, v43
  s_lshl_b32 s72, s35, 12
  s_add_u32 s72, s72, 131072
  v_and_b32 v117, 31, v0
  v_lshlrev_b32 v117, 6, v117
  v_lshrrev_b32 v118, 5, v0
  v_lshlrev_b32 v118, 3, v118
  v_add_u32 v117, v117, v118
  v_add_u32 v117, s72, v117
  v_bfe_u32 v118, v0, 1, 2
  v_lshlrev_b32 v118, 4, v118
  v_add_u32 v117, v117, v118
  v_xor_b32 v112, 0, v117
  v_xor_b32 v113, 16, v117
  v_xor_b32 v114, 32, v117
  v_xor_b32 v115, 48, v117
  v_lshrrev_b32 v117, 2, v0
  v_lshlrev_b32 v117, 6, v117
  v_bfe_u32 v118, v0, 3, 2
  v_and_b32 v116, 3, v0
  v_xor_b32 v118, v118, v116
  v_lshlrev_b32 v118, 4, v118
  v_add_u32 v117, v117, v118
  v_add_u32 v116, s72, v117
  s_lshr_b32 s72, s61, 1
  v_mov_b32 v120, s72
  v_and_b32 v117, 3, v0
  v_lshlrev_b32 v117, 3, v117
  v_and_b32 v119, 7, v120
  v_add_u32 v117, v117, v119
  v_lshlrev_b32 v117, 3, v117
  v_lshrrev_b32 v119, 2, v0
  v_lshlrev_b32 v119, 1, v119
  v_add_u32 v117, v117, v119
  v_lshrrev_b32 v119, 3, v120
  v_add_u32 v117, v117, v119
  s_and_b32 s72, s61, 1
  s_lshl_b32 s72, s72, 3
  s_add_u32 s72, s72, s62
  v_mov_b32 v118, s72
  v_lshlrev_b32 v12, 7, v117
  v_lshlrev_b32 v118, 2, v118
  v_add_u32 v12, v12, v118
  v_add_u32 v12, 0x1218000, v12
  s_mov_b32 s70, 0x7fff
  s_mov_b32 s71, 0
  s_mov_b32 s69, s61
  v_bfe_u32 v120, v0, 3, 2
  s_lshl_b32 s72, s62, 2
  v_add_u32 v120, s72, v120
  v_and_b32 v121, 7, v0
  v_lshlrev_b32 v117, 2, v121
  v_and_b32 v119, 3, v120
  v_or_b32 v117, v117, v119
  v_lshlrev_b32 v117, 3, v117
  v_lshrrev_b32 v119, 2, v120
  v_add_u32 v117, v117, v119
  v_mov_b32 v118, s69
  v_lshlrev_b32 v13, 7, v117
  v_lshlrev_b32 v118, 2, v118
  v_add_u32 v13, v13, v118
  v_add_u32 v13, 0x1238000, v13
  v_lshrrev_b32 v152, 2, v0
  v_mul_u32_u24 v152, 1024, v152
  v_and_b32 v117, 3, v0
  v_lshlrev_b32 v117, 4, v117
  v_add_u32 v117, v117, v152
  s_lshl_b32 s63, s61, 1
  s_add_u32 s63, s63, s56
  s_lshl_b32 s63, s63, 15
  s_lshl_b32 s79, s62, 1
  s_add_u32 s79, s79, s57
  s_lshl_b32 s79, s79, 6
  s_add_u32 s63, s63, s79
  s_mov_b32 s52, s8
  s_mov_b32 s53, s9
  s_mov_b32 s54, 0x200000
  s_mov_b32 s55, 0x20000
  buffer_load_dwordx4 v[120:123], v117, s[52:55], s63 offen
  s_add_u32 s72, s63, 16384
  buffer_load_dwordx4 v[124:127], v117, s[52:55], s72 offen
  s_mov_b32 s64, 0xffff
  s_cmp_eq_u32 s61, 0
  s_cselect_b32 s64, 0xff, s64
  s_cmp_eq_u32 s61, 31
  s_cselect_b32 s64, 0xff, s64
  v_and_b32 v170, 31, v0
  v_lshlrev_b32 v170, 5, v170
  v_lshrrev_b32 v171, 5, v0
  v_lshlrev_b32 v171, 4, v171
  v_add_u32 v170, v170, v171
  s_lshl_b32 s72, s69, 16
  s_lshl_b32 s73, s62, 13
  s_add_u32 s72, s72, s73
  s_lshl_b32 s73, s35, 10
  s_add_u32 s76, s72, s73
  s_add_u32 s68, s76, 0x800000
  v_mov_b32 v168, 0x3fb8aa3b
  v_mov_b32 v169, 0xbfb8aa3b
  v_lshrrev_b32 v172, 5, v0
  v_lshlrev_b32 v172, 3, v172
  v_bfe_u32 v173, v0, 2, 2
  v_add_u32 v172, v172, v173
  v_lshlrev_b32 v172, 5, v172
  v_and_b32 v173, 3, v0
  v_lshlrev_b32 v173, 3, v173
  v_add_u32 v172, v172, v173
  s_and_b32 s72, s69, 1
  s_lshl_b32 s72, s72, 9
  s_add_u32 s72, s72, 153088
  v_add_u32 v172, s72, v172
  v_mov_b32 v190, 0x3f803f80
  v_lshrrev_b32 v191, 2, v0
  v_lshlrev_b32 v191, 3, v191
  s_lshl_b32 s72, s61, 1
  s_add_u32 s72, s72, s56
  s_lshl_b32 s72, s72, 4
  s_lshl_b32 s73, s62, 1
  s_add_u32 s72, s72, s73
  s_add_u32 s72, s72, s57
  s_lshl_b32 s72, s72, 8
  s_add_u32 s65, s72, 0x1240000
  s_add_u32 s66, s63, 0x600000
  s_add_u32 s67, s63, 0x604000
  s_waitcnt vmcnt(0)
  v_lshlrev_b32 v174, 16, v120
  v_and_b32 v175, 0xffff0000, v120
  v_lshlrev_b32 v176, 16, v121
  v_and_b32 v177, 0xffff0000, v121
  v_lshlrev_b32 v178, 16, v122
  v_and_b32 v179, 0xffff0000, v122
  v_lshlrev_b32 v180, 16, v123
  v_and_b32 v181, 0xffff0000, v123
  v_lshlrev_b32 v182, 16, v124
  v_and_b32 v183, 0xffff0000, v124
  v_lshlrev_b32 v184, 16, v125
  v_and_b32 v185, 0xffff0000, v125
  v_lshlrev_b32 v186, 16, v126
  v_and_b32 v187, 0xffff0000, v126
  v_lshlrev_b32 v188, 16, v127
  v_and_b32 v189, 0xffff0000, v127
  s_cmp_lg_u32 s35, 0
  s_nop 0
  s_cbranch_scc1 L_poll_p2_done
  v_and_b32 v192, 31, v0
  v_lshlrev_b32 v192, 2, v192
  s_lshl_b32 s72, s2, 7
  s_add_u32 s72, s72, 0x1210000
  s_mov_b32 s73, 0x20000
  s_waitcnt vmcnt(0)
L_poll_p2:
  buffer_load_dword v2, v192, s[48:51], s72 offen sc1
  s_waitcnt vmcnt(0)
  v_cmp_ne_u32 vcc, s34, v2
  s_nop 3
  s_and_b32 s74, vcc_lo, s64
  s_cbranch_scc0 L_poll_p2_done
  s_sub_u32 s73, s73, 1
  s_cmp_lg_u32 s73, 0
  s_cbranch_scc1 L_poll_p2
L_poll_p2_done:
  s_barrier
  s_barrier
  ds_read_b64_tr_b16 v[72:73], v43 offset:0
  ds_read_b64_tr_b16 v[74:75], v43 offset:512
  ds_read_b128 v[48:51], v35 offset:0
  ds_read_b64_tr_b16 v[76:77], v43 offset:2048
  ds_read_b64_tr_b16 v[78:79], v43 offset:2560
  ds_read_b128 v[52:55], v36 offset:0
  ds_read_b64_tr_b16 v[80:81], v43 offset:4096
  ds_read_b64_tr_b16 v[82:83], v43 offset:4608
  ds_read_b128 v[56:59], v37 offset:0
  ds_read_b64_tr_b16 v[84:85], v43 offset:6144
  ds_read_b64_tr_b16 v[86:87], v43 offset:6656
  ds_read_b128 v[60:63], v38 offset:0
  ds_read_b64_tr_b16 v[88:89], v43 offset:8192
  ds_read_b64_tr_b16 v[90:91], v43 offset:8704
  ds_read_b128 v[64:67], v39 offset:0
  s_waitcnt lgkmcnt(12)
  v_mfma_f32_32x32x16_bf16 v[96:111], v[72:75], v[48:51], 0
  ds_read_b64_tr_b16 v[92:93], v43 offset:10240
  ds_read_b64_tr_b16 v[94:95], v43 offset:10752
  ds_read_b128 v[68:71], v40 offset:0
  s_waitcnt lgkmcnt(12)
  v_mfma_f32_32x32x16_bf16 v[96:111], v[76:79], v[52:55], v[96:111]
  ds_read_b64_tr_b16 v[72:73], v43 offset:12288
  ds_read_b64_tr_b16 v[74:75], v43 offset:12800
  ds_read_b128 v[48:51], v41 offset:0
  s_waitcnt lgkmcnt(12)
  v_mfma_f32_32x32x16_bf16 v[96:111], v[80:83], v[56:59], v[96:111]
  ds_read_b64_tr_b16 v[76:77], v43 offset:14336
  ds_read_b64_tr_b16 v[78:79], v43 offset:14848
  ds_read_b128 v[52:55], v42 offset:0
  s_waitcnt lgkmcnt(12)
  v_mfma_f32_32x32x16_bf16 v[96:111], v[84:87], v[60:63], v[96:111]
  s_waitcnt lgkmcnt(0)
  s_barrier
  ds_read_b64_tr_b16 v[80:81], v43 offset:16384
  ds_read_b64_tr_b16 v[82:83], v43 offset:16896
  ds_read_b128 v[56:59], v35 offset:16384
  v_mfma_f32_32x32x16_bf16 v[96:111], v[88:91], v[64:67], v[96:111]
  ds_read_b64_tr_b16 v[84:85], v43 offset:18432
  ds_read_b64_tr_b16 v[86:87], v43 offset:18944
  ds_read_b128 v[60:63], v36 offset:16384
  v_mfma_f32_32x32x16_bf16 v[96:111], v[92:95], v[68:71], v[96:111]
  ds_read_b64_tr_b16 v[88:89], v43 offset:20480
  ds_read_b64_tr_b16 v[90:91], v43 offset:20992
  ds_read_b128 v[64:67], v37 offset:16384
  v_mfma_f32_32x32x16_bf16 v[96:111], v[72:75], v[48:51], v[96:111]
  ds_read_b64_tr_b16 v[92:93], v43 offset:22528
  ds_read_b64_tr_b16 v[94:95], v43 offset:23040
  ds_read_b128 v[68:71], v38 offset:16384
  v_mfma_f32_32x32x16_bf16 v[96:111], v[76:79], v[52:55], v[96:111]
  ds_read_b64_tr_b16 v[72:73], v43 offset:24576
  ds_read_b64_tr_b16 v[74:75], v43 offset:25088
  ds_read_b128 v[48:51], v39 offset:16384
  s_waitcnt lgkmcnt(12)
  v_mfma_f32_32x32x16_bf16 v[96:111], v[80:83], v[56:59], v[96:111]
  ds_read_b64_tr_b16 v[76:77], v43 offset:26624
  ds_read_b64_tr_b16 v[78:79], v43 offset:27136
  ds_read_b128 v[52:55], v40 offset:16384
  s_waitcnt lgkmcnt(12)
  v_mfma_f32_32x32x16_bf16 v[96:111], v[84:87], v[60:63], v[96:111]
  ds_read_b64_tr_b16 v[80:81], v43 offset:28672
  ds_read_b64_tr_b16 v[82:83], v43 offset:29184
  ds_read_b128 v[56:59], v41 offset:16384
  s_waitcnt lgkmcnt(12)
  v_mfma_f32_32x32x16_bf16 v[96:111], v[88:91], v[64:67], v[96:111]
  ds_read_b64_tr_b16 v[84:85], v43 offset:30720
  ds_read_b64_tr_b16 v[86:87], v43 offset:31232
  ds_read_b128 v[60:63], v42 offset:16384
  s_waitcnt lgkmcnt(12)
  v_mfma_f32_32x32x16_bf16 v[96:111], v[92:95], v[68:71], v[96:111]
  s_waitcnt lgkmcnt(0)
  s_barrier
  ds_read_b64_tr_b16 v[88:89], v43 offset:32768
  ds_read_b64_tr_b16 v[90:91], v43 offset:33280
  ds_read_b128 v[64:67], v35 offset:32768
  v_mfma_f32_32x32x16_bf16 v[96:111], v[72:75], v[48:51], v[96:111]
  ds_read_b64_tr_b16 v[92:93], v43 offset:34816
  ds_read_b64_tr_b16 v[94:95], v43 offset:35328
  ds_read_b128 v[68:71], v36 offset:32768
  v_mfma_f32_32x32x16_bf16 v[96:111], v[76:79], v[52:55], v[96:111]
  ds_read_b64_tr_b16 v[72:73], v43 offset:36864
  ds_read_b64_tr_b16 v[74:75], v43 offset:37376
  ds_read_b128 v[48:51], v37 offset:32768
  v_mfma_f32_32x32x16_bf16 v[96:111], v[80:83], v[56:59], v[96:111]
  ds_read_b64_tr_b16 v[76:77], v43 offset:38912
  ds_read_b64_tr_b16 v[78:79], v43 offset:39424
  ds_read_b128 v[52:55], v38 offset:32768
  v_mfma_f32_32x32x16_bf16 v[96:111], v[84:87], v[60:63], v[96:111]
  ds_read_b64_tr_b16 v[80:81], v43 offset:40960
  ds_read_b64_tr_b16 v[82:83], v43 offset:41472
  ds_read_b128 v[56:59], v39 offset:32768
  s_waitcnt lgkmcnt(12)
  v_mfma_f32_32x32x16_bf16 v[96:111], v[88:91], v[64:67], v[96:111]
  ds_read_b64_tr_b16 v[84:85], v43 offset:43008
  ds_read_b64_tr_b16 v[86:87], v43 offset:43520
  ds_read_b128 v[60:63], v40 offset:32768
  s_waitcnt lgkmcnt(12)
  v_mfma_f32_32x32x16_bf16 v[96:111], v[92:95], v[68:71], v[96:111]
  ds_read_b64_tr_b16 v[88:89], v43 offset:45056
  ds_read_b64_tr_b16 v[90:91], v43 offset:45568
  ds_read_b128 v[64:67], v41 offset:32768
  s_waitcnt lgkmcnt(12)
  v_mfma_f32_32x32x16_bf16 v[96:111], v[72:75], v[48:51], v[96:111]
  ds_read_b64_tr_b16 v[92:93], v43 offset:47104
  ds_read_b64_tr_b16 v[94:95], v43 offset:47616
  ds_read_b128 v[68:71], v42 offset:32768
  s_waitcnt lgkmcnt(12)
  v_mfma_f32_32x32x16_bf16 v[96:111], v[76:79], v[52:55], v[96:111]
  s_waitcnt lgkmcnt(0)
  s_barrier
  ds_read_b64_tr_b16 v[72:73], v43 offset:49152
  ds_read_b64_tr_b16 v[74:75], v43 offset:49664
  ds_read_b128 v[48:51], v35 offset:49152
  v_mfma_f32_32x32x16_bf16 v[96:111], v[80:83], v[56:59], v[96:111]
  ds_read_b64_tr_b16 v[76:77], v43 offset:51200
  ds_read_b64_tr_b16 v[78:79], v43 offset:51712
  ds_read_b128 v[52:55], v36 offset:49152
  v_mfma_f32_32x32x16_bf16 v[96:111], v[84:87], v[60:63], v[96:111]
  ds_read_b64_tr_b16 v[80:81], v43 offset:53248
  ds_read_b64_tr_b16 v[82:83], v43 offset:53760
  ds_read_b128 v[56:59], v37 offset:49152
  v_mfma_f32_32x32x16_bf16 v[96:111], v[88:91], v[64:67], v[96:111]
  ds_read_b64_tr_b16 v[84:85], v43 offset:55296
  ds_read_b64_tr_b16 v[86:87], v43 offset:55808
  ds_read_b128 v[60:63], v38 offset:49152
  v_mfma_f32_32x32x16_bf16 v[96:111], v[92:95], v[68:71], v[96:111]
  ds_read_b64_tr_b16 v[88:89], v43 offset:57344
  ds_read_b64_tr_b16 v[90:91], v43 offset:57856
  ds_read_b128 v[64:67], v39 offset:49152
  s_waitcnt lgkmcnt(12)
  v_mfma_f32_32x32x16_bf16 v[96:111], v[72:75], v[48:51], v[96:111]
  ds_read_b64_tr_b16 v[92:93], v43 offset:59392
  ds_read_b64_tr_b16 v[94:95], v43 offset:59904
  ds_read_b128 v[68:71], v40 offset:49152
  s_waitcnt lgkmcnt(12)
  v_mfma_f32_32x32x16_bf16 v[96:111], v[76:79], v[52:55], v[96:111]
  ds_read_b64_tr_b16 v[72:73], v43 offset:61440
  ds_read_b64_tr_b16 v[74:75], v43 offset:61952
  ds_read_b128 v[48:51], v41 offset:49152
  s_waitcnt lgkmcnt(12)
  v_mfma_f32_32x32x16_bf16 v[96:111], v[80:83], v[56:59], v[96:111]
  ds_read_b64_tr_b16 v[76:77], v43 offset:63488
  ds_read_b64_tr_b16 v[78:79], v43 offset:64000
  ds_read_b128 v[52:55], v42 offset:49152
  s_waitcnt lgkmcnt(12)
  v_mfma_f32_32x32x16_bf16 v[96:111], v[84:87], v[60:63], v[96:111]
  s_waitcnt lgkmcnt(9)
  v_mfma_f32_32x32x16_bf16 v[96:111], v[88:91], v[64:67], v[96:111]
  s_waitcnt lgkmcnt(6)
  v_mfma_f32_32x32x16_bf16 v[96:111], v[92:95], v[68:71], v[96:111]
  s_waitcnt lgkmcnt(3)
  v_mfma_f32_32x32x16_bf16 v[96:111], v[72:75], v[48:51], v[96:111]
  s_waitcnt lgkmcnt(0)
  v_mfma_f32_32x32x16_bf16 v[96:111], v[76:79], v[52:55], v[96:111]
  s_nop 11
  v_cvt_pk_bf16_f32 v136, v96, v97
  v_cvt_pk_bf16_f32 v137, v98, v99
  v_cvt_pk_bf16_f32 v138, v100, v101
  v_cvt_pk_bf16_f32 v139, v102, v103
  v_cvt_pk_bf16_f32 v140, v104, v105
  v_cvt_pk_bf16_f32 v141, v106, v107
  v_cvt_pk_bf16_f32 v142, v108, v109
  v_cvt_pk_bf16_f32 v143, v110, v111
  ds_write_b64 v112, v[136:137] offset:0
  ds_write_b64 v113, v[138:139] offset:0
  ds_write_b64 v114, v[140:141] offset:0
  ds_write_b64 v115, v[142:143] offset:0
  ds_read_b128 v[128:131], v116 offset:0
  ds_read_b128 v[132:135], v116 offset:1024
  s_barrier
  s_waitcnt lgkmcnt(0)
  v_lshlrev_b32 v144, 16, v128
  v_and_b32 v145, 0xffff0000, v128
  v_lshlrev_b32 v146, 16, v129
  v_and_b32 v147, 0xffff0000, v129
  v_lshlrev_b32 v148, 16, v130
  v_and_b32 v149, 0xffff0000, v130
  v_lshlrev_b32 v150, 16, v131
  v_and_b32 v151, 0xffff0000, v131
  v_pk_add_f32 v[144:145], v[174:175], v[144:145]
  v_pk_add_f32 v[146:147], v[176:177], v[146:147]
  v_pk_add_f32 v[148:149], v[178:179], v[148:149]
  v_pk_add_f32 v[150:151], v[180:181], v[150:151]
  v_cvt_pk_bf16_f32 v4, v144, v145
  v_cvt_pk_bf16_f32 v5, v146, v147
  v_cvt_pk_bf16_f32 v6, v148, v149
  v_cvt_pk_bf16_f32 v7, v150, v151
  buffer_store_dwordx4 v[4:7], v117, s[48:51], s66 offen sc1
  v_lshlrev_b32 v144, 16, v132
  v_and_b32 v145, 0xffff0000, v132
  v_lshlrev_b32 v146, 16, v133
  v_and_b32 v147, 0xffff0000, v133
  v_lshlrev_b32 v148, 16, v134
  v_and_b32 v149, 0xffff0000, v134
  v_lshlrev_b32 v150, 16, v135
  v_and_b32 v151, 0xffff0000, v135
  v_pk_add_f32 v[144:145], v[182:183], v[144:145]
  v_pk_add_f32 v[146:147], v[184:185], v[146:147]
  v_pk_add_f32 v[148:149], v[186:187], v[148:149]
  v_pk_add_f32 v[150:151], v[188:189], v[150:151]
  v_cvt_pk_bf16_f32 v8, v144, v145
  v_cvt_pk_bf16_f32 v9, v146, v147
  v_cvt_pk_bf16_f32 v10, v148, v149
  v_cvt_pk_bf16_f32 v11, v150, v151
  buffer_store_dwordx4 v[8:11], v117, s[48:51], s67 offen sc1
  v_mov_b32 v128, 0
  v_mov_b32 v129, 0
  v_mov_b32 v130, 0
  v_mov_b32 v131, 0
  v_dot2_f32_bf16 v128, v4, v190, v128
  v_dot2_f32_bf16 v129, v4, v4, v129
  v_dot2_f32_bf16 v130, v8, v190, v130
  v_dot2_f32_bf16 v131, v8, v8, v131
  v_dot2_f32_bf16 v128, v5, v190, v128
  v_dot2_f32_bf16 v129, v5, v5, v129
  v_dot2_f32_bf16 v130, v9, v190, v130
  v_dot2_f32_bf16 v131, v9, v9, v131
  v_dot2_f32_bf16 v128, v6, v190, v128
  v_dot2_f32_bf16 v129, v6, v6, v129
  v_dot2_f32_bf16 v130, v10, v190, v130
  v_dot2_f32_bf16 v131, v10, v10, v131
  v_dot2_f32_bf16 v128, v7, v190, v128
  v_dot2_f32_bf16 v129, v7, v7, v129
  v_dot2_f32_bf16 v130, v11, v190, v130
  v_dot2_f32_bf16 v131, v11, v11, v131
  v_add_f32_dpp v128, v128, v128 quad_perm:[1,0,3,2] row_mask:0xf bank_mask:0xf
  v_add_f32_dpp v129, v129, v129 quad_perm:[1,0,3,2] row_mask:0xf bank_mask:0xf
  v_add_f32_dpp v130, v130, v130 quad_perm:[1,0,3,2] row_mask:0xf bank_mask:0xf
  v_add_f32_dpp v131, v131, v131 quad_perm:[1,0,3,2] row_mask:0xf bank_mask:0xf
  v_add_f32_dpp v128, v128, v128 quad_perm:[2,3,0,1] row_mask:0xf bank_mask:0xf
  v_add_f32_dpp v129, v129, v129 quad_perm:[2,3,0,1] row_mask:0xf bank_mask:0xf
  v_add_f32_dpp v130, v130, v130 quad_perm:[2,3,0,1] row_mask:0xf bank_mask:0xf
  v_add_f32_dpp v131, v131, v131 quad_perm:[2,3,0,1] row_mask:0xf bank_mask:0xf
  s_mov_b32 exec_lo, 0x11111111
  s_mov_b32 exec_hi, 0x11111111
  buffer_store_dwordx2 v[128:129], v191, s[48:51], s65 offen sc1
  buffer_store_dwordx2 v[130:131], v191, s[48:51], s65 offen offset:128 sc1
  s_mov_b64 exec, -1
  v_mov_b32 v192, 152604
  s_mov_b32 s78, 0x100000
  s_nop 0
L_spin9:
  ds_read_b32 v193, v192
  s_waitcnt lgkmcnt(0)
  v_readfirstlane_b32 s79, v193
  s_nop 3
  s_cmp_eq_u32 s79, 1
  s_cbranch_scc1 L_spin9_ok
  s_sub_u32 s78, s78, 1
  s_cmp_lg_u32 s78, 0
  s_cbranch_scc1 L_spin9
L_spin9_ok:
  s_sub_u32 s77, s68, 0x600000
  buffer_load_dwordx4 v[152:155], v170, s[48:51], s77 offen sc1
  s_cmp_eq_u32 s35, 3
  s_cselect_b32 s5, 0, s35
  s_add_u32 s6, s5, 1
  s_cmp_eq_u32 s6, 3
  s_cselect_b32 s6, 0, s6
  s_add_u32 s7, s6, 1
  s_cmp_eq_u32 s7, 3
  s_cselect_b32 s7, 0, s7
  v_lshrrev_b32 v192, 5, v0
  v_bfe_u32 v193, v0, 1, 3
  v_xor_b32 v192, v192, v193
  v_lshlrev_b32 v192, 4, v192
  v_and_b32 v193, 31, v0
  v_lshlrev_b32 v193, 7, v193
  s_lshl_b32 s72, s35, 12
  v_add_u32 v193, s72, v193
  v_xor_b32 v194, 0, v192
  v_add_u32 v14, v193, v194
  v_xor_b32 v194, 32, v192
  v_add_u32 v15, v193, v194
  v_xor_b32 v194, 64, v192
  v_add_u32 v16, v193, v194
  v_xor_b32 v194, 96, v192
  v_add_u32 v17, v193, v194
  v_lshrrev_b32 v192, 5, v0
  v_lshlrev_b32 v192, 3, v192
  v_bfe_u32 v193, v0, 2, 2
  v_add_u32 v192, v192, v193
  v_mul_u32_u24 v192, 192, v192
  v_bfe_u32 v193, v0, 4, 1
  v_lshlrev_b32 v193, 5, v193
  v_add_u32 v192, v192, v193
  v_and_b32 v193, 3, v0
  v_lshlrev_b32 v193, 3, v193
  v_add_u32 v192, v192, v193
  v_add_u32 v192, 0x10000, v192
  s_lshl_b32 s72, s5, 6
  v_add_u32 v18, s72, v192
  v_add_u32 v21, 0xffff0000, v18
  s_lshl_b32 s72, s6, 6
  v_add_u32 v19, s72, v192
  v_add_u32 v22, 0xffff0000, v19
  s_lshl_b32 s72, s7, 6
  v_add_u32 v20, s72, v192
  v_add_u32 v23, 0xffff0000, v20
  s_lshl_b32 s72, s35, 12
  s_add_u32 s72, s72, 131072
  v_and_b32 v192, 31, v0
  v_lshlrev_b32 v192, 6, v192
  v_lshrrev_b32 v193, 5, v0
  v_lshlrev_b32 v193, 3, v193
  v_add_u32 v192, v192, v193
  v_add_u32 v192, s72, v192
  v_bfe_u32 v193, v0, 1, 2
  v_lshlrev_b32 v193, 4, v193
  v_add_u32 v192, v192, v193
  v_xor_b32 v24, 0, v192
  v_xor_b32 v25, 16, v192
  v_xor_b32 v26, 32, v192
  v_xor_b32 v27, 48, v192
  v_lshrrev_b32 v192, 2, v0
  v_lshlrev_b32 v192, 6, v192
  v_bfe_u32 v193, v0, 3, 2
  v_and_b32 v28, 3, v0
  v_xor_b32 v193, v193, v28
  v_lshlrev_b32 v193, 4, v193
  v_add_u32 v192, v192, v193
  v_add_u32 v28, s72, v192
  s_mov_b32 s64, s70
  s_lshl_b32 s72, s38, 1
  v_bfe_u32 v195, v0, 3, 1
  v_add_u32 v195, s72, v195
  v_and_b32 v196, 7, v0
  v_mov_b32 v193, s39
  s_mov_b32 s70, 0xffff
  s_mov_b32 s71, 0
  v_lshlrev_b32 v192, 2, v196
  v_and_b32 v194, 3, v195
  v_or_b32 v192, v192, v194
  v_lshlrev_b32 v192, 3, v192
  v_lshrrev_b32 v194, 2, v195
  v_add_u32 v192, v192, v194
  v_lshlrev_b32 v29, 7, v192
  v_lshlrev_b32 v193, 2, v193
  v_add_u32 v29, v29, v193
  v_add_u32 v29, 0x1220000, v29
  s_mov_b32 s70, s64
  v_lshrrev_b32 v192, 2, v0
  v_mul_u32_u24 v192, 2944, v192
  v_and_b32 v30, 3, v0
  v_lshlrev_b32 v30, 4, v30
  v_add_u32 v30, v30, v192
  s_lshl_b32 s67, s38, 2
  s_add_u32 s67, s67, s35
  s_lshl_b32 s67, s67, 5
  s_mul_i32 s67, s67, 2944
  s_mul_i32 s72, s39, 192
  s_add_u32 s67, s67, s72
  s_add_u32 s67, s67, 0xa00000
  v_lshrrev_b32 v34, 5, v0
  v_lshlrev_b32 v34, 4, v34
  s_lshl_b32 s72, s5, 7
  s_add_u32 s72, s72, 152064
  v_add_u32 v31, s72, v34
  s_lshl_b32 s72, s6, 7
  s_add_u32 s72, s72, 152064
  v_add_u32 v32, s72, v34
  s_lshl_b32 s72, s7, 7
  s_add_u32 s72, s72, 152064
  v_add_u32 v33, s72, v34
  v_and_b32 v34, 31, v0
  v_lshlrev_b32 v34, 3, v34
  s_lshl_b32 s72, s35, 8
  s_add_u32 s72, s72, 155648
  v_add_u32 v34, s72, v34
  s_lshl_b32 s5, s5, 6
  s_lshl_b32 s6, s6, 6
  s_lshl_b32 s7, s7, 6
  s_waitcnt vmcnt(0)
  v_mov_b32 v192, 152580
  v_mov_b32 v193, 1
  s_mov_b64 exec, 1
  ds_add_rtn_u32 v193, v192, v193
  s_waitcnt lgkmcnt(0)
  v_readfirstlane_b32 s72, v193
  s_mov_b64 exec, -1
  s_nop 2
  s_cmp_lg_u32 s72, 3
  s_cbranch_scc1 L_nopush_p2x
  v_mov_b32 v193, s34
  s_mov_b64 exec, s[70:71]
  buffer_store_dword v193, v12, s[48:51], 0 offen sc1
  s_mov_b64 exec, -1
L_nopush_p2x:
  ds_read_b64_tr_b16 v[164:165], v172
  ds_read_b64_tr_b16 v[166:167], v172 offset:128
  s_waitcnt vmcnt(0) lgkmcnt(0)
  v_mfma_f32_32x32x16_bf16 v[48:63], v[164:167], v[152:155], 0
  s_nop 11
  v_max3_f32 v96, v48, v49, v50
  v_max3_f32 v97, -v48, -v49, -v50
  v_max3_f32 v96, v96, v51, v52
  v_max3_f32 v97, v97, -v51, -v52
  v_max3_f32 v96, v96, v53, v54
  v_max3_f32 v97, v97, -v53, -v54
  v_max_f32 v96, v96, v55
  v_max_f32 v97, v97, -v55
  s_nop 1
  v_permlane32_swap_b32 v96, v97
  v_max_f32 v96, v96, v97
  v_mov_b32 v97, v96
  s_nop 1
  v_permlane32_swap_b32 v96, v97
  v_pk_mul_f32 v[96:97], v[96:97], v[168:169] op_sel:[0,1] op_sel_hi:[1,1]
  v_pk_fma_f32 v[80:81], v[48:49], v[168:169], v[96:97] op_sel:[0,0,0] op_sel_hi:[1,0,0]
  v_pk_fma_f32 v[82:83], v[50:51], v[168:169], v[96:97] op_sel:[0,0,0] op_sel_hi:[1,0,0]
  v_pk_fma_f32 v[84:85], v[52:53], v[168:169], v[96:97] op_sel:[0,0,0] op_sel_hi:[1,0,0]
  v_pk_fma_f32 v[86:87], v[54:55], v[168:169], v[96:97] op_sel:[0,0,0] op_sel_hi:[1,0,0]
  v_pk_fma_f32 v[88:89], v[48:49], v[168:169], v[96:97] op_sel:[0,1,1] op_sel_hi:[1,1,1]
  v_pk_fma_f32 v[90:91], v[50:51], v[168:169], v[96:97] op_sel:[0,1,1] op_sel_hi:[1,1,1]
  v_pk_fma_f32 v[92:93], v[52:53], v[168:169], v[96:97] op_sel:[0,1,1] op_sel_hi:[1,1,1]
  v_pk_fma_f32 v[94:95], v[54:55], v[168:169], v[96:97] op_sel:[0,1,1] op_sel_hi:[1,1,1]
  v_exp_f32 v80, v80
  v_exp_f32 v81, v81
  v_exp_f32 v82, v82
  v_exp_f32 v83, v83
  v_exp_f32 v84, v84
  v_exp_f32 v85, v85
  v_exp_f32 v86, v86
  v_exp_f32 v87, v87
  v_exp_f32 v88, v88
  v_exp_f32 v89, v89
  v_exp_f32 v90, v90
  v_exp_f32 v91, v91
  v_exp_f32 v92, v92
  v_exp_f32 v93, v93
  v_exp_f32 v94, v94
  v_exp_f32 v95, v95
  v_pk_add_f32 v[100:101], v[80:81], v[82:83]
  v_pk_add_f32 v[102:103], v[84:85], v[86:87]
  v_pk_add_f32 v[104:105], v[88:89], v[90:91]
  v_pk_add_f32 v[106:107], v[92:93], v[94:95]
  v_pk_add_f32 v[100:101], v[100:101], v[102:103]
  v_pk_add_f32 v[104:105], v[104:105], v[106:107]
  v_add_f32 v98, v100, v101
  v_add_f32 v99, v104, v105
  s_nop 1
  v_permlane32_swap_b32 v98, v99
  v_add_f32 v98, v98, v99
  v_mov_b32 v99, v98
  s_nop 1
  v_permlane32_swap_b32 v98, v99
  v_rcp_f32 v98, v98
  v_rcp_f32 v99, v99
  s_nop 0
  v_pk_mul_f32 v[80:81], v[80:81], v[98:99] op_sel:[0,0] op_sel_hi:[1,0]
  v_pk_mul_f32 v[82:83], v[82:83], v[98:99] op_sel:[0,0] op_sel_hi:[1,0]
  v_pk_mul_f32 v[84:85], v[84:85], v[98:99] op_sel:[0,0] op_sel_hi:[1,0]
  v_pk_mul_f32 v[86:87], v[86:87], v[98:99] op_sel:[0,0] op_sel_hi:[1,0]
  v_pk_mul_f32 v[88:89], v[88:89], v[98:99] op_sel:[0,1] op_sel_hi:[1,1]
  v_pk_mul_f32 v[90:91], v[90:91], v[98:99] op_sel:[0,1] op_sel_hi:[1,1]
  v_pk_mul_f32 v[92:93], v[92:93], v[98:99] op_sel:[0,1] op_sel_hi:[1,1]
  v_pk_mul_f32 v[94:95], v[94:95], v[98:99] op_sel:[0,1] op_sel_hi:[1,1]
  v_cvt_pk_bf16_f32 v100, v80, v81
  v_cvt_pk_bf16_f32 v101, v82, v83
  v_cvt_pk_bf16_f32 v102, v84, v85
  v_cvt_pk_bf16_f32 v103, v86, v87
  v_cvt_pk_bf16_f32 v104, v88, v89
  v_cvt_pk_bf16_f32 v105, v90, v91
  v_cvt_pk_bf16_f32 v106, v92, v93
  v_cvt_pk_bf16_f32 v107, v94, v95
  v_mov_b32 v192, 152600
  s_mov_b32 s78, 0x100000
  s_nop 0
L_spin10:
  ds_read_b32 v193, v192
  s_waitcnt lgkmcnt(0)
  v_readfirstlane_b32 s79, v193
  s_nop 3
  s_cmp_eq_u32 s79, 4
  s_cbranch_scc1 L_spin10_ok
  s_sub_u32 s78, s78, 1
  s_cmp_lg_u32 s78, 0
  s_cbranch_scc1 L_spin10
L_spin10_ok:
  v_lshlrev_b32 v171, 4, v0
  v_add_u32 v171, 159744, v171
  ds_read_b128 v[156:159], v171
  ds_read_b128 v[160:163], v171 offset:1024
  s_waitcnt lgkmcnt(0)
  v_mfma_f32_32x32x16_bf16 v[64:79], v[156:159], v[100:103], 0
  v_mfma_f32_32x32x16_bf16 v[64:79], v[160:163], v[104:107], v[64:79]
  s_nop 11
  v_add_f32 v172, 0x358637bd, v72
  v_rcp_f32 v172, v172
  s_nop 0
  v_mul_f32 v64, v64, v172
  v_mul_f32 v65, v65, v172
  v_mul_f32 v66, v66, v172
  v_mul_f32 v67, v67, v172
  v_mul_f32 v68, v68, v172
  v_mul_f32 v69, v69, v172
  v_mul_f32 v70, v70, v172
  v_mul_f32 v71, v71, v172
  v_cvt_pk_bf16_f32 v48, v64, v65
  v_cvt_pk_bf16_f32 v49, v66, v67
  v_cvt_pk_bf16_f32 v50, v68, v69
  v_cvt_pk_bf16_f32 v51, v70, v71
  s_nop 0
  v_permlane32_swap_b32 v48, v50
  v_permlane32_swap_b32 v49, v51
  buffer_store_dwordx4 v[48:51], v170, s[48:51], s68 offen sc1
  s_cmp_eq_u32 s39, 15
  s_cbranch_scc1 L_c3_idle
  s_mov_b32 s70, 0xffff
  s_mov_b32 s71, 0
  s_mov_b32 s64, 0xffff
  s_cmp_lg_u32 s35, 0
  s_cbranch_scc1 L_poll_p3_done
  v_and_b32 v132, 31, v0
  v_lshlrev_b32 v132, 2, v132
  s_lshl_b32 s72, s2, 7
  s_add_u32 s72, s72, 0x1218000
  s_mov_b32 s73, 0x20000
  s_waitcnt vmcnt(0)
L_poll_p3:
  buffer_load_dword v2, v132, s[48:51], s72 offen sc1
  s_waitcnt vmcnt(0)
  v_cmp_ne_u32 vcc, s34, v2
  s_nop 3
  s_and_b32 s74, vcc_lo, s64
  s_cbranch_scc0 L_poll_p3_done
  s_sub_u32 s73, s73, 1
  s_cmp_lg_u32 s73, 0
  s_cbranch_scc1 L_poll_p3
L_poll_p3_done:
  s_barrier
  s_barrier
  ds_read_b64_tr_b16 v[48:49], v18 offset:0
  ds_read_b64_tr_b16 v[50:51], v18 offset:768
  ds_read_b128 v[36:39], v14 offset:0
  ds_read_b64_tr_b16 v[52:53], v19 offset:0
  ds_read_b64_tr_b16 v[54:55], v19 offset:768
  ds_read_b64_tr_b16 v[56:57], v20 offset:0
  ds_read_b64_tr_b16 v[58:59], v20 offset:768
  ds_read_b64_tr_b16 v[60:61], v18 offset:3072
  ds_read_b64_tr_b16 v[62:63], v18 offset:3840
  ds_read_b128 v[40:43], v15 offset:0
  ds_read_b64_tr_b16 v[64:65], v19 offset:3072
  ds_read_b64_tr_b16 v[66:67], v19 offset:3840
  ds_read_b64_tr_b16 v[68:69], v20 offset:3072
  ds_read_b64_tr_b16 v[70:71], v20 offset:3840
  s_waitcnt lgkmcnt(11)
  v_mfma_f32_32x32x16_bf16 v[84:99], v[48:51], v[36:39], 0
  ds_read_b64_tr_b16 v[72:73], v18 offset:6144
  ds_read_b64_tr_b16 v[74:75], v18 offset:6912
  ds_read_b128 v[44:47], v16 offset:0
  s_waitcnt lgkmcnt(12)
  v_mfma_f32_32x32x16_bf16 v[100:115], v[52:55], v[36:39], 0
  ds_read_b64_tr_b16 v[76:77], v19 offset:6144
  ds_read_b64_tr_b16 v[78:79], v19 offset:6912
  s_waitcnt lgkmcnt(12)
  v_mfma_f32_32x32x16_bf16 v[116:131], v[56:59], v[36:39], 0
  ds_read_b64_tr_b16 v[80:81], v20 offset:6144
  ds_read_b64_tr_b16 v[82:83], v20 offset:6912
  s_waitcnt lgkmcnt(11)
  v_mfma_f32_32x32x16_bf16 v[84:99], v[60:63], v[40:43], v[84:99]
  ds_read_b64_tr_b16 v[48:49], v18 offset:9216
  ds_read_b64_tr_b16 v[50:51], v18 offset:9984
  ds_read_b128 v[36:39], v17 offset:0
  s_waitcnt lgkmcnt(12)
  v_mfma_f32_32x32x16_bf16 v[100:115], v[64:67], v[40:43], v[100:115]
  ds_read_b64_tr_b16 v[52:53], v19 offset:9216
  ds_read_b64_tr_b16 v[54:55], v19 offset:9984
  s_waitcnt lgkmcnt(12)
  v_mfma_f32_32x32x16_bf16 v[116:131], v[68:71], v[40:43], v[116:131]
  ds_read_b64_tr_b16 v[56:57], v20 offset:9216
  ds_read_b64_tr_b16 v[58:59], v20 offset:9984
  s_waitcnt lgkmcnt(11)
  v_mfma_f32_32x32x16_bf16 v[84:99], v[72:75], v[44:47], v[84:99]
  s_waitcnt lgkmcnt(0)
  s_barrier
  s_mov_b32 s76, s70
  s_mov_b32 s77, s71
  s_mov_b32 s70, -1
  s_mov_b32 s71, 0
  s_waitcnt vmcnt(0)
  v_mov_b32 v184, 152584
  v_mov_b32 v185, 1
  s_mov_b64 exec, 1
  ds_add_rtn_u32 v185, v184, v185
  s_waitcnt lgkmcnt(0)
  v_readfirstlane_b32 s72, v185
  s_mov_b64 exec, -1
  s_nop 2
  s_cmp_lg_u32 s72, 7
  s_cbranch_scc1 L_nopush_o_cW3
  v_mov_b32 v185, s34
  s_mov_b64 exec, s[70:71]
  buffer_store_dword v185, v13, s[48:51], 0 offen sc1
  s_mov_b64 exec, -1
L_nopush_o_cW3:
  s_mov_b32 s70, s76
  s_mov_b32 s71, s77
  ds_read_b64_tr_b16 v[60:61], v18 offset:16384
  ds_read_b64_tr_b16 v[62:63], v18 offset:17152
  ds_read_b128 v[40:43], v14 offset:16384
  v_mfma_f32_32x32x16_bf16 v[100:115], v[76:79], v[44:47], v[100:115]
  ds_read_b64_tr_b16 v[64:65], v19 offset:16384
  ds_read_b64_tr_b16 v[66:67], v19 offset:17152
  ds_read_b64_tr_b16 v[68:69], v20 offset:16384
  v_mfma_f32_32x32x16_bf16 v[116:131], v[80:83], v[44:47], v[116:131]
  ds_read_b64_tr_b16 v[70:71], v20 offset:17152
  ds_read_b64_tr_b16 v[72:73], v18 offset:19456
  ds_read_b64_tr_b16 v[74:75], v18 offset:20224
  v_mfma_f32_32x32x16_bf16 v[84:99], v[48:51], v[36:39], v[84:99]
  ds_read_b128 v[44:47], v15 offset:16384
  ds_read_b64_tr_b16 v[76:77], v19 offset:19456
  ds_read_b64_tr_b16 v[78:79], v19 offset:20224
  ds_read_b64_tr_b16 v[80:81], v20 offset:19456
  v_mfma_f32_32x32x16_bf16 v[100:115], v[52:55], v[36:39], v[100:115]
  ds_read_b64_tr_b16 v[82:83], v20 offset:20224
  v_mfma_f32_32x32x16_bf16 v[116:131], v[56:59], v[36:39], v[116:131]
  s_waitcnt lgkmcnt(11)
  v_mfma_f32_32x32x16_bf16 v[84:99], v[60:63], v[40:43], v[84:99]
  ds_read_b64_tr_b16 v[48:49], v18 offset:22528
  ds_read_b64_tr_b16 v[50:51], v18 offset:23296
  ds_read_b128 v[36:39], v16 offset:16384
  s_waitcnt lgkmcnt(12)
  v_mfma_f32_32x32x16_bf16 v[100:115], v[64:67], v[40:43], v[100:115]
  ds_read_b64_tr_b16 v[52:53], v19 offset:22528
  ds_read_b64_tr_b16 v[54:55], v19 offset:23296
  s_waitcnt lgkmcnt(12)
  v_mfma_f32_32x32x16_bf16 v[116:131], v[68:71], v[40:43], v[116:131]
  ds_read_b64_tr_b16 v[56:57], v20 offset:22528
  ds_read_b64_tr_b16 v[58:59], v20 offset:23296
  s_waitcnt lgkmcnt(11)
  v_mfma_f32_32x32x16_bf16 v[84:99], v[72:75], v[44:47], v[84:99]
  ds_read_b64_tr_b16 v[60:61], v18 offset:25600
  ds_read_b64_tr_b16 v[62:63], v18 offset:26368
  ds_read_b128 v[40:43], v17 offset:16384
  s_waitcnt lgkmcnt(12)
  v_mfma_f32_32x32x16_bf16 v[100:115], v[76:79], v[44:47], v[100:115]
  ds_read_b64_tr_b16 v[64:65], v19 offset:25600
  ds_read_b64_tr_b16 v[66:67], v19 offset:26368
  s_waitcnt lgkmcnt(12)
  v_mfma_f32_32x32x16_bf16 v[116:131], v[80:83], v[44:47], v[116:131]
  ds_read_b64_tr_b16 v[68:69], v20 offset:25600
  ds_read_b64_tr_b16 v[70:71], v20 offset:26368
  s_waitcnt lgkmcnt(11)
  v_mfma_f32_32x32x16_bf16 v[84:99], v[48:51], v[36:39], v[84:99]
  s_waitcnt lgkmcnt(0)
  s_barrier
  ds_read_b64_tr_b16 v[72:73], v18 offset:32768
  ds_read_b64_tr_b16 v[74:75], v18 offset:33536
  ds_read_b128 v[44:47], v14 offset:32768
  v_mfma_f32_32x32x16_bf16 v[100:115], v[52:55], v[36:39], v[100:115]
  ds_read_b64_tr_b16 v[76:77], v19 offset:32768
  ds_read_b64_tr_b16 v[78:79], v19 offset:33536
  ds_read_b64_tr_b16 v[80:81], v20 offset:32768
  v_mfma_f32_32x32x16_bf16 v[116:131], v[56:59], v[36:39], v[116:131]
  ds_read_b64_tr_b16 v[82:83], v20 offset:33536
  ds_read_b64_tr_b16 v[48:49], v18 offset:35840
  ds_read_b64_tr_b16 v[50:51], v18 offset:36608
  v_mfma_f32_32x32x16_bf16 v[84:99], v[60:63], v[40:43], v[84:99]
  ds_read_b128 v[36:39], v15 offset:32768
  ds_read_b64_tr_b16 v[52:53], v19 offset:35840
  ds_read_b64_tr_b16 v[54:55], v19 offset:36608
  ds_read_b64_tr_b16 v[56:57], v20 offset:35840
  v_mfma_f32_32x32x16_bf16 v[100:115], v[64:67], v[40:43], v[100:115]
  ds_read_b64_tr_b16 v[58:59], v20 offset:36608
  v_mfma_f32_32x32x16_bf16 v[116:131], v[68:71], v[40:43], v[116:131]
  s_waitcnt lgkmcnt(11)
  v_mfma_f32_32x32x16_bf16 v[84:99], v[72:75], v[44:47], v[84:99]
  ds_read_b64_tr_b16 v[60:61], v18 offset:38912
  ds_read_b64_tr_b16 v[62:63], v18 offset:39680
  ds_read_b128 v[40:43], v16 offset:32768
  s_waitcnt lgkmcnt(12)
  v_mfma_f32_32x32x16_bf16 v[100:115], v[76:79], v[44:47], v[100:115]
  ds_read_b64_tr_b16 v[64:65], v19 offset:38912
  ds_read_b64_tr_b16 v[66:67], v19 offset:39680
  s_waitcnt lgkmcnt(12)
  v_mfma_f32_32x32x16_bf16 v[116:131], v[80:83], v[44:47], v[116:131]
  ds_read_b64_tr_b16 v[68:69], v20 offset:38912
  ds_read_b64_tr_b16 v[70:71], v20 offset:39680
  s_waitcnt lgkmcnt(11)
  v_mfma_f32_32x32x16_bf16 v[84:99], v[48:51], v[36:39], v[84:99]
  ds_read_b64_tr_b16 v[72:73], v18 offset:41984
  ds_read_b64_tr_b16 v[74:75], v18 offset:42752
  ds_read_b128 v[44:47], v17 offset:32768
  s_waitcnt lgkmcnt(12)
  v_mfma_f32_32x32x16_bf16 v[100:115], v[52:55], v[36:39], v[100:115]
  ds_read_b64_tr_b16 v[76:77], v19 offset:41984
  ds_read_b64_tr_b16 v[78:79], v19 offset:42752
  s_waitcnt lgkmcnt(12)
  v_mfma_f32_32x32x16_bf16 v[116:131], v[56:59], v[36:39], v[116:131]
  ds_read_b64_tr_b16 v[80:81], v20 offset:41984
  ds_read_b64_tr_b16 v[82:83], v20 offset:42752
  s_waitcnt lgkmcnt(11)
  v_mfma_f32_32x32x16_bf16 v[84:99], v[60:63], v[40:43], v[84:99]
  s_waitcnt lgkmcnt(0)
  s_barrier
  ds_read_b64_tr_b16 v[48:49], v18 offset:49152
  ds_read_b64_tr_b16 v[50:51], v18 offset:49920
  ds_read_b128 v[36:39], v14 offset:49152
  v_mfma_f32_32x32x16_bf16 v[100:115], v[64:67], v[40:43], v[100:115]
  ds_read_b64_tr_b16 v[52:53], v19 offset:49152
  ds_read_b64_tr_b16 v[54:55], v19 offset:49920
  ds_read_b64_tr_b16 v[56:57], v20 offset:49152
  v_mfma_f32_32x32x16_bf16 v[116:131], v[68:71], v[40:43], v[116:131]
  ds_read_b64_tr_b16 v[58:59], v20 offset:49920
  ds_read_b64_tr_b16 v[60:61], v18 offset:52224
  ds_read_b64_tr_b16 v[62:63], v18 offset:52992
  v_mfma_f32_32x32x16_bf16 v[84:99], v[72:75], v[44:47], v[84:99]
  ds_read_b128 v[40:43], v15 offset:49152
  ds_read_b64_tr_b16 v[64:65], v19 offset:52224
  ds_read_b64_tr_b16 v[66:67], v19 offset:52992
  ds_read_b64_tr_b16 v[68:69], v20 offset:52224
  v_mfma_f32_32x32x16_bf16 v[100:115], v[76:79], v[44:47], v[100:115]
  ds_read_b64_tr_b16 v[70:71], v20 offset:52992
  v_mfma_f32_32x32x16_bf16 v[116:131], v[80:83], v[44:47], v[116:131]
  s_waitcnt lgkmcnt(11)
  v_mfma_f32_32x32x16_bf16 v[84:99], v[48:51], v[36:39], v[84:99]
  ds_read_b64_tr_b16 v[72:73], v18 offset:55296
  ds_read_b64_tr_b16 v[74:75], v18 offset:56064
  ds_read_b128 v[44:47], v16 offset:49152
  s_waitcnt lgkmcnt(12)
  v_mfma_f32_32x32x16_bf16 v[100:115], v[52:55], v[36:39], v[100:115]
  ds_read_b64_tr_b16 v[76:77], v19 offset:55296
  ds_read_b64_tr_b16 v[78:79], v19 offset:56064
  s_waitcnt lgkmcnt(12)
  v_mfma_f32_32x32x16_bf16 v[116:131], v[56:59], v[36:39], v[116:131]
  ds_read_b64_tr_b16 v[80:81], v20 offset:55296
  ds_read_b64_tr_b16 v[82:83], v20 offset:56064
  s_waitcnt lgkmcnt(11)
  v_mfma_f32_32x32x16_bf16 v[84:99], v[60:63], v[40:43], v[84:99]
  ds_read_b64_tr_b16 v[48:49], v18 offset:58368
  ds_read_b64_tr_b16 v[50:51], v18 offset:59136
  ds_read_b128 v[36:39], v17 offset:49152
  s_waitcnt lgkmcnt(12)
  v_mfma_f32_32x32x16_bf16 v[100:115], v[64:67], v[40:43], v[100:115]
  ds_read_b64_tr_b16 v[52:53], v19 offset:58368
  ds_read_b64_tr_b16 v[54:55], v19 offset:59136
  s_waitcnt lgkmcnt(12)
  v_mfma_f32_32x32x16_bf16 v[116:131], v[68:71], v[40:43], v[116:131]
  ds_read_b64_tr_b16 v[56:57], v20 offset:58368
  ds_read_b64_tr_b16 v[58:59], v20 offset:59136
  s_waitcnt lgkmcnt(11)
  v_mfma_f32_32x32x16_bf16 v[84:99], v[72:75], v[44:47], v[84:99]
  s_waitcnt lgkmcnt(0)
  s_barrier
  ds_read_b64_tr_b16 v[60:61], v18 offset:0
  ds_read_b64_tr_b16 v[62:63], v18 offset:768
  ds_read_b128 v[40:43], v14 offset:0
  v_mfma_f32_32x32x16_bf16 v[100:115], v[76:79], v[44:47], v[100:115]
  ds_read_b64_tr_b16 v[64:65], v19 offset:0
  ds_read_b64_tr_b16 v[66:67], v19 offset:768
  ds_read_b64_tr_b16 v[68:69], v20 offset:0
  v_mfma_f32_32x32x16_bf16 v[116:131], v[80:83], v[44:47], v[116:131]
  ds_read_b64_tr_b16 v[70:71], v20 offset:768
  ds_read_b64_tr_b16 v[72:73], v18 offset:3072
  ds_read_b64_tr_b16 v[74:75], v18 offset:3840
  v_mfma_f32_32x32x16_bf16 v[84:99], v[48:51], v[36:39], v[84:99]
  ds_read_b128 v[44:47], v15 offset:0
  ds_read_b64_tr_b16 v[76:77], v19 offset:3072
  ds_read_b64_tr_b16 v[78:79], v19 offset:3840
  ds_read_b64_tr_b16 v[80:81], v20 offset:3072
  v_mfma_f32_32x32x16_bf16 v[100:115], v[52:55], v[36:39], v[100:115]
  ds_read_b64_tr_b16 v[82:83], v20 offset:3840
  v_mfma_f32_32x32x16_bf16 v[116:131], v[56:59], v[36:39], v[116:131]
  s_waitcnt lgkmcnt(11)
  v_mfma_f32_32x32x16_bf16 v[84:99], v[60:63], v[40:43], v[84:99]
  ds_read_b64_tr_b16 v[48:49], v18 offset:6144
  ds_read_b64_tr_b16 v[50:51], v18 offset:6912
  ds_read_b128 v[36:39], v16 offset:0
  s_waitcnt lgkmcnt(12)
  v_mfma_f32_32x32x16_bf16 v[100:115], v[64:67], v[40:43], v[100:115]
  ds_read_b64_tr_b16 v[52:53], v19 offset:6144
  ds_read_b64_tr_b16 v[54:55], v19 offset:6912
  s_waitcnt lgkmcnt(12)
  v_mfma_f32_32x32x16_bf16 v[116:131], v[68:71], v[40:43], v[116:131]
  ds_read_b64_tr_b16 v[56:57], v20 offset:6144
  ds_read_b64_tr_b16 v[58:59], v20 offset:6912
  s_waitcnt lgkmcnt(11)
  v_mfma_f32_32x32x16_bf16 v[84:99], v[72:75], v[44:47], v[84:99]
  ds_read_b64_tr_b16 v[60:61], v18 offset:9216
  ds_read_b64_tr_b16 v[62:63], v18 offset:9984
  ds_read_b128 v[40:43], v17 offset:0
  s_waitcnt lgkmcnt(12)
  v_mfma_f32_32x32x16_bf16 v[100:115], v[76:79], v[44:47], v[100:115]
  ds_read_b64_tr_b16 v[64:65], v19 offset:9216
  ds_read_b64_tr_b16 v[66:67], v19 offset:9984
  s_waitcnt lgkmcnt(12)
  v_mfma_f32_32x32x16_bf16 v[116:131], v[80:83], v[44:47], v[116:131]
  ds_read_b64_tr_b16 v[68:69], v20 offset:9216
  ds_read_b64_tr_b16 v[70:71], v20 offset:9984
  s_waitcnt lgkmcnt(11)
  v_mfma_f32_32x32x16_bf16 v[84:99], v[48:51], v[36:39], v[84:99]
  s_waitcnt lgkmcnt(0)
  s_barrier
  ds_read_b64_tr_b16 v[72:73], v18 offset:16384
  ds_read_b64_tr_b16 v[74:75], v18 offset:17152
  ds_read_b128 v[44:47], v14 offset:16384
  v_mfma_f32_32x32x16_bf16 v[100:115], v[52:55], v[36:39], v[100:115]
  ds_read_b64_tr_b16 v[76:77], v19 offset:16384
  ds_read_b64_tr_b16 v[78:79], v19 offset:17152
  ds_read_b64_tr_b16 v[80:81], v20 offset:16384
  v_mfma_f32_32x32x16_bf16 v[116:131], v[56:59], v[36:39], v[116:131]
  ds_read_b64_tr_b16 v[82:83], v20 offset:17152
  ds_read_b64_tr_b16 v[48:49], v18 offset:19456
  ds_read_b64_tr_b16 v[50:51], v18 offset:20224
  v_mfma_f32_32x32x16_bf16 v[84:99], v[60:63], v[40:43], v[84:99]
  ds_read_b128 v[36:39], v15 offset:16384
  ds_read_b64_tr_b16 v[52:53], v19 offset:19456
  ds_read_b64_tr_b16 v[54:55], v19 offset:20224
  ds_read_b64_tr_b16 v[56:57], v20 offset:19456
  v_mfma_f32_32x32x16_bf16 v[100:115], v[64:67], v[40:43], v[100:115]
  ds_read_b64_tr_b16 v[58:59], v20 offset:20224
  v_mfma_f32_32x32x16_bf16 v[116:131], v[68:71], v[40:43], v[116:131]
  s_waitcnt lgkmcnt(11)
  v_mfma_f32_32x32x16_bf16 v[84:99], v[72:75], v[44:47], v[84:99]
  ds_read_b64_tr_b16 v[60:61], v18 offset:22528
  ds_read_b64_tr_b16 v[62:63], v18 offset:23296
  ds_read_b128 v[40:43], v16 offset:16384
  s_waitcnt lgkmcnt(12)
  v_mfma_f32_32x32x16_bf16 v[100:115], v[76:79], v[44:47], v[100:115]
  ds_read_b64_tr_b16 v[64:65], v19 offset:22528
  ds_read_b64_tr_b16 v[66:67], v19 offset:23296
  s_waitcnt lgkmcnt(12)
  v_mfma_f32_32x32x16_bf16 v[116:131], v[80:83], v[44:47], v[116:131]
  ds_read_b64_tr_b16 v[68:69], v20 offset:22528
  ds_read_b64_tr_b16 v[70:71], v20 offset:23296
  s_waitcnt lgkmcnt(11)
  v_mfma_f32_32x32x16_bf16 v[84:99], v[48:51], v[36:39], v[84:99]
  ds_read_b64_tr_b16 v[72:73], v18 offset:25600
  ds_read_b64_tr_b16 v[74:75], v18 offset:26368
  ds_read_b128 v[44:47], v17 offset:16384
  s_waitcnt lgkmcnt(12)
  v_mfma_f32_32x32x16_bf16 v[100:115], v[52:55], v[36:39], v[100:115]
  ds_read_b64_tr_b16 v[76:77], v19 offset:25600
  ds_read_b64_tr_b16 v[78:79], v19 offset:26368
  s_waitcnt lgkmcnt(12)
  v_mfma_f32_32x32x16_bf16 v[116:131], v[56:59], v[36:39], v[116:131]
  ds_read_b64_tr_b16 v[80:81], v20 offset:25600
  ds_read_b64_tr_b16 v[82:83], v20 offset:26368
  s_waitcnt lgkmcnt(11)
  v_mfma_f32_32x32x16_bf16 v[84:99], v[60:63], v[40:43], v[84:99]
  s_waitcnt lgkmcnt(0)
  s_barrier
  ds_read_b64_tr_b16 v[48:49], v18 offset:32768
  ds_read_b64_tr_b16 v[50:51], v18 offset:33536
  ds_read_b128 v[36:39], v14 offset:32768
  v_mfma_f32_32x32x16_bf16 v[100:115], v[64:67], v[40:43], v[100:115]
  ds_read_b64_tr_b16 v[52:53], v19 offset:32768
  ds_read_b64_tr_b16 v[54:55], v19 offset:33536
  ds_read_b64_tr_b16 v[56:57], v20 offset:32768
  v_mfma_f32_32x32x16_bf16 v[116:131], v[68:71], v[40:43], v[116:131]
  ds_read_b64_tr_b16 v[58:59], v20 offset:33536
  ds_read_b64_tr_b16 v[60:61], v18 offset:35840
  ds_read_b64_tr_b16 v[62:63], v18 offset:36608
  v_mfma_f32_32x32x16_bf16 v[84:99], v[72:75], v[44:47], v[84:99]
  ds_read_b128 v[40:43], v15 offset:32768
  ds_read_b64_tr_b16 v[64:65], v19 offset:35840
  ds_read_b64_tr_b16 v[66:67], v19 offset:36608
  ds_read_b64_tr_b16 v[68:69], v20 offset:35840
  v_mfma_f32_32x32x16_bf16 v[100:115], v[76:79], v[44:47], v[100:115]
  ds_read_b64_tr_b16 v[70:71], v20 offset:36608
  v_mfma_f32_32x32x16_bf16 v[116:131], v[80:83], v[44:47], v[116:131]
  s_waitcnt lgkmcnt(11)
  v_mfma_f32_32x32x16_bf16 v[84:99], v[48:51], v[36:39], v[84:99]
  ds_read_b64_tr_b16 v[72:73], v18 offset:38912
  ds_read_b64_tr_b16 v[74:75], v18 offset:39680
  ds_read_b128 v[44:47], v16 offset:32768
  s_waitcnt lgkmcnt(12)
  v_mfma_f32_32x32x16_bf16 v[100:115], v[52:55], v[36:39], v[100:115]
  ds_read_b64_tr_b16 v[76:77], v19 offset:38912
  ds_read_b64_tr_b16 v[78:79], v19 offset:39680
  s_waitcnt lgkmcnt(12)
  v_mfma_f32_32x32x16_bf16 v[116:131], v[56:59], v[36:39], v[116:131]
  ds_read_b64_tr_b16 v[80:81], v20 offset:38912
  ds_read_b64_tr_b16 v[82:83], v20 offset:39680
  s_waitcnt lgkmcnt(11)
  v_mfma_f32_32x32x16_bf16 v[84:99], v[60:63], v[40:43], v[84:99]
  ds_read_b64_tr_b16 v[48:49], v18 offset:41984
  ds_read_b64_tr_b16 v[50:51], v18 offset:42752
  ds_read_b128 v[36:39], v17 offset:32768
  s_waitcnt lgkmcnt(12)
  v_mfma_f32_32x32x16_bf16 v[100:115], v[64:67], v[40:43], v[100:115]
  ds_read_b64_tr_b16 v[52:53], v19 offset:41984
  ds_read_b64_tr_b16 v[54:55], v19 offset:42752
  s_waitcnt lgkmcnt(12)
  v_mfma_f32_32x32x16_bf16 v[116:131], v[68:71], v[40:43], v[116:131]
  ds_read_b64_tr_b16 v[56:57], v20 offset:41984
  ds_read_b64_tr_b16 v[58:59], v20 offset:42752
  s_waitcnt lgkmcnt(11)
  v_mfma_f32_32x32x16_bf16 v[84:99], v[72:75], v[44:47], v[84:99]
  s_waitcnt lgkmcnt(0)
  s_barrier
  ds_read_b64 v[172:173], v34 offset:0
  ds_read_b64 v[174:175], v34 offset:1024
  ds_read_b64 v[176:177], v34 offset:2048
  ds_read_b64 v[178:179], v34 offset:3072
  s_waitcnt lgkmcnt(0)
  v_add_f32 v172, v172, v174
  v_add_f32 v173, v173, v175
  v_add_f32 v176, v176, v178
  v_add_f32 v177, v177, v179
  v_add_f32 v172, v172, v176
  v_add_f32 v173, v173, v177
  v_mul_f32 v180, 0xbb000000, v172
  v_mul_f32 v184, 0x3b000000, v173
  v_fma_f32 v184, -v180, v180, v184
  v_max_f32 v184, 0, v184
  v_add_f32 v184, 0x3727c5ac, v184
  v_rsq_f32 v185, v184
  v_sqrt_f32 v183, v184
  v_mul_f32 v182, 0xc0135761, v185
  v_mul_f32 v184, v185, v185
  v_mul_f32 v184, v184, v185
  v_mul_f32 v181, 0xbdd2d3e8, v184
  ds_read_b64_tr_b16 v[60:61], v18 offset:49152
  ds_read_b64_tr_b16 v[62:63], v18 offset:49920
  ds_read_b128 v[40:43], v14 offset:49152
  v_mfma_f32_32x32x16_bf16 v[100:115], v[76:79], v[44:47], v[100:115]
  ds_read_b64_tr_b16 v[64:65], v19 offset:49152
  ds_read_b64_tr_b16 v[66:67], v19 offset:49920
  ds_read_b64_tr_b16 v[68:69], v20 offset:49152
  v_mfma_f32_32x32x16_bf16 v[116:131], v[80:83], v[44:47], v[116:131]
  ds_read_b64_tr_b16 v[70:71], v20 offset:49920
  ds_read_b64_tr_b16 v[72:73], v18 offset:52224
  ds_read_b64_tr_b16 v[74:75], v18 offset:52992
  v_mfma_f32_32x32x16_bf16 v[84:99], v[48:51], v[36:39], v[84:99]
  ds_read_b128 v[44:47], v15 offset:49152
  ds_read_b64_tr_b16 v[76:77], v19 offset:52224
  ds_read_b64_tr_b16 v[78:79], v19 offset:52992
  ds_read_b64_tr_b16 v[80:81], v20 offset:52224
  v_mfma_f32_32x32x16_bf16 v[100:115], v[52:55], v[36:39], v[100:115]
  ds_read_b64_tr_b16 v[82:83], v20 offset:52992
  v_mfma_f32_32x32x16_bf16 v[116:131], v[56:59], v[36:39], v[116:131]
  s_waitcnt lgkmcnt(11)
  v_mfma_f32_32x32x16_bf16 v[84:99], v[60:63], v[40:43], v[84:99]
  ds_read_b64_tr_b16 v[48:49], v18 offset:55296
  ds_read_b64_tr_b16 v[50:51], v18 offset:56064
  ds_read_b128 v[36:39], v16 offset:49152
  s_waitcnt lgkmcnt(12)
  v_mfma_f32_32x32x16_bf16 v[100:115], v[64:67], v[40:43], v[100:115]
  ds_read_b64_tr_b16 v[52:53], v19 offset:55296
  ds_read_b64_tr_b16 v[54:55], v19 offset:56064
  s_waitcnt lgkmcnt(12)
  v_mfma_f32_32x32x16_bf16 v[116:131], v[68:71], v[40:43], v[116:131]
  ds_read_b64_tr_b16 v[56:57], v20 offset:55296
  ds_read_b64_tr_b16 v[58:59], v20 offset:56064
  s_waitcnt lgkmcnt(11)
  v_mfma_f32_32x32x16_bf16 v[84:99], v[72:75], v[44:47], v[84:99]
  ds_read_b64_tr_b16 v[60:61], v18 offset:58368
  ds_read_b64_tr_b16 v[62:63], v18 offset:59136
  ds_read_b128 v[40:43], v17 offset:49152
  s_waitcnt lgkmcnt(12)
  v_mfma_f32_32x32x16_bf16 v[100:115], v[76:79], v[44:47], v[100:115]
  ds_read_b64_tr_b16 v[64:65], v19 offset:58368
  ds_read_b64_tr_b16 v[66:67], v19 offset:59136
  s_waitcnt lgkmcnt(12)
  v_mfma_f32_32x32x16_bf16 v[116:131], v[80:83], v[44:47], v[116:131]
  ds_read_b64_tr_b16 v[68:69], v20 offset:58368
  ds_read_b64_tr_b16 v[70:71], v20 offset:59136
  s_waitcnt lgkmcnt(11)
  v_mfma_f32_32x32x16_bf16 v[84:99], v[48:51], v[36:39], v[84:99]
  s_waitcnt lgkmcnt(9)
  v_mfma_f32_32x32x16_bf16 v[100:115], v[52:55], v[36:39], v[100:115]
  s_waitcnt lgkmcnt(7)
  v_mfma_f32_32x32x16_bf16 v[116:131], v[56:59], v[36:39], v[116:131]
  s_waitcnt lgkmcnt(4)
  v_mfma_f32_32x32x16_bf16 v[84:99], v[60:63], v[40:43], v[84:99]
  s_waitcnt lgkmcnt(2)
  v_mfma_f32_32x32x16_bf16 v[100:115], v[64:67], v[40:43], v[100:115]
  s_waitcnt lgkmcnt(0)
  v_mfma_f32_32x32x16_bf16 v[116:131], v[68:71], v[40:43], v[116:131]
  s_barrier
  ds_read_b128 v[36:39], v31 offset:0
  ds_read_b128 v[40:43], v31 offset:32
  ds_read_b128 v[44:47], v31 offset:64
  ds_read_b128 v[48:51], v31 offset:96
  ds_read_b128 v[52:55], v32 offset:0
  ds_read_b128 v[56:59], v32 offset:32
  ds_read_b128 v[60:63], v32 offset:64
  ds_read_b128 v[64:67], v32 offset:96
  ds_read_b128 v[68:71], v33 offset:0
  ds_read_b128 v[72:75], v33 offset:32
  ds_read_b128 v[76:79], v33 offset:64
  ds_read_b128 v[80:83], v33 offset:96
  s_waitcnt lgkmcnt(8)
  v_pk_fma_f32 v[84:85], v[36:37], v[180:181], v[84:85] op_sel:[0,0,0] op_sel_hi:[1,0,1]
  v_pk_fma_f32 v[86:87], v[38:39], v[180:181], v[86:87] op_sel:[0,0,0] op_sel_hi:[1,0,1]
  v_pk_fma_f32 v[88:89], v[40:41], v[180:181], v[88:89] op_sel:[0,0,0] op_sel_hi:[1,0,1]
  v_pk_fma_f32 v[90:91], v[42:43], v[180:181], v[90:91] op_sel:[0,0,0] op_sel_hi:[1,0,1]
  v_pk_fma_f32 v[92:93], v[44:45], v[180:181], v[92:93] op_sel:[0,0,0] op_sel_hi:[1,0,1]
  v_pk_fma_f32 v[94:95], v[46:47], v[180:181], v[94:95] op_sel:[0,0,0] op_sel_hi:[1,0,1]
  v_pk_fma_f32 v[96:97], v[48:49], v[180:181], v[96:97] op_sel:[0,0,0] op_sel_hi:[1,0,1]
  v_pk_fma_f32 v[98:99], v[50:51], v[180:181], v[98:99] op_sel:[0,0,0] op_sel_hi:[1,0,1]
  v_pk_mul_f32 v[156:157], v[84:85], v[84:85]
  v_pk_mul_f32 v[158:159], v[86:87], v[86:87]
  v_pk_mul_f32 v[160:161], v[88:89], v[88:89]
  v_pk_mul_f32 v[162:163], v[90:91], v[90:91]
  v_pk_mul_f32 v[164:165], v[92:93], v[92:93]
  v_pk_mul_f32 v[166:167], v[94:95], v[94:95]
  v_pk_mul_f32 v[168:169], v[96:97], v[96:97]
  v_pk_mul_f32 v[170:171], v[98:99], v[98:99]
  v_pk_fma_f32 v[156:157], v[156:157], v[180:181], v[182:183] op_sel:[0,1,0] op_sel_hi:[1,1,0]
  v_pk_fma_f32 v[158:159], v[158:159], v[180:181], v[182:183] op_sel:[0,1,0] op_sel_hi:[1,1,0]
  v_pk_fma_f32 v[160:161], v[160:161], v[180:181], v[182:183] op_sel:[0,1,0] op_sel_hi:[1,1,0]
  v_pk_fma_f32 v[162:163], v[162:163], v[180:181], v[182:183] op_sel:[0,1,0] op_sel_hi:[1,1,0]
  v_pk_fma_f32 v[164:165], v[164:165], v[180:181], v[182:183] op_sel:[0,1,0] op_sel_hi:[1,1,0]
  v_pk_fma_f32 v[166:167], v[166:167], v[180:181], v[182:183] op_sel:[0,1,0] op_sel_hi:[1,1,0]
  v_pk_fma_f32 v[168:169], v[168:169], v[180:181], v[182:183] op_sel:[0,1,0] op_sel_hi:[1,1,0]
  v_pk_fma_f32 v[170:171], v[170:171], v[180:181], v[182:183] op_sel:[0,1,0] op_sel_hi:[1,1,0]
  v_pk_mul_f32 v[156:157], v[156:157], v[84:85]
  v_pk_mul_f32 v[158:159], v[158:159], v[86:87]
  v_pk_mul_f32 v[160:161], v[160:161], v[88:89]
  v_pk_mul_f32 v[162:163], v[162:163], v[90:91]
  v_pk_mul_f32 v[164:165], v[164:165], v[92:93]
  v_pk_mul_f32 v[166:167], v[166:167], v[94:95]
  v_pk_mul_f32 v[168:169], v[168:169], v[96:97]
  v_pk_mul_f32 v[170:171], v[170:171], v[98:99]
  v_exp_f32 v156, v156
  v_exp_f32 v157, v157
  v_exp_f32 v158, v158
  v_exp_f32 v159, v159
  v_exp_f32 v160, v160
  v_exp_f32 v161, v161
  v_exp_f32 v162, v162
  v_exp_f32 v163, v163
  v_exp_f32 v164, v164
  v_exp_f32 v165, v165
  v_exp_f32 v166, v166
  v_exp_f32 v167, v167
  v_exp_f32 v168, v168
  v_exp_f32 v169, v169
  v_exp_f32 v170, v170
  v_exp_f32 v171, v171
  v_pk_fma_f32 v[156:157], v[156:157], v[182:183], v[182:183] op_sel:[0,1,1] op_sel_hi:[1,1,1]
  v_pk_fma_f32 v[158:159], v[158:159], v[182:183], v[182:183] op_sel:[0,1,1] op_sel_hi:[1,1,1]
  v_pk_fma_f32 v[160:161], v[160:161], v[182:183], v[182:183] op_sel:[0,1,1] op_sel_hi:[1,1,1]
  v_pk_fma_f32 v[162:163], v[162:163], v[182:183], v[182:183] op_sel:[0,1,1] op_sel_hi:[1,1,1]
  v_pk_fma_f32 v[164:165], v[164:165], v[182:183], v[182:183] op_sel:[0,1,1] op_sel_hi:[1,1,1]
  v_pk_fma_f32 v[166:167], v[166:167], v[182:183], v[182:183] op_sel:[0,1,1] op_sel_hi:[1,1,1]
  v_pk_fma_f32 v[168:169], v[168:169], v[182:183], v[182:183] op_sel:[0,1,1] op_sel_hi:[1,1,1]
  v_pk_fma_f32 v[170:171], v[170:171], v[182:183], v[182:183] op_sel:[0,1,1] op_sel_hi:[1,1,1]
  v_rcp_f32 v156, v156
  v_rcp_f32 v157, v157
  v_rcp_f32 v158, v158
  v_rcp_f32 v159, v159
  v_rcp_f32 v160, v160
  v_rcp_f32 v161, v161
  v_rcp_f32 v162, v162
  v_rcp_f32 v163, v163
  v_rcp_f32 v164, v164
  v_rcp_f32 v165, v165
  v_rcp_f32 v166, v166
  v_rcp_f32 v167, v167
  v_rcp_f32 v168, v168
  v_rcp_f32 v169, v169
  v_rcp_f32 v170, v170
  v_rcp_f32 v171, v171
  v_pk_mul_f32 v[84:85], v[84:85], v[156:157]
  v_pk_mul_f32 v[86:87], v[86:87], v[158:159]
  v_pk_mul_f32 v[88:89], v[88:89], v[160:161]
  v_pk_mul_f32 v[90:91], v[90:91], v[162:163]
  v_pk_mul_f32 v[92:93], v[92:93], v[164:165]
  v_pk_mul_f32 v[94:95], v[94:95], v[166:167]
  v_pk_mul_f32 v[96:97], v[96:97], v[168:169]
  v_pk_mul_f32 v[98:99], v[98:99], v[170:171]
  v_cvt_pk_bf16_f32 v132, v84, v85
  v_cvt_pk_bf16_f32 v133, v86, v87
  v_cvt_pk_bf16_f32 v134, v88, v89
  v_cvt_pk_bf16_f32 v135, v90, v91
  v_cvt_pk_bf16_f32 v136, v92, v93
  v_cvt_pk_bf16_f32 v137, v94, v95
  v_cvt_pk_bf16_f32 v138, v96, v97
  v_cvt_pk_bf16_f32 v139, v98, v99
  ds_write_b64 v24, v[132:133] offset:0
  ds_write_b64 v25, v[134:135] offset:0
  ds_write_b64 v26, v[136:137] offset:0
  ds_write_b64 v27, v[138:139] offset:0
  ds_read_b128 v[140:143], v28 offset:0
  ds_read_b128 v[144:147], v28 offset:1024
  s_waitcnt lgkmcnt(6)
  v_pk_fma_f32 v[100:101], v[52:53], v[180:181], v[100:101] op_sel:[0,0,0] op_sel_hi:[1,0,1]
  v_pk_fma_f32 v[102:103], v[54:55], v[180:181], v[102:103] op_sel:[0,0,0] op_sel_hi:[1,0,1]
  v_pk_fma_f32 v[104:105], v[56:57], v[180:181], v[104:105] op_sel:[0,0,0] op_sel_hi:[1,0,1]
  v_pk_fma_f32 v[106:107], v[58:59], v[180:181], v[106:107] op_sel:[0,0,0] op_sel_hi:[1,0,1]
  v_pk_fma_f32 v[108:109], v[60:61], v[180:181], v[108:109] op_sel:[0,0,0] op_sel_hi:[1,0,1]
  v_pk_fma_f32 v[110:111], v[62:63], v[180:181], v[110:111] op_sel:[0,0,0] op_sel_hi:[1,0,1]
  v_pk_fma_f32 v[112:113], v[64:65], v[180:181], v[112:113] op_sel:[0,0,0] op_sel_hi:[1,0,1]
  v_pk_fma_f32 v[114:115], v[66:67], v[180:181], v[114:115] op_sel:[0,0,0] op_sel_hi:[1,0,1]
  v_pk_mul_f32 v[156:157], v[100:101], v[100:101]
  v_pk_mul_f32 v[158:159], v[102:103], v[102:103]
  v_pk_mul_f32 v[160:161], v[104:105], v[104:105]
  v_pk_mul_f32 v[162:163], v[106:107], v[106:107]
  v_pk_mul_f32 v[164:165], v[108:109], v[108:109]
  v_pk_mul_f32 v[166:167], v[110:111], v[110:111]
  v_pk_mul_f32 v[168:169], v[112:113], v[112:113]
  v_pk_mul_f32 v[170:171], v[114:115], v[114:115]
  v_pk_fma_f32 v[156:157], v[156:157], v[180:181], v[182:183] op_sel:[0,1,0] op_sel_hi:[1,1,0]
  v_pk_fma_f32 v[158:159], v[158:159], v[180:181], v[182:183] op_sel:[0,1,0] op_sel_hi:[1,1,0]
  v_pk_fma_f32 v[160:161], v[160:161], v[180:181], v[182:183] op_sel:[0,1,0] op_sel_hi:[1,1,0]
  v_pk_fma_f32 v[162:163], v[162:163], v[180:181], v[182:183] op_sel:[0,1,0] op_sel_hi:[1,1,0]
  v_pk_fma_f32 v[164:165], v[164:165], v[180:181], v[182:183] op_sel:[0,1,0] op_sel_hi:[1,1,0]
  v_pk_fma_f32 v[166:167], v[166:167], v[180:181], v[182:183] op_sel:[0,1,0] op_sel_hi:[1,1,0]
  v_pk_fma_f32 v[168:169], v[168:169], v[180:181], v[182:183] op_sel:[0,1,0] op_sel_hi:[1,1,0]
  v_pk_fma_f32 v[170:171], v[170:171], v[180:181], v[182:183] op_sel:[0,1,0] op_sel_hi:[1,1,0]
  v_pk_mul_f32 v[156:157], v[156:157], v[100:101]
  v_pk_mul_f32 v[158:159], v[158:159], v[102:103]
  v_pk_mul_f32 v[160:161], v[160:161], v[104:105]
  v_pk_mul_f32 v[162:163], v[162:163], v[106:107]
  v_pk_mul_f32 v[164:165], v[164:165], v[108:109]
  v_pk_mul_f32 v[166:167], v[166:167], v[110:111]
  v_pk_mul_f32 v[168:169], v[168:169], v[112:113]
  v_pk_mul_f32 v[170:171], v[170:171], v[114:115]
  v_exp_f32 v156, v156
  v_exp_f32 v157, v157
  v_exp_f32 v158, v158
  v_exp_f32 v159, v159
  v_exp_f32 v160, v160
  v_exp_f32 v161, v161
  v_exp_f32 v162, v162
  v_exp_f32 v163, v163
  v_exp_f32 v164, v164
  v_exp_f32 v165, v165
  v_exp_f32 v166, v166
  v_exp_f32 v167, v167
  v_exp_f32 v168, v168
  v_exp_f32 v169, v169
  v_exp_f32 v170, v170
  v_exp_f32 v171, v171
  v_pk_fma_f32 v[156:157], v[156:157], v[182:183], v[182:183] op_sel:[0,1,1] op_sel_hi:[1,1,1]
  v_pk_fma_f32 v[158:159], v[158:159], v[182:183], v[182:183] op_sel:[0,1,1] op_sel_hi:[1,1,1]
  v_pk_fma_f32 v[160:161], v[160:161], v[182:183], v[182:183] op_sel:[0,1,1] op_sel_hi:[1,1,1]
  v_pk_fma_f32 v[162:163], v[162:163], v[182:183], v[182:183] op_sel:[0,1,1] op_sel_hi:[1,1,1]
  v_pk_fma_f32 v[164:165], v[164:165], v[182:183], v[182:183] op_sel:[0,1,1] op_sel_hi:[1,1,1]
  v_pk_fma_f32 v[166:167], v[166:167], v[182:183], v[182:183] op_sel:[0,1,1] op_sel_hi:[1,1,1]
  v_pk_fma_f32 v[168:169], v[168:169], v[182:183], v[182:183] op_sel:[0,1,1] op_sel_hi:[1,1,1]
  v_pk_fma_f32 v[170:171], v[170:171], v[182:183], v[182:183] op_sel:[0,1,1] op_sel_hi:[1,1,1]
  v_rcp_f32 v156, v156
  v_rcp_f32 v157, v157
  v_rcp_f32 v158, v158
  v_rcp_f32 v159, v159
  v_rcp_f32 v160, v160
  v_rcp_f32 v161, v161
  v_rcp_f32 v162, v162
  v_rcp_f32 v163, v163
  v_rcp_f32 v164, v164
  v_rcp_f32 v165, v165
  v_rcp_f32 v166, v166
  v_rcp_f32 v167, v167
  v_rcp_f32 v168, v168
  v_rcp_f32 v169, v169
  v_rcp_f32 v170, v170
  v_rcp_f32 v171, v171
  v_pk_mul_f32 v[100:101], v[100:101], v[156:157]
  v_pk_mul_f32 v[102:103], v[102:103], v[158:159]
  v_pk_mul_f32 v[104:105], v[104:105], v[160:161]
  v_pk_mul_f32 v[106:107], v[106:107], v[162:163]
  v_pk_mul_f32 v[108:109], v[108:109], v[164:165]
  v_pk_mul_f32 v[110:111], v[110:111], v[166:167]
  v_pk_mul_f32 v[112:113], v[112:113], v[168:169]
  v_pk_mul_f32 v[114:115], v[114:115], v[170:171]
  v_cvt_pk_bf16_f32 v132, v100, v101
  v_cvt_pk_bf16_f32 v133, v102, v103
  v_cvt_pk_bf16_f32 v134, v104, v105
  v_cvt_pk_bf16_f32 v135, v106, v107
  v_cvt_pk_bf16_f32 v136, v108, v109
  v_cvt_pk_bf16_f32 v137, v110, v111
  v_cvt_pk_bf16_f32 v138, v112, v113
  v_cvt_pk_bf16_f32 v139, v114, v115
  ds_write_b64 v24, v[132:133] offset:2048
  ds_write_b64 v25, v[134:135] offset:2048
  ds_write_b64 v26, v[136:137] offset:2048
  ds_write_b64 v27, v[138:139] offset:2048
  ds_read_b128 v[148:151], v28 offset:2048
  ds_read_b128 v[152:155], v28 offset:3072
  s_waitcnt lgkmcnt(6)
  s_add_u32 s72, s67, s5
  buffer_store_dwordx4 v[140:143], v30, s[48:51], s72 offen sc1
  s_add_u32 s72, s67, s5
  s_add_u32 s72, s72, 47104
  buffer_store_dwordx4 v[144:147], v30, s[48:51], s72 offen sc1
  v_pk_fma_f32 v[116:117], v[68:69], v[180:181], v[116:117] op_sel:[0,0,0] op_sel_hi:[1,0,1]
  v_pk_fma_f32 v[118:119], v[70:71], v[180:181], v[118:119] op_sel:[0,0,0] op_sel_hi:[1,0,1]
  v_pk_fma_f32 v[120:121], v[72:73], v[180:181], v[120:121] op_sel:[0,0,0] op_sel_hi:[1,0,1]
  v_pk_fma_f32 v[122:123], v[74:75], v[180:181], v[122:123] op_sel:[0,0,0] op_sel_hi:[1,0,1]
  v_pk_fma_f32 v[124:125], v[76:77], v[180:181], v[124:125] op_sel:[0,0,0] op_sel_hi:[1,0,1]
  v_pk_fma_f32 v[126:127], v[78:79], v[180:181], v[126:127] op_sel:[0,0,0] op_sel_hi:[1,0,1]
  v_pk_fma_f32 v[128:129], v[80:81], v[180:181], v[128:129] op_sel:[0,0,0] op_sel_hi:[1,0,1]
  v_pk_fma_f32 v[130:131], v[82:83], v[180:181], v[130:131] op_sel:[0,0,0] op_sel_hi:[1,0,1]
  v_pk_mul_f32 v[156:157], v[116:117], v[116:117]
  v_pk_mul_f32 v[158:159], v[118:119], v[118:119]
  v_pk_mul_f32 v[160:161], v[120:121], v[120:121]
  v_pk_mul_f32 v[162:163], v[122:123], v[122:123]
  v_pk_mul_f32 v[164:165], v[124:125], v[124:125]
  v_pk_mul_f32 v[166:167], v[126:127], v[126:127]
  v_pk_mul_f32 v[168:169], v[128:129], v[128:129]
  v_pk_mul_f32 v[170:171], v[130:131], v[130:131]
  v_pk_fma_f32 v[156:157], v[156:157], v[180:181], v[182:183] op_sel:[0,1,0] op_sel_hi:[1,1,0]
  v_pk_fma_f32 v[158:159], v[158:159], v[180:181], v[182:183] op_sel:[0,1,0] op_sel_hi:[1,1,0]
  v_pk_fma_f32 v[160:161], v[160:161], v[180:181], v[182:183] op_sel:[0,1,0] op_sel_hi:[1,1,0]
  v_pk_fma_f32 v[162:163], v[162:163], v[180:181], v[182:183] op_sel:[0,1,0] op_sel_hi:[1,1,0]
  v_pk_fma_f32 v[164:165], v[164:165], v[180:181], v[182:183] op_sel:[0,1,0] op_sel_hi:[1,1,0]
  v_pk_fma_f32 v[166:167], v[166:167], v[180:181], v[182:183] op_sel:[0,1,0] op_sel_hi:[1,1,0]
  v_pk_fma_f32 v[168:169], v[168:169], v[180:181], v[182:183] op_sel:[0,1,0] op_sel_hi:[1,1,0]
  v_pk_fma_f32 v[170:171], v[170:171], v[180:181], v[182:183] op_sel:[0,1,0] op_sel_hi:[1,1,0]
  v_pk_mul_f32 v[156:157], v[156:157], v[116:117]
  v_pk_mul_f32 v[158:159], v[158:159], v[118:119]
  v_pk_mul_f32 v[160:161], v[160:161], v[120:121]
  v_pk_mul_f32 v[162:163], v[162:163], v[122:123]
  v_pk_mul_f32 v[164:165], v[164:165], v[124:125]
  v_pk_mul_f32 v[166:167], v[166:167], v[126:127]
  v_pk_mul_f32 v[168:169], v[168:169], v[128:129]
  v_pk_mul_f32 v[170:171], v[170:171], v[130:131]
  v_exp_f32 v156, v156
  v_exp_f32 v157, v157
  v_exp_f32 v158, v158
  v_exp_f32 v159, v159
  v_exp_f32 v160, v160
  v_exp_f32 v161, v161
  v_exp_f32 v162, v162
  v_exp_f32 v163, v163
  v_exp_f32 v164, v164
  v_exp_f32 v165, v165
  v_exp_f32 v166, v166
  v_exp_f32 v167, v167
  v_exp_f32 v168, v168
  v_exp_f32 v169, v169
  v_exp_f32 v170, v170
  v_exp_f32 v171, v171
  v_pk_fma_f32 v[156:157], v[156:157], v[182:183], v[182:183] op_sel:[0,1,1] op_sel_hi:[1,1,1]
  v_pk_fma_f32 v[158:159], v[158:159], v[182:183], v[182:183] op_sel:[0,1,1] op_sel_hi:[1,1,1]
  v_pk_fma_f32 v[160:161], v[160:161], v[182:183], v[182:183] op_sel:[0,1,1] op_sel_hi:[1,1,1]
  v_pk_fma_f32 v[162:163], v[162:163], v[182:183], v[182:183] op_sel:[0,1,1] op_sel_hi:[1,1,1]
  v_pk_fma_f32 v[164:165], v[164:165], v[182:183], v[182:183] op_sel:[0,1,1] op_sel_hi:[1,1,1]
  v_pk_fma_f32 v[166:167], v[166:167], v[182:183], v[182:183] op_sel:[0,1,1] op_sel_hi:[1,1,1]
  v_pk_fma_f32 v[168:169], v[168:169], v[182:183], v[182:183] op_sel:[0,1,1] op_sel_hi:[1,1,1]
  v_pk_fma_f32 v[170:171], v[170:171], v[182:183], v[182:183] op_sel:[0,1,1] op_sel_hi:[1,1,1]
  v_rcp_f32 v156, v156
  v_rcp_f32 v157, v157
  v_rcp_f32 v158, v158
  v_rcp_f32 v159, v159
  v_rcp_f32 v160, v160
  v_rcp_f32 v161, v161
  v_rcp_f32 v162, v162
  v_rcp_f32 v163, v163
  v_rcp_f32 v164, v164
  v_rcp_f32 v165, v165
  v_rcp_f32 v166, v166
  v_rcp_f32 v167, v167
  v_rcp_f32 v168, v168
  v_rcp_f32 v169, v169
  v_rcp_f32 v170, v170
  v_rcp_f32 v171, v171
  v_pk_mul_f32 v[116:117], v[116:117], v[156:157]
  v_pk_mul_f32 v[118:119], v[118:119], v[158:159]
  v_pk_mul_f32 v[120:121], v[120:121], v[160:161]
  v_pk_mul_f32 v[122:123], v[122:123], v[162:163]
  v_pk_mul_f32 v[124:125], v[124:125], v[164:165]
  v_pk_mul_f32 v[126:127], v[126:127], v[166:167]
  v_pk_mul_f32 v[128:129], v[128:129], v[168:169]
  v_pk_mul_f32 v[130:131], v[130:131], v[170:171]
  v_cvt_pk_bf16_f32 v132, v116, v117
  v_cvt_pk_bf16_f32 v133, v118, v119
  v_cvt_pk_bf16_f32 v134, v120, v121
  v_cvt_pk_bf16_f32 v135, v122, v123
  v_cvt_pk_bf16_f32 v136, v124, v125
  v_cvt_pk_bf16_f32 v137, v126, v127
  v_cvt_pk_bf16_f32 v138, v128, v129
  v_cvt_pk_bf16_f32 v139, v130, v131
  ds_write_b64 v24, v[132:133] offset:0
  ds_write_b64 v25, v[134:135] offset:0
  ds_write_b64 v26, v[136:137] offset:0
  ds_write_b64 v27, v[138:139] offset:0
  ds_read_b128 v[140:143], v28 offset:0
  ds_read_b128 v[144:147], v28 offset:1024
  s_waitcnt lgkmcnt(6)
  s_add_u32 s72, s67, s6
  buffer_store_dwordx4 v[148:151], v30, s[48:51], s72 offen sc1
  s_add_u32 s72, s67, s6
  s_add_u32 s72, s72, 47104
  buffer_store_dwordx4 v[152:155], v30, s[48:51], s72 offen sc1
  s_waitcnt lgkmcnt(0)
  s_add_u32 s72, s67, s7
  buffer_store_dwordx4 v[140:143], v30, s[48:51], s72 offen sc1
  s_add_u32 s72, s67, s7
  s_add_u32 s72, s72, 47104
  buffer_store_dwordx4 v[144:147], v30, s[48:51], s72 offen sc1
  s_waitcnt vmcnt(0)
  v_mov_b32 v35, 152588
  v_mov_b32 v36, 1
  s_mov_b64 exec, 1
  ds_add_rtn_u32 v36, v35, v36
  s_waitcnt lgkmcnt(0)
  v_readfirstlane_b32 s72, v36
  s_mov_b64 exec, -1
  s_nop 2
  s_cmp_lg_u32 s72, 3
  s_cbranch_scc1 L_nopush_p3
  v_mov_b32 v36, s34
  s_mov_b64 exec, s[70:71]
  buffer_store_dword v36, v29, s[48:51], 0 offen sc1
  s_mov_b64 exec, -1
L_nopush_p3:
  s_branch L_c4
L_c3_idle:
  s_mov_b32 s76, s70
  s_mov_b32 s77, s71
  s_mov_b32 s70, -1
  s_mov_b32 s71, 0
  s_waitcnt vmcnt(0)
  v_mov_b32 v35, 152584
  v_mov_b32 v36, 1
  s_mov_b64 exec, 1
  ds_add_rtn_u32 v36, v35, v36
  s_waitcnt lgkmcnt(0)
  v_readfirstlane_b32 s72, v36
  s_mov_b64 exec, -1
  s_nop 2
  s_cmp_lg_u32 s72, 7
  s_cbranch_scc1 L_nopush_o_cidle
  v_mov_b32 v36, s34
  s_mov_b64 exec, s[70:71]
  buffer_store_dword v36, v13, s[48:51], 0 offen sc1
  s_mov_b64 exec, -1
L_nopush_o_cidle:
  s_mov_b32 s70, s76
  s_mov_b32 s71, s77
  s_cmp_eq_u32 s38, 15
  s_cbranch_scc1 L_c3_epoch
  s_cmp_eq_u32 s35, 3
  s_cselect_b32 s65, 0, s35
  v_lshrrev_b32 v64, 5, v0
  v_lshlrev_b32 v64, 3, v64
  v_bfe_u32 v65, v0, 2, 2
  v_add_u32 v64, v64, v65
  v_mul_u32_u24 v64, 192, v64
  v_bfe_u32 v65, v0, 4, 1
  v_lshlrev_b32 v65, 5, v65
  v_add_u32 v64, v64, v65
  v_and_b32 v65, 3, v0
  v_lshlrev_b32 v65, 3, v65
  v_add_u32 v64, v64, v65
  s_lshl_b32 s72, s65, 6
  v_add_u32 v35, s72, v64
  v_add_u32 v36, 0x10000, v35
  v_and_b32 v64, 15, v0
  v_bfe_u32 v65, v0, 4, 1
  v_cmp_eq_u32 vcc, v64, v65
  v_mov_b32 v66, 0x3f803f80
  s_nop 0
  v_cndmask_b32 v40, 0, v66, vcc
  v_mov_b32 v41, v40
  v_mov_b32 v42, v40
  v_mov_b32 v43, v40
  v_mov_b32 v64, s38
  v_and_b32 v65, 3, v64
  v_lshlrev_b32 v65, 3, v65
  v_and_b32 v66, 7, v0
  v_add_u32 v65, v65, v66
  v_lshlrev_b32 v65, 3, v65
  v_lshrrev_b32 v66, 2, v64
  v_lshlrev_b32 v66, 1, v66
  v_add_u32 v65, v65, v66
  v_lshrrev_b32 v66, 3, v0
  v_add_u32 v65, v65, v66
  v_mov_b32 v64, 16
  v_lshlrev_b32 v67, 7, v65
  v_lshlrev_b32 v64, 2, v64
  v_add_u32 v67, v67, v64
  v_add_u32 v67, 0x1218000, v67
  s_mov_b32 s70, 0xffff
  s_mov_b32 s71, 0
  s_barrier
  ds_read_b64_tr_b16 v[44:45], v36 offset:0
  ds_read_b64_tr_b16 v[46:47], v36 offset:768
  ds_read_b64_tr_b16 v[48:49], v36 offset:3072
  ds_read_b64_tr_b16 v[50:51], v36 offset:3840
  ds_read_b64_tr_b16 v[52:53], v36 offset:6144
  ds_read_b64_tr_b16 v[54:55], v36 offset:6912
  s_waitcnt lgkmcnt(4)
  v_mfma_f32_16x16x32_bf16 v[60:63], v[44:47], v[40:43], 0
  ds_read_b64_tr_b16 v[56:57], v36 offset:9216
  ds_read_b64_tr_b16 v[58:59], v36 offset:9984
  s_waitcnt lgkmcnt(4)
  v_mfma_f32_16x16x32_bf16 v[60:63], v[48:51], v[40:43], v[60:63]
  ds_read_b64_tr_b16 v[44:45], v36 offset:16384
  ds_read_b64_tr_b16 v[46:47], v36 offset:17152
  s_waitcnt lgkmcnt(4)
  v_mfma_f32_16x16x32_bf16 v[60:63], v[52:55], v[40:43], v[60:63]
  ds_read_b64_tr_b16 v[48:49], v36 offset:19456
  ds_read_b64_tr_b16 v[50:51], v36 offset:20224
  s_waitcnt lgkmcnt(4)
  v_mfma_f32_16x16x32_bf16 v[60:63], v[56:59], v[40:43], v[60:63]
  ds_read_b64_tr_b16 v[52:53], v36 offset:22528
  ds_read_b64_tr_b16 v[54:55], v36 offset:23296
  s_waitcnt lgkmcnt(4)
  v_mfma_f32_16x16x32_bf16 v[60:63], v[44:47], v[40:43], v[60:63]
  ds_read_b64_tr_b16 v[56:57], v36 offset:25600
  ds_read_b64_tr_b16 v[58:59], v36 offset:26368
  s_waitcnt lgkmcnt(4)
  v_mfma_f32_16x16x32_bf16 v[60:63], v[48:51], v[40:43], v[60:63]
  ds_read_b64_tr_b16 v[44:45], v36 offset:32768
  ds_read_b64_tr_b16 v[46:47], v36 offset:33536
  s_waitcnt lgkmcnt(4)
  v_mfma_f32_16x16x32_bf16 v[60:63], v[52:55], v[40:43], v[60:63]
  ds_read_b64_tr_b16 v[48:49], v36 offset:35840
  ds_read_b64_tr_b16 v[50:51], v36 offset:36608
  s_waitcnt lgkmcnt(4)
  v_mfma_f32_16x16x32_bf16 v[60:63], v[56:59], v[40:43], v[60:63]
  ds_read_b64_tr_b16 v[52:53], v36 offset:38912
  ds_read_b64_tr_b16 v[54:55], v36 offset:39680
  s_waitcnt lgkmcnt(4)
  v_mfma_f32_16x16x32_bf16 v[60:63], v[44:47], v[40:43], v[60:63]
  ds_read_b64_tr_b16 v[56:57], v36 offset:41984
  ds_read_b64_tr_b16 v[58:59], v36 offset:42752
  s_waitcnt lgkmcnt(4)
  v_mfma_f32_16x16x32_bf16 v[60:63], v[48:51], v[40:43], v[60:63]
  ds_read_b64_tr_b16 v[44:45], v36 offset:49152
  ds_read_b64_tr_b16 v[46:47], v36 offset:49920
  s_waitcnt lgkmcnt(4)
  v_mfma_f32_16x16x32_bf16 v[60:63], v[52:55], v[40:43], v[60:63]
  ds_read_b64_tr_b16 v[48:49], v36 offset:52224
  ds_read_b64_tr_b16 v[50:51], v36 offset:52992
  s_waitcnt lgkmcnt(4)
  v_mfma_f32_16x16x32_bf16 v[60:63], v[56:59], v[40:43], v[60:63]
  ds_read_b64_tr_b16 v[52:53], v36 offset:55296
  ds_read_b64_tr_b16 v[54:55], v36 offset:56064
  s_waitcnt lgkmcnt(4)
  v_mfma_f32_16x16x32_bf16 v[60:63], v[44:47], v[40:43], v[60:63]
  ds_read_b64_tr_b16 v[56:57], v36 offset:58368
  ds_read_b64_tr_b16 v[58:59], v36 offset:59136
  s_waitcnt lgkmcnt(4)
  v_mfma_f32_16x16x32_bf16 v[60:63], v[48:51], v[40:43], v[60:63]
  ds_read_b64_tr_b16 v[44:45], v35 offset:16384
  ds_read_b64_tr_b16 v[46:47], v35 offset:17152
  s_waitcnt lgkmcnt(4)
  v_mfma_f32_16x16x32_bf16 v[60:63], v[52:55], v[40:43], v[60:63]
  ds_read_b64_tr_b16 v[48:49], v35 offset:19456
  ds_read_b64_tr_b16 v[50:51], v35 offset:20224
  s_waitcnt lgkmcnt(4)
  v_mfma_f32_16x16x32_bf16 v[60:63], v[56:59], v[40:43], v[60:63]
  ds_read_b64_tr_b16 v[52:53], v35 offset:22528
  ds_read_b64_tr_b16 v[54:55], v35 offset:23296
  s_waitcnt lgkmcnt(4)
  v_mfma_f32_16x16x32_bf16 v[60:63], v[44:47], v[40:43], v[60:63]
  ds_read_b64_tr_b16 v[56:57], v35 offset:25600
  ds_read_b64_tr_b16 v[58:59], v35 offset:26368
  s_waitcnt lgkmcnt(4)
  v_mfma_f32_16x16x32_bf16 v[60:63], v[48:51], v[40:43], v[60:63]
  ds_read_b64_tr_b16 v[44:45], v35 offset:32768
  ds_read_b64_tr_b16 v[46:47], v35 offset:33536
  s_waitcnt lgkmcnt(4)
  v_mfma_f32_16x16x32_bf16 v[60:63], v[52:55], v[40:43], v[60:63]
  ds_read_b64_tr_b16 v[48:49], v35 offset:35840
  ds_read_b64_tr_b16 v[50:51], v35 offset:36608
  s_waitcnt lgkmcnt(4)
  v_mfma_f32_16x16x32_bf16 v[60:63], v[56:59], v[40:43], v[60:63]
  ds_read_b64_tr_b16 v[52:53], v35 offset:38912
  ds_read_b64_tr_b16 v[54:55], v35 offset:39680
  s_waitcnt lgkmcnt(4)
  v_mfma_f32_16x16x32_bf16 v[60:63], v[44:47], v[40:43], v[60:63]
  ds_read_b64_tr_b16 v[56:57], v35 offset:41984
  ds_read_b64_tr_b16 v[58:59], v35 offset:42752
  s_waitcnt lgkmcnt(4)
  v_mfma_f32_16x16x32_bf16 v[60:63], v[48:51], v[40:43], v[60:63]
  ds_read_b64_tr_b16 v[44:45], v35 offset:49152
  ds_read_b64_tr_b16 v[46:47], v35 offset:49920
  s_waitcnt lgkmcnt(4)
  v_mfma_f32_16x16x32_bf16 v[60:63], v[52:55], v[40:43], v[60:63]
  ds_read_b64_tr_b16 v[48:49], v35 offset:52224
  ds_read_b64_tr_b16 v[50:51], v35 offset:52992
  s_waitcnt lgkmcnt(4)
  v_mfma_f32_16x16x32_bf16 v[60:63], v[56:59], v[40:43], v[60:63]
  ds_read_b64_tr_b16 v[52:53], v35 offset:55296
  ds_read_b64_tr_b16 v[54:55], v35 offset:56064
  s_waitcnt lgkmcnt(4)
  v_mfma_f32_16x16x32_bf16 v[60:63], v[44:47], v[40:43], v[60:63]
  ds_read_b64_tr_b16 v[56:57], v35 offset:58368
  ds_read_b64_tr_b16 v[58:59], v35 offset:59136
  s_waitcnt lgkmcnt(4)
  v_mfma_f32_16x16x32_bf16 v[60:63], v[48:51], v[40:43], v[60:63]
  ds_read_b64_tr_b16 v[44:45], v35 offset:0
  ds_read_b64_tr_b16 v[46:47], v35 offset:768
  s_waitcnt lgkmcnt(4)
  v_mfma_f32_16x16x32_bf16 v[60:63], v[52:55], v[40:43], v[60:63]
  ds_read_b64_tr_b16 v[48:49], v35 offset:3072
  ds_read_b64_tr_b16 v[50:51], v35 offset:3840
  s_waitcnt lgkmcnt(4)
  v_mfma_f32_16x16x32_bf16 v[60:63], v[56:59], v[40:43], v[60:63]
  ds_read_b64_tr_b16 v[52:53], v35 offset:6144
  ds_read_b64_tr_b16 v[54:55], v35 offset:6912
  s_waitcnt lgkmcnt(4)
  v_mfma_f32_16x16x32_bf16 v[60:63], v[44:47], v[40:43], v[60:63]
  ds_read_b64_tr_b16 v[56:57], v35 offset:9216
  ds_read_b64_tr_b16 v[58:59], v35 offset:9984
  s_waitcnt lgkmcnt(4)
  v_mfma_f32_16x16x32_bf16 v[60:63], v[48:51], v[40:43], v[60:63]
  s_waitcnt lgkmcnt(2)
  v_mfma_f32_16x16x32_bf16 v[60:63], v[52:55], v[40:43], v[60:63]
  s_waitcnt lgkmcnt(0)
  v_mfma_f32_16x16x32_bf16 v[60:63], v[56:59], v[40:43], v[60:63]
  s_mul_i32 s74, s38, 384
  s_lshl_b32 s72, s65, 7
  s_add_u32 s74, s74, s72
  s_add_u32 s74, s74, 0x1208000
  v_and_b32 v68, 1, v0
  v_lshlrev_b32 v68, 6, v68
  v_lshrrev_b32 v69, 4, v0
  v_lshlrev_b32 v69, 4, v69
  v_add_u32 v68, v68, v69
  s_cmp_eq_u32 s35, 3
  s_nop 0
  s_cbranch_scc1 L_cs3_nost
  s_mov_b32 exec_lo, 0x30003
  s_mov_b32 exec_hi, 0x30003
  buffer_store_dwordx4 v[60:63], v68, s[48:51], s74 offen sc1
  s_mov_b64 exec, -1
  s_nop 0
L_cs3_nost:
  s_waitcnt vmcnt(0)
  v_mov_b32 v70, 152624
  v_mov_b32 v71, 1
  s_mov_b64 exec, 1
  ds_add_rtn_u32 v71, v70, v71
  s_waitcnt lgkmcnt(0)
  v_readfirstlane_b32 s72, v71
  s_mov_b64 exec, -1
  s_nop 2
  s_cmp_lg_u32 s72, 3
  s_cbranch_scc1 L_nopush_cs3
  v_mov_b32 v71, s34
  s_mov_b64 exec, s[70:71]
  buffer_store_dword v71, v67, s[48:51], 0 offen sc1
  s_mov_b64 exec, -1
L_nopush_cs3:
  s_barrier
  s_branch L_c4
L_c3_epoch:
  s_cmp_lg_u32 s35, 1
  s_cbranch_scc1 L_c4
  v_lshlrev_b32 v35, 4, v0
  s_mov_b32 s72, 0x1280000
  s_mov_b32 s73, 0x40000
L_ep_poll:
  buffer_load_dwordx4 v[36:39], v35, s[48:51], s72 offen sc1
  s_waitcnt vmcnt(0)
  v_xor_b32 v36, s34, v36
  v_xor_b32 v37, s34, v37
  v_xor_b32 v38, s34, v38
  v_xor_b32 v39, s34, v39
  v_or_b32 v36, v36, v37
  v_or_b32 v38, v38, v39
  v_or_b32 v36, v36, v38
  v_cmp_ne_u32 vcc, 0, v36
  s_nop 3
  s_cmp_eq_u64 vcc, 0
  s_cbranch_scc1 L_ep_go
  s_sub_u32 s73, s73, 1
  s_cmp_lg_u32 s73, 0
  s_cbranch_scc1 L_ep_poll
  s_branch L_c4
L_ep_go:
  v_mov_b32 v35, 0
  v_mov_b32 v36, s34
  s_mov_b32 s72, 0x1281000
  s_mov_b64 exec, 1
  buffer_store_dword v36, v35, s[48:51], s72 offen sc1
  s_mov_b64 exec, -1
L_c4:
  v_lshrrev_b32 v88, 5, v0
  v_and_b32 v89, 15, v0
  v_xor_b32 v88, v88, v89
  v_lshlrev_b32 v88, 4, v88
  v_and_b32 v89, 31, v0
  v_lshlrev_b32 v89, 8, v89
  s_lshl_b32 s72, s56, 13
  v_add_u32 v89, s72, v89
  v_xor_b32 v90, 0, v88
  v_add_u32 v14, v89, v90
  v_xor_b32 v90, 32, v88
  v_add_u32 v15, v89, v90
  v_xor_b32 v90, 64, v88
  v_add_u32 v16, v89, v90
  v_xor_b32 v90, 96, v88
  v_add_u32 v17, v89, v90
  v_xor_b32 v90, 128, v88
  v_add_u32 v18, v89, v90
  v_xor_b32 v90, 160, v88
  v_add_u32 v19, v89, v90
  v_xor_b32 v90, 192, v88
  v_add_u32 v20, v89, v90
  v_xor_b32 v90, 224, v88
  v_add_u32 v21, v89, v90
  v_lshrrev_b32 v91, 5, v0
  v_lshlrev_b32 v91, 3, v91
  v_bfe_u32 v92, v0, 2, 2
  v_add_u32 v91, v91, v92
  v_lshlrev_b32 v91, 7, v91
  v_and_b32 v92, 1, v0
  v_lshlrev_b32 v92, 3, v92
  v_add_u32 v91, v91, v92
  v_bfe_u32 v92, v0, 4, 1
  v_lshlrev_b32 v92, 1, v92
  v_bfe_u32 v93, v0, 1, 1
  v_add_u32 v92, v92, v93
  s_lshl_b32 s72, s57, 2
  v_add_u32 v92, s72, v92
  v_bfe_u32 v93, v0, 3, 1
  v_lshlrev_b32 v93, 2, v93
  v_xor_b32 v92, v92, v93
  v_lshlrev_b32 v92, 4, v92
  v_add_u32 v22, v91, v92
  v_add_u32 v22, 0x10000, v22
  v_add_u32 v23, 0xffff0000, v22
  v_lshrrev_b32 v156, 2, v0
  v_mul_u32_u24 v156, 1024, v156
  v_and_b32 v88, 3, v0
  v_lshlrev_b32 v88, 4, v88
  v_add_u32 v88, v88, v156
  s_lshl_b32 s63, s61, 1
  s_add_u32 s63, s63, s56
  s_lshl_b32 s63, s63, 15
  s_lshl_b32 s79, s62, 1
  s_add_u32 s79, s79, s57
  s_lshl_b32 s79, s79, 6
  s_add_u32 s63, s63, s79
  s_lshl_b32 s72, s35, 12
  s_add_u32 s72, s72, 131072
  v_and_b32 v123, 31, v0
  v_lshlrev_b32 v123, 7, v123
  v_add_u32 v123, s72, v123
  v_lshrrev_b32 v124, 5, v0
  v_and_b32 v113, 7, v0
  v_xor_b32 v124, v124, v113
  v_lshlrev_b32 v124, 4, v124
  v_xor_b32 v113, 0, v124
  v_add_u32 v113, v113, v123
  v_xor_b32 v114, 32, v124
  v_add_u32 v114, v114, v123
  v_xor_b32 v115, 64, v124
  v_add_u32 v115, v115, v123
  v_xor_b32 v116, 96, v124
  v_add_u32 v116, v116, v123
  v_lshrrev_b32 v123, 2, v0
  v_and_b32 v124, 7, v123
  v_lshlrev_b32 v123, 7, v123
  v_add_u32 v123, s72, v123
  v_and_b32 v121, 3, v0
  v_lshlrev_b32 v121, 1, v121
  v_xor_b32 v121, v121, v124
  v_lshlrev_b32 v121, 4, v121
  v_xor_b32 v122, 16, v121
  v_add_u32 v121, v121, v123
  v_add_u32 v122, v122, v123
  s_lshl_b32 s72, s61, 1
  s_add_u32 s72, s72, s56
  s_lshl_b32 s72, s72, 7
  s_add_u32 s65, s72, 0x1200000
  v_and_b32 v112, 31, v0
  v_lshlrev_b32 v112, 2, v112
  buffer_load_dword v108, v112, s[48:51], s65 offen sc1
  v_lshrrev_b32 v112, 2, v0
  v_lshlrev_b32 v112, 2, v112
  buffer_load_dword v110, v112, s[48:51], s65 offen sc1
  buffer_load_dword v111, v112, s[48:51], s65 offen offset:64 sc1
  s_barrier
  ds_read_b64_tr_b16 v[48:49], v22 offset:0
  ds_read_b64_tr_b16 v[50:51], v22 offset:512
  ds_read_b128 v[24:27], v14 offset:0
  ds_read_b64_tr_b16 v[52:53], v22 offset:2048
  ds_read_b64_tr_b16 v[54:55], v22 offset:2560
  ds_read_b128 v[28:31], v15 offset:0
  ds_read_b64_tr_b16 v[56:57], v22 offset:4096
  ds_read_b64_tr_b16 v[58:59], v22 offset:4608
  ds_read_b128 v[32:35], v16 offset:0
  ds_read_b64_tr_b16 v[60:61], v22 offset:6144
  ds_read_b64_tr_b16 v[62:63], v22 offset:6656
  ds_read_b128 v[36:39], v17 offset:0
  ds_read_b64_tr_b16 v[64:65], v22 offset:8192
  ds_read_b64_tr_b16 v[66:67], v22 offset:8704
  ds_read_b128 v[40:43], v18 offset:0
  s_waitcnt lgkmcnt(12)
  v_mfma_f32_32x32x16_bf16 v[72:87], v[48:51], v[24:27], 0
  ds_read_b64_tr_b16 v[68:69], v22 offset:10240
  ds_read_b64_tr_b16 v[70:71], v22 offset:10752
  ds_read_b128 v[44:47], v19 offset:0
  s_waitcnt lgkmcnt(12)
  v_mfma_f32_32x32x16_bf16 v[72:87], v[52:55], v[28:31], v[72:87]
  ds_read_b64_tr_b16 v[48:49], v22 offset:12288
  ds_read_b64_tr_b16 v[50:51], v22 offset:12800
  ds_read_b128 v[24:27], v20 offset:0
  s_waitcnt lgkmcnt(12)
  v_mfma_f32_32x32x16_bf16 v[72:87], v[56:59], v[32:35], v[72:87]
  ds_read_b64_tr_b16 v[52:53], v22 offset:14336
  ds_read_b64_tr_b16 v[54:55], v22 offset:14848
  ds_read_b128 v[28:31], v21 offset:0
  s_waitcnt lgkmcnt(12)
  v_mfma_f32_32x32x16_bf16 v[72:87], v[60:63], v[36:39], v[72:87]
  s_waitcnt lgkmcnt(0)
  s_barrier
  ds_read_b64_tr_b16 v[56:57], v22 offset:16384
  ds_read_b64_tr_b16 v[58:59], v22 offset:16896
  ds_read_b128 v[32:35], v14 offset:16384
  v_mfma_f32_32x32x16_bf16 v[72:87], v[64:67], v[40:43], v[72:87]
  ds_read_b64_tr_b16 v[60:61], v22 offset:18432
  ds_read_b64_tr_b16 v[62:63], v22 offset:18944
  ds_read_b128 v[36:39], v15 offset:16384
  v_mfma_f32_32x32x16_bf16 v[72:87], v[68:71], v[44:47], v[72:87]
  ds_read_b64_tr_b16 v[64:65], v22 offset:20480
  ds_read_b64_tr_b16 v[66:67], v22 offset:20992
  ds_read_b128 v[40:43], v16 offset:16384
  v_mfma_f32_32x32x16_bf16 v[72:87], v[48:51], v[24:27], v[72:87]
  ds_read_b64_tr_b16 v[68:69], v22 offset:22528
  ds_read_b64_tr_b16 v[70:71], v22 offset:23040
  ds_read_b128 v[44:47], v17 offset:16384
  v_mfma_f32_32x32x16_bf16 v[72:87], v[52:55], v[28:31], v[72:87]
  ds_read_b64_tr_b16 v[48:49], v22 offset:24576
  ds_read_b64_tr_b16 v[50:51], v22 offset:25088
  ds_read_b128 v[24:27], v18 offset:16384
  s_waitcnt lgkmcnt(12)
  v_mfma_f32_32x32x16_bf16 v[72:87], v[56:59], v[32:35], v[72:87]
  ds_read_b64_tr_b16 v[52:53], v22 offset:26624
  ds_read_b64_tr_b16 v[54:55], v22 offset:27136
  ds_read_b128 v[28:31], v19 offset:16384
  s_waitcnt lgkmcnt(12)
  v_mfma_f32_32x32x16_bf16 v[72:87], v[60:63], v[36:39], v[72:87]
  ds_read_b64_tr_b16 v[56:57], v22 offset:28672
  ds_read_b64_tr_b16 v[58:59], v22 offset:29184
  ds_read_b128 v[32:35], v20 offset:16384
  s_waitcnt lgkmcnt(12)
  v_mfma_f32_32x32x16_bf16 v[72:87], v[64:67], v[40:43], v[72:87]
  ds_read_b64_tr_b16 v[60:61], v22 offset:30720
  ds_read_b64_tr_b16 v[62:63], v22 offset:31232
  ds_read_b128 v[36:39], v21 offset:16384
  s_waitcnt lgkmcnt(12)
  v_mfma_f32_32x32x16_bf16 v[72:87], v[68:71], v[44:47], v[72:87]
  s_waitcnt lgkmcnt(0)
  s_barrier
  ds_read_b64_tr_b16 v[64:65], v22 offset:32768
  ds_read_b64_tr_b16 v[66:67], v22 offset:33280
  ds_read_b128 v[40:43], v14 offset:32768
  v_mfma_f32_32x32x16_bf16 v[72:87], v[48:51], v[24:27], v[72:87]
  ds_read_b64_tr_b16 v[68:69], v22 offset:34816
  ds_read_b64_tr_b16 v[70:71], v22 offset:35328
  ds_read_b128 v[44:47], v15 offset:32768
  v_mfma_f32_32x32x16_bf16 v[72:87], v[52:55], v[28:31], v[72:87]
  ds_read_b64_tr_b16 v[48:49], v22 offset:36864
  ds_read_b64_tr_b16 v[50:51], v22 offset:37376
  ds_read_b128 v[24:27], v16 offset:32768
  v_mfma_f32_32x32x16_bf16 v[72:87], v[56:59], v[32:35], v[72:87]
  ds_read_b64_tr_b16 v[52:53], v22 offset:38912
  ds_read_b64_tr_b16 v[54:55], v22 offset:39424
  ds_read_b128 v[28:31], v17 offset:32768
  v_mfma_f32_32x32x16_bf16 v[72:87], v[60:63], v[36:39], v[72:87]
  ds_read_b64_tr_b16 v[56:57], v22 offset:40960
  ds_read_b64_tr_b16 v[58:59], v22 offset:41472
  ds_read_b128 v[32:35], v18 offset:32768
  s_waitcnt lgkmcnt(12)
  v_mfma_f32_32x32x16_bf16 v[72:87], v[64:67], v[40:43], v[72:87]
  ds_read_b64_tr_b16 v[60:61], v22 offset:43008
  ds_read_b64_tr_b16 v[62:63], v22 offset:43520
  ds_read_b128 v[36:39], v19 offset:32768
  s_waitcnt lgkmcnt(12)
  v_mfma_f32_32x32x16_bf16 v[72:87], v[68:71], v[44:47], v[72:87]
  ds_read_b64_tr_b16 v[64:65], v22 offset:45056
  ds_read_b64_tr_b16 v[66:67], v22 offset:45568
  ds_read_b128 v[40:43], v20 offset:32768
  s_waitcnt lgkmcnt(12)
  v_mfma_f32_32x32x16_bf16 v[72:87], v[48:51], v[24:27], v[72:87]
  ds_read_b64_tr_b16 v[68:69], v22 offset:47104
  ds_read_b64_tr_b16 v[70:71], v22 offset:47616
  ds_read_b128 v[44:47], v21 offset:32768
  s_waitcnt lgkmcnt(12)
  v_mfma_f32_32x32x16_bf16 v[72:87], v[52:55], v[28:31], v[72:87]
  s_waitcnt lgkmcnt(0)
  s_barrier
  ds_read_b64_tr_b16 v[48:49], v22 offset:49152
  ds_read_b64_tr_b16 v[50:51], v22 offset:49664
  ds_read_b128 v[24:27], v14 offset:49152
  v_mfma_f32_32x32x16_bf16 v[72:87], v[56:59], v[32:35], v[72:87]
  ds_read_b64_tr_b16 v[52:53], v22 offset:51200
  ds_read_b64_tr_b16 v[54:55], v22 offset:51712
  ds_read_b128 v[28:31], v15 offset:49152
  v_mfma_f32_32x32x16_bf16 v[72:87], v[60:63], v[36:39], v[72:87]
  ds_read_b64_tr_b16 v[56:57], v22 offset:53248
  ds_read_b64_tr_b16 v[58:59], v22 offset:53760
  ds_read_b128 v[32:35], v16 offset:49152
  v_mfma_f32_32x32x16_bf16 v[72:87], v[64:67], v[40:43], v[72:87]
  ds_read_b64_tr_b16 v[60:61], v22 offset:55296
  ds_read_b64_tr_b16 v[62:63], v22 offset:55808
  ds_read_b128 v[36:39], v17 offset:49152
  v_mfma_f32_32x32x16_bf16 v[72:87], v[68:71], v[44:47], v[72:87]
  ds_read_b64_tr_b16 v[64:65], v22 offset:57344
  ds_read_b64_tr_b16 v[66:67], v22 offset:57856
  ds_read_b128 v[40:43], v18 offset:49152
  s_waitcnt lgkmcnt(12)
  v_mfma_f32_32x32x16_bf16 v[72:87], v[48:51], v[24:27], v[72:87]
  ds_read_b64_tr_b16 v[68:69], v22 offset:59392
  ds_read_b64_tr_b16 v[70:71], v22 offset:59904
  ds_read_b128 v[44:47], v19 offset:49152
  s_waitcnt lgkmcnt(12)
  v_mfma_f32_32x32x16_bf16 v[72:87], v[52:55], v[28:31], v[72:87]
  ds_read_b64_tr_b16 v[48:49], v22 offset:61440
  ds_read_b64_tr_b16 v[50:51], v22 offset:61952
  ds_read_b128 v[24:27], v20 offset:49152
  s_waitcnt lgkmcnt(12)
  v_mfma_f32_32x32x16_bf16 v[72:87], v[56:59], v[32:35], v[72:87]
  ds_read_b64_tr_b16 v[52:53], v22 offset:63488
  ds_read_b64_tr_b16 v[54:55], v22 offset:64000
  ds_read_b128 v[28:31], v21 offset:49152
  s_waitcnt lgkmcnt(12)
  v_mfma_f32_32x32x16_bf16 v[72:87], v[60:63], v[36:39], v[72:87]
  s_waitcnt lgkmcnt(9)
  v_mfma_f32_32x32x16_bf16 v[72:87], v[64:67], v[40:43], v[72:87]
  s_waitcnt lgkmcnt(6)
  v_mfma_f32_32x32x16_bf16 v[72:87], v[68:71], v[44:47], v[72:87]
  s_waitcnt lgkmcnt(3)
  v_mfma_f32_32x32x16_bf16 v[72:87], v[48:51], v[24:27], v[72:87]
  s_waitcnt lgkmcnt(0)
  v_mfma_f32_32x32x16_bf16 v[72:87], v[52:55], v[28:31], v[72:87]
  s_nop 11
  v_mov_b32 v92, v72
  v_mov_b32 v93, v73
  v_mov_b32 v94, v74
  v_mov_b32 v95, v75
  v_mov_b32 v96, v76
  v_mov_b32 v97, v77
  v_mov_b32 v98, v78
  v_mov_b32 v99, v79
  v_mov_b32 v100, v80
  v_mov_b32 v101, v81
  v_mov_b32 v102, v82
  v_mov_b32 v103, v83
  v_mov_b32 v104, v84
  v_mov_b32 v105, v85
  v_mov_b32 v106, v86
  v_mov_b32 v107, v87
  s_barrier
  s_mov_b32 s64, 0x7fff
  s_cmp_lg_u32 s35, 0
  s_cbranch_scc1 L_poll_p4_done
  v_and_b32 v156, 31, v0
  v_lshlrev_b32 v156, 2, v156
  s_lshl_b32 s72, s2, 7
  s_add_u32 s72, s72, 0x1220000
  s_mov_b32 s73, 0x20000
  s_waitcnt vmcnt(0)
L_poll_p4:
  buffer_load_dword v2, v156, s[48:51], s72 offen sc1
  s_waitcnt vmcnt(0)
  v_cmp_ne_u32 vcc, s34, v2
  s_nop 3
  s_and_b32 s74, vcc_lo, s64
  s_cbranch_scc0 L_poll_p4_done
  s_sub_u32 s73, s73, 1
  s_cmp_lg_u32 s73, 0
  s_cbranch_scc1 L_poll_p4
L_poll_p4_done:
  s_barrier
  s_barrier
  ds_read_b64_tr_b16 v[48:49], v22 offset:0
  ds_read_b64_tr_b16 v[50:51], v22 offset:512
  ds_read_b128 v[24:27], v14 offset:0
  ds_read_b64_tr_b16 v[52:53], v22 offset:2048
  ds_read_b64_tr_b16 v[54:55], v22 offset:2560
  ds_read_b128 v[28:31], v15 offset:0
  ds_read_b64_tr_b16 v[56:57], v22 offset:4096
  ds_read_b64_tr_b16 v[58:59], v22 offset:4608
  ds_read_b128 v[32:35], v16 offset:0
  ds_read_b64_tr_b16 v[60:61], v22 offset:6144
  ds_read_b64_tr_b16 v[62:63], v22 offset:6656
  ds_read_b128 v[36:39], v17 offset:0
  ds_read_b64_tr_b16 v[64:65], v22 offset:8192
  ds_read_b64_tr_b16 v[66:67], v22 offset:8704
  ds_read_b128 v[40:43], v18 offset:0
  s_waitcnt lgkmcnt(12)
  v_mfma_f32_32x32x16_bf16 v[72:87], v[48:51], v[24:27], 0
  ds_read_b64_tr_b16 v[68:69], v22 offset:10240
  ds_read_b64_tr_b16 v[70:71], v22 offset:10752
  ds_read_b128 v[44:47], v19 offset:0
  s_waitcnt lgkmcnt(12)
  v_mfma_f32_32x32x16_bf16 v[72:87], v[52:55], v[28:31], v[72:87]
  ds_read_b64_tr_b16 v[48:49], v22 offset:12288
  ds_read_b64_tr_b16 v[50:51], v22 offset:12800
  ds_read_b128 v[24:27], v20 offset:0
  s_waitcnt lgkmcnt(12)
  v_mfma_f32_32x32x16_bf16 v[72:87], v[56:59], v[32:35], v[72:87]
  ds_read_b64_tr_b16 v[52:53], v22 offset:14336
  ds_read_b64_tr_b16 v[54:55], v22 offset:14848
  ds_read_b128 v[28:31], v21 offset:0
  s_waitcnt lgkmcnt(12)
  v_mfma_f32_32x32x16_bf16 v[72:87], v[60:63], v[36:39], v[72:87]
  s_waitcnt lgkmcnt(0)
  s_barrier
  ds_read_b64_tr_b16 v[56:57], v22 offset:16384
  ds_read_b64_tr_b16 v[58:59], v22 offset:16896
  ds_read_b128 v[32:35], v14 offset:16384
  v_mfma_f32_32x32x16_bf16 v[72:87], v[64:67], v[40:43], v[72:87]
  ds_read_b64_tr_b16 v[60:61], v22 offset:18432
  ds_read_b64_tr_b16 v[62:63], v22 offset:18944
  ds_read_b128 v[36:39], v15 offset:16384
  v_mfma_f32_32x32x16_bf16 v[72:87], v[68:71], v[44:47], v[72:87]
  ds_read_b64_tr_b16 v[64:65], v22 offset:20480
  ds_read_b64_tr_b16 v[66:67], v22 offset:20992
  ds_read_b128 v[40:43], v16 offset:16384
  v_mfma_f32_32x32x16_bf16 v[72:87], v[48:51], v[24:27], v[72:87]
  ds_read_b64_tr_b16 v[68:69], v22 offset:22528
  ds_read_b64_tr_b16 v[70:71], v22 offset:23040
  ds_read_b128 v[44:47], v17 offset:16384
  v_mfma_f32_32x32x16_bf16 v[72:87], v[52:55], v[28:31], v[72:87]
  ds_read_b64_tr_b16 v[48:49], v22 offset:24576
  ds_read_b64_tr_b16 v[50:51], v22 offset:25088
  ds_read_b128 v[24:27], v18 offset:16384
  s_waitcnt lgkmcnt(12)
  v_mfma_f32_32x32x16_bf16 v[72:87], v[56:59], v[32:35], v[72:87]
  ds_read_b64_tr_b16 v[52:53], v22 offset:26624
  ds_read_b64_tr_b16 v[54:55], v22 offset:27136
  ds_read_b128 v[28:31], v19 offset:16384
  s_waitcnt lgkmcnt(12)
  v_mfma_f32_32x32x16_bf16 v[72:87], v[60:63], v[36:39], v[72:87]
  ds_read_b64_tr_b16 v[56:57], v22 offset:28672
  ds_read_b64_tr_b16 v[58:59], v22 offset:29184
  ds_read_b128 v[32:35], v20 offset:16384
  s_waitcnt lgkmcnt(12)
  v_mfma_f32_32x32x16_bf16 v[72:87], v[64:67], v[40:43], v[72:87]
  ds_read_b64_tr_b16 v[60:61], v22 offset:30720
  ds_read_b64_tr_b16 v[62:63], v22 offset:31232
  ds_read_b128 v[36:39], v21 offset:16384
  s_waitcnt lgkmcnt(12)
  v_mfma_f32_32x32x16_bf16 v[72:87], v[68:71], v[44:47], v[72:87]
  s_waitcnt lgkmcnt(0)
  s_barrier
  ds_read_b64_tr_b16 v[64:65], v22 offset:32768
  ds_read_b64_tr_b16 v[66:67], v22 offset:33280
  ds_read_b128 v[40:43], v14 offset:32768
  v_mfma_f32_32x32x16_bf16 v[72:87], v[48:51], v[24:27], v[72:87]
  ds_read_b64_tr_b16 v[68:69], v22 offset:34816
  ds_read_b64_tr_b16 v[70:71], v22 offset:35328
  ds_read_b128 v[44:47], v15 offset:32768
  v_mfma_f32_32x32x16_bf16 v[72:87], v[52:55], v[28:31], v[72:87]
  ds_read_b64_tr_b16 v[48:49], v22 offset:36864
  ds_read_b64_tr_b16 v[50:51], v22 offset:37376
  ds_read_b128 v[24:27], v16 offset:32768
  v_mfma_f32_32x32x16_bf16 v[72:87], v[56:59], v[32:35], v[72:87]
  ds_read_b64_tr_b16 v[52:53], v22 offset:38912
  ds_read_b64_tr_b16 v[54:55], v22 offset:39424
  ds_read_b128 v[28:31], v17 offset:32768
  v_mfma_f32_32x32x16_bf16 v[72:87], v[60:63], v[36:39], v[72:87]
  ds_read_b64_tr_b16 v[56:57], v22 offset:40960
  ds_read_b64_tr_b16 v[58:59], v22 offset:41472
  ds_read_b128 v[32:35], v18 offset:32768
  s_waitcnt lgkmcnt(12)
  v_mfma_f32_32x32x16_bf16 v[72:87], v[64:67], v[40:43], v[72:87]
  ds_read_b64_tr_b16 v[60:61], v22 offset:43008
  ds_read_b64_tr_b16 v[62:63], v22 offset:43520
  ds_read_b128 v[36:39], v19 offset:32768
  s_waitcnt lgkmcnt(12)
  v_mfma_f32_32x32x16_bf16 v[72:87], v[68:71], v[44:47], v[72:87]
  ds_read_b64_tr_b16 v[64:65], v22 offset:45056
  ds_read_b64_tr_b16 v[66:67], v22 offset:45568
  ds_read_b128 v[40:43], v20 offset:32768
  s_waitcnt lgkmcnt(12)
  v_mfma_f32_32x32x16_bf16 v[72:87], v[48:51], v[24:27], v[72:87]
  ds_read_b64_tr_b16 v[68:69], v22 offset:47104
  ds_read_b64_tr_b16 v[70:71], v22 offset:47616
  ds_read_b128 v[44:47], v21 offset:32768
  s_waitcnt lgkmcnt(12)
  v_mfma_f32_32x32x16_bf16 v[72:87], v[52:55], v[28:31], v[72:87]
  s_waitcnt lgkmcnt(0)
  s_barrier
  ds_read_b64_tr_b16 v[48:49], v22 offset:49152
  ds_read_b64_tr_b16 v[50:51], v22 offset:49664
  ds_read_b128 v[24:27], v14 offset:0
  v_mfma_f32_32x32x16_bf16 v[72:87], v[56:59], v[32:35], v[72:87]
  ds_read_b64_tr_b16 v[52:53], v22 offset:51200
  ds_read_b64_tr_b16 v[54:55], v22 offset:51712
  ds_read_b128 v[28:31], v15 offset:0
  v_mfma_f32_32x32x16_bf16 v[72:87], v[60:63], v[36:39], v[72:87]
  ds_read_b64_tr_b16 v[56:57], v22 offset:53248
  ds_read_b64_tr_b16 v[58:59], v22 offset:53760
  ds_read_b128 v[32:35], v16 offset:0
  v_mfma_f32_32x32x16_bf16 v[72:87], v[64:67], v[40:43], v[72:87]
  ds_read_b64_tr_b16 v[60:61], v22 offset:55296
  ds_read_b64_tr_b16 v[62:63], v22 offset:55808
  ds_read_b128 v[36:39], v17 offset:0
  v_mfma_f32_32x32x16_bf16 v[72:87], v[68:71], v[44:47], v[72:87]
  ds_read_b64_tr_b16 v[64:65], v22 offset:57344
  ds_read_b64_tr_b16 v[66:67], v22 offset:57856
  ds_read_b128 v[40:43], v18 offset:0
  s_waitcnt lgkmcnt(12)
  v_mfma_f32_32x32x16_bf16 v[72:87], v[48:51], v[24:27], v[72:87]
  ds_read_b64_tr_b16 v[68:69], v22 offset:59392
  ds_read_b64_tr_b16 v[70:71], v22 offset:59904
  ds_read_b128 v[44:47], v19 offset:0
  s_waitcnt lgkmcnt(12)
  v_mfma_f32_32x32x16_bf16 v[72:87], v[52:55], v[28:31], v[72:87]
  ds_read_b64_tr_b16 v[48:49], v22 offset:61440
  ds_read_b64_tr_b16 v[50:51], v22 offset:61952
  ds_read_b128 v[24:27], v20 offset:0
  s_waitcnt lgkmcnt(12)
  v_mfma_f32_32x32x16_bf16 v[72:87], v[56:59], v[32:35], v[72:87]
  ds_read_b64_tr_b16 v[52:53], v22 offset:63488
  ds_read_b64_tr_b16 v[54:55], v22 offset:64000
  ds_read_b128 v[28:31], v21 offset:0
  s_waitcnt lgkmcnt(12)
  v_mfma_f32_32x32x16_bf16 v[72:87], v[60:63], v[36:39], v[72:87]
  s_waitcnt lgkmcnt(0)
  s_barrier
  ds_read_b64_tr_b16 v[56:57], v23 offset:49152
  ds_read_b64_tr_b16 v[58:59], v23 offset:49664
  ds_read_b128 v[32:35], v14 offset:16384
  v_mfma_f32_32x32x16_bf16 v[72:87], v[64:67], v[40:43], v[72:87]
  ds_read_b64_tr_b16 v[60:61], v23 offset:51200
  ds_read_b64_tr_b16 v[62:63], v23 offset:51712
  ds_read_b128 v[36:39], v15 offset:16384
  v_mfma_f32_32x32x16_bf16 v[72:87], v[68:71], v[44:47], v[72:87]
  ds_read_b64_tr_b16 v[64:65], v23 offset:53248
  ds_read_b64_tr_b16 v[66:67], v23 offset:53760
  ds_read_b128 v[40:43], v16 offset:16384
  v_mfma_f32_32x32x16_bf16 v[72:87], v[48:51], v[24:27], v[72:87]
  ds_read_b64_tr_b16 v[68:69], v23 offset:55296
  ds_read_b64_tr_b16 v[70:71], v23 offset:55808
  ds_read_b128 v[44:47], v17 offset:16384
  v_mfma_f32_32x32x16_bf16 v[72:87], v[52:55], v[28:31], v[72:87]
  ds_read_b64_tr_b16 v[48:49], v23 offset:57344
  ds_read_b64_tr_b16 v[50:51], v23 offset:57856
  ds_read_b128 v[24:27], v18 offset:16384
  s_waitcnt lgkmcnt(12)
  v_mfma_f32_32x32x16_bf16 v[72:87], v[56:59], v[32:35], v[72:87]
  ds_read_b64_tr_b16 v[52:53], v23 offset:59392
  ds_read_b64_tr_b16 v[54:55], v23 offset:59904
  ds_read_b128 v[28:31], v19 offset:16384
  s_waitcnt lgkmcnt(12)
  v_mfma_f32_32x32x16_bf16 v[72:87], v[60:63], v[36:39], v[72:87]
  ds_read_b64_tr_b16 v[56:57], v23 offset:61440
  ds_read_b64_tr_b16 v[58:59], v23 offset:61952
  ds_read_b128 v[32:35], v20 offset:16384
  s_waitcnt lgkmcnt(12)
  v_mfma_f32_32x32x16_bf16 v[72:87], v[64:67], v[40:43], v[72:87]
  ds_read_b64_tr_b16 v[60:61], v23 offset:63488
  ds_read_b64_tr_b16 v[62:63], v23 offset:64000
  ds_read_b128 v[36:39], v21 offset:16384
  s_waitcnt lgkmcnt(12)
  v_mfma_f32_32x32x16_bf16 v[72:87], v[68:71], v[44:47], v[72:87]
  s_waitcnt lgkmcnt(0)
  s_barrier
  ds_read_b64_tr_b16 v[64:65], v22 offset:0
  ds_read_b64_tr_b16 v[66:67], v22 offset:512
  ds_read_b128 v[40:43], v14 offset:32768
  v_mfma_f32_32x32x16_bf16 v[72:87], v[48:51], v[24:27], v[72:87]
  ds_read_b64_tr_b16 v[68:69], v22 offset:2048
  ds_read_b64_tr_b16 v[70:71], v22 offset:2560
  ds_read_b128 v[44:47], v15 offset:32768
  v_mfma_f32_32x32x16_bf16 v[72:87], v[52:55], v[28:31], v[72:87]
  ds_read_b64_tr_b16 v[48:49], v22 offset:4096
  ds_read_b64_tr_b16 v[50:51], v22 offset:4608
  ds_read_b128 v[24:27], v16 offset:32768
  v_mfma_f32_32x32x16_bf16 v[72:87], v[56:59], v[32:35], v[72:87]
  ds_read_b64_tr_b16 v[52:53], v22 offset:6144
  ds_read_b64_tr_b16 v[54:55], v22 offset:6656
  ds_read_b128 v[28:31], v17 offset:32768
  v_mfma_f32_32x32x16_bf16 v[72:87], v[60:63], v[36:39], v[72:87]
  ds_read_b64_tr_b16 v[56:57], v22 offset:8192
  ds_read_b64_tr_b16 v[58:59], v22 offset:8704
  ds_read_b128 v[32:35], v18 offset:32768
  s_waitcnt lgkmcnt(12)
  v_mfma_f32_32x32x16_bf16 v[72:87], v[64:67], v[40:43], v[72:87]
  ds_read_b64_tr_b16 v[60:61], v22 offset:10240
  ds_read_b64_tr_b16 v[62:63], v22 offset:10752
  ds_read_b128 v[36:39], v19 offset:32768
  s_waitcnt lgkmcnt(12)
  v_mfma_f32_32x32x16_bf16 v[72:87], v[68:71], v[44:47], v[72:87]
  ds_read_b64_tr_b16 v[64:65], v22 offset:12288
  ds_read_b64_tr_b16 v[66:67], v22 offset:12800
  ds_read_b128 v[40:43], v20 offset:32768
  s_waitcnt lgkmcnt(12)
  v_mfma_f32_32x32x16_bf16 v[72:87], v[48:51], v[24:27], v[72:87]
  ds_read_b64_tr_b16 v[68:69], v22 offset:14336
  ds_read_b64_tr_b16 v[70:71], v22 offset:14848
  ds_read_b128 v[44:47], v21 offset:32768
  s_waitcnt lgkmcnt(12)
  v_mfma_f32_32x32x16_bf16 v[72:87], v[52:55], v[28:31], v[72:87]
  s_waitcnt lgkmcnt(0)
  s_barrier
  ds_read_b64_tr_b16 v[48:49], v22 offset:16384
  ds_read_b64_tr_b16 v[50:51], v22 offset:16896
  ds_read_b128 v[24:27], v14 offset:0
  v_mfma_f32_32x32x16_bf16 v[72:87], v[56:59], v[32:35], v[72:87]
  ds_read_b64_tr_b16 v[52:53], v22 offset:18432
  ds_read_b64_tr_b16 v[54:55], v22 offset:18944
  ds_read_b128 v[28:31], v15 offset:0
  v_mfma_f32_32x32x16_bf16 v[72:87], v[60:63], v[36:39], v[72:87]
  ds_read_b64_tr_b16 v[56:57], v22 offset:20480
  ds_read_b64_tr_b16 v[58:59], v22 offset:20992
  ds_read_b128 v[32:35], v16 offset:0
  v_mfma_f32_32x32x16_bf16 v[72:87], v[64:67], v[40:43], v[72:87]
  ds_read_b64_tr_b16 v[60:61], v22 offset:22528
  ds_read_b64_tr_b16 v[62:63], v22 offset:23040
  ds_read_b128 v[36:39], v17 offset:0
  v_mfma_f32_32x32x16_bf16 v[72:87], v[68:71], v[44:47], v[72:87]
  ds_read_b64_tr_b16 v[64:65], v22 offset:24576
  ds_read_b64_tr_b16 v[66:67], v22 offset:25088
  ds_read_b128 v[40:43], v18 offset:0
  s_waitcnt lgkmcnt(12)
  v_mfma_f32_32x32x16_bf16 v[72:87], v[48:51], v[24:27], v[72:87]
  ds_read_b64_tr_b16 v[68:69], v22 offset:26624
  ds_read_b64_tr_b16 v[70:71], v22 offset:27136
  ds_read_b128 v[44:47], v19 offset:0
  s_waitcnt lgkmcnt(12)
  v_mfma_f32_32x32x16_bf16 v[72:87], v[52:55], v[28:31], v[72:87]
  ds_read_b64_tr_b16 v[48:49], v22 offset:28672
  ds_read_b64_tr_b16 v[50:51], v22 offset:29184
  ds_read_b128 v[24:27], v20 offset:0
  s_waitcnt lgkmcnt(12)
  v_mfma_f32_32x32x16_bf16 v[72:87], v[56:59], v[32:35], v[72:87]
  ds_read_b64_tr_b16 v[52:53], v22 offset:30720
  ds_read_b64_tr_b16 v[54:55], v22 offset:31232
  ds_read_b128 v[28:31], v21 offset:0
  s_waitcnt lgkmcnt(12)
  v_mfma_f32_32x32x16_bf16 v[72:87], v[60:63], v[36:39], v[72:87]
  s_waitcnt lgkmcnt(0)
  s_barrier
  ds_read_b64_tr_b16 v[56:57], v22 offset:32768
  ds_read_b64_tr_b16 v[58:59], v22 offset:33280
  ds_read_b128 v[32:35], v14 offset:16384
  v_mfma_f32_32x32x16_bf16 v[72:87], v[64:67], v[40:43], v[72:87]
  ds_read_b64_tr_b16 v[60:61], v22 offset:34816
  ds_read_b64_tr_b16 v[62:63], v22 offset:35328
  ds_read_b128 v[36:39], v15 offset:16384
  v_mfma_f32_32x32x16_bf16 v[72:87], v[68:71], v[44:47], v[72:87]
  ds_read_b64_tr_b16 v[64:65], v22 offset:36864
  ds_read_b64_tr_b16 v[66:67], v22 offset:37376
  ds_read_b128 v[40:43], v16 offset:16384
  v_mfma_f32_32x32x16_bf16 v[72:87], v[48:51], v[24:27], v[72:87]
  ds_read_b64_tr_b16 v[68:69], v22 offset:38912
  ds_read_b64_tr_b16 v[70:71], v22 offset:39424
  ds_read_b128 v[44:47], v17 offset:16384
  v_mfma_f32_32x32x16_bf16 v[72:87], v[52:55], v[28:31], v[72:87]
  ds_read_b64_tr_b16 v[48:49], v22 offset:40960
  ds_read_b64_tr_b16 v[50:51], v22 offset:41472
  ds_read_b128 v[24:27], v18 offset:16384
  s_waitcnt lgkmcnt(12)
  v_mfma_f32_32x32x16_bf16 v[72:87], v[56:59], v[32:35], v[72:87]
  ds_read_b64_tr_b16 v[52:53], v22 offset:43008
  ds_read_b64_tr_b16 v[54:55], v22 offset:43520
  ds_read_b128 v[28:31], v19 offset:16384
  s_waitcnt lgkmcnt(12)
  v_mfma_f32_32x32x16_bf16 v[72:87], v[60:63], v[36:39], v[72:87]
  ds_read_b64_tr_b16 v[56:57], v22 offset:45056
  ds_read_b64_tr_b16 v[58:59], v22 offset:45568
  ds_read_b128 v[32:35], v20 offset:16384
  s_waitcnt lgkmcnt(12)
  v_mfma_f32_32x32x16_bf16 v[72:87], v[64:67], v[40:43], v[72:87]
  ds_read_b64_tr_b16 v[60:61], v22 offset:47104
  ds_read_b64_tr_b16 v[62:63], v22 offset:47616
  ds_read_b128 v[36:39], v21 offset:16384
  s_waitcnt lgkmcnt(12)
  v_mfma_f32_32x32x16_bf16 v[72:87], v[68:71], v[44:47], v[72:87]
  s_waitcnt lgkmcnt(0)
  s_barrier
  ds_read_b64_tr_b16 v[64:65], v22 offset:49152
  ds_read_b64_tr_b16 v[66:67], v22 offset:49664
  ds_read_b128 v[40:43], v14 offset:32768
  v_mfma_f32_32x32x16_bf16 v[72:87], v[48:51], v[24:27], v[72:87]
  ds_read_b64_tr_b16 v[68:69], v22 offset:51200
  ds_read_b64_tr_b16 v[70:71], v22 offset:51712
  ds_read_b128 v[44:47], v15 offset:32768
  v_mfma_f32_32x32x16_bf16 v[72:87], v[52:55], v[28:31], v[72:87]
  ds_read_b64_tr_b16 v[48:49], v22 offset:53248
  ds_read_b64_tr_b16 v[50:51], v22 offset:53760
  ds_read_b128 v[24:27], v16 offset:32768
  v_mfma_f32_32x32x16_bf16 v[72:87], v[56:59], v[32:35], v[72:87]
  ds_read_b64_tr_b16 v[52:53], v22 offset:55296
  ds_read_b64_tr_b16 v[54:55], v22 offset:55808
  ds_read_b128 v[28:31], v17 offset:32768
  v_mfma_f32_32x32x16_bf16 v[72:87], v[60:63], v[36:39], v[72:87]
  ds_read_b64_tr_b16 v[56:57], v22 offset:57344
  ds_read_b64_tr_b16 v[58:59], v22 offset:57856
  ds_read_b128 v[32:35], v18 offset:32768
  s_waitcnt lgkmcnt(12)
  v_mfma_f32_32x32x16_bf16 v[72:87], v[64:67], v[40:43], v[72:87]
  ds_read_b64_tr_b16 v[60:61], v22 offset:59392
  ds_read_b64_tr_b16 v[62:63], v22 offset:59904
  ds_read_b128 v[36:39], v19 offset:32768
  s_waitcnt lgkmcnt(12)
  v_mfma_f32_32x32x16_bf16 v[72:87], v[68:71], v[44:47], v[72:87]
  ds_read_b64_tr_b16 v[64:65], v22 offset:61440
  ds_read_b64_tr_b16 v[66:67], v22 offset:61952
  ds_read_b128 v[40:43], v20 offset:32768
  s_waitcnt lgkmcnt(12)
  v_mfma_f32_32x32x16_bf16 v[72:87], v[48:51], v[24:27], v[72:87]
  ds_read_b64_tr_b16 v[68:69], v22 offset:63488
  ds_read_b64_tr_b16 v[70:71], v22 offset:64000
  ds_read_b128 v[44:47], v21 offset:32768
  s_waitcnt lgkmcnt(12)
  v_mfma_f32_32x32x16_bf16 v[72:87], v[52:55], v[28:31], v[72:87]
  s_waitcnt lgkmcnt(0)
  s_barrier
  ds_read_b64_tr_b16 v[48:49], v23 offset:49152
  ds_read_b64_tr_b16 v[50:51], v23 offset:49664
  ds_read_b128 v[24:27], v14 offset:0
  v_mfma_f32_32x32x16_bf16 v[72:87], v[56:59], v[32:35], v[72:87]
  ds_read_b64_tr_b16 v[52:53], v23 offset:51200
  ds_read_b64_tr_b16 v[54:55], v23 offset:51712
  ds_read_b128 v[28:31], v15 offset:0
  v_mfma_f32_32x32x16_bf16 v[72:87], v[60:63], v[36:39], v[72:87]
  ds_read_b64_tr_b16 v[56:57], v23 offset:53248
  ds_read_b64_tr_b16 v[58:59], v23 offset:53760
  ds_read_b128 v[32:35], v16 offset:0
  v_mfma_f32_32x32x16_bf16 v[72:87], v[64:67], v[40:43], v[72:87]
  ds_read_b64_tr_b16 v[60:61], v23 offset:55296
  ds_read_b64_tr_b16 v[62:63], v23 offset:55808
  ds_read_b128 v[36:39], v17 offset:0
  v_mfma_f32_32x32x16_bf16 v[72:87], v[68:71], v[44:47], v[72:87]
  ds_read_b64_tr_b16 v[64:65], v23 offset:57344
  ds_read_b64_tr_b16 v[66:67], v23 offset:57856
  ds_read_b128 v[40:43], v18 offset:0
  s_waitcnt lgkmcnt(12)
  v_mfma_f32_32x32x16_bf16 v[72:87], v[48:51], v[24:27], v[72:87]
  ds_read_b64_tr_b16 v[68:69], v23 offset:59392
  ds_read_b64_tr_b16 v[70:71], v23 offset:59904
  ds_read_b128 v[44:47], v19 offset:0
  s_waitcnt lgkmcnt(12)
  v_mfma_f32_32x32x16_bf16 v[72:87], v[52:55], v[28:31], v[72:87]
  ds_read_b64_tr_b16 v[48:49], v23 offset:61440
  ds_read_b64_tr_b16 v[50:51], v23 offset:61952
  ds_read_b128 v[24:27], v20 offset:0
  s_waitcnt lgkmcnt(12)
  v_mfma_f32_32x32x16_bf16 v[72:87], v[56:59], v[32:35], v[72:87]
  ds_read_b64_tr_b16 v[52:53], v23 offset:63488
  ds_read_b64_tr_b16 v[54:55], v23 offset:64000
  ds_read_b128 v[28:31], v21 offset:0
  s_waitcnt lgkmcnt(12)
  v_mfma_f32_32x32x16_bf16 v[72:87], v[60:63], v[36:39], v[72:87]
  s_waitcnt lgkmcnt(0)
  s_barrier
  ds_read_b64_tr_b16 v[56:57], v22 offset:0
  ds_read_b64_tr_b16 v[58:59], v22 offset:512
  ds_read_b128 v[32:35], v14 offset:16384
  v_mfma_f32_32x32x16_bf16 v[72:87], v[64:67], v[40:43], v[72:87]
  ds_read_b64_tr_b16 v[60:61], v22 offset:2048
  ds_read_b64_tr_b16 v[62:63], v22 offset:2560
  ds_read_b128 v[36:39], v15 offset:16384
  v_mfma_f32_32x32x16_bf16 v[72:87], v[68:71], v[44:47], v[72:87]
  ds_read_b64_tr_b16 v[64:65], v22 offset:4096
  ds_read_b64_tr_b16 v[66:67], v22 offset:4608
  ds_read_b128 v[40:43], v16 offset:16384
  v_mfma_f32_32x32x16_bf16 v[72:87], v[48:51], v[24:27], v[72:87]
  ds_read_b64_tr_b16 v[68:69], v22 offset:6144
  ds_read_b64_tr_b16 v[70:71], v22 offset:6656
  ds_read_b128 v[44:47], v17 offset:16384
  v_mfma_f32_32x32x16_bf16 v[72:87], v[52:55], v[28:31], v[72:87]
  ds_read_b64_tr_b16 v[48:49], v22 offset:8192
  ds_read_b64_tr_b16 v[50:51], v22 offset:8704
  ds_read_b128 v[24:27], v18 offset:16384
  s_waitcnt lgkmcnt(12)
  v_mfma_f32_32x32x16_bf16 v[72:87], v[56:59], v[32:35], v[72:87]
  ds_read_b64_tr_b16 v[52:53], v22 offset:10240
  ds_read_b64_tr_b16 v[54:55], v22 offset:10752
  ds_read_b128 v[28:31], v19 offset:16384
  s_waitcnt lgkmcnt(12)
  v_mfma_f32_32x32x16_bf16 v[72:87], v[60:63], v[36:39], v[72:87]
  ds_read_b64_tr_b16 v[56:57], v22 offset:12288
  ds_read_b64_tr_b16 v[58:59], v22 offset:12800
  ds_read_b128 v[32:35], v20 offset:16384
  s_waitcnt lgkmcnt(12)
  v_mfma_f32_32x32x16_bf16 v[72:87], v[64:67], v[40:43], v[72:87]
  ds_read_b64_tr_b16 v[60:61], v22 offset:14336
  ds_read_b64_tr_b16 v[62:63], v22 offset:14848
  ds_read_b128 v[36:39], v21 offset:16384
  s_waitcnt lgkmcnt(12)
  v_mfma_f32_32x32x16_bf16 v[72:87], v[68:71], v[44:47], v[72:87]
  s_waitcnt lgkmcnt(9)
  v_mfma_f32_32x32x16_bf16 v[72:87], v[48:51], v[24:27], v[72:87]
  s_waitcnt lgkmcnt(6)
  v_mfma_f32_32x32x16_bf16 v[72:87], v[52:55], v[28:31], v[72:87]
  s_waitcnt lgkmcnt(3)
  v_mfma_f32_32x32x16_bf16 v[72:87], v[56:59], v[32:35], v[72:87]
  s_waitcnt lgkmcnt(0)
  v_mfma_f32_32x32x16_bf16 v[72:87], v[60:63], v[36:39], v[72:87]
  s_waitcnt vmcnt(0)
  s_nop 10
  v_pk_add_f32 v[92:93], v[92:93], v[72:73] neg_lo:[0,1] neg_hi:[0,1]
  v_pk_add_f32 v[94:95], v[94:95], v[74:75] neg_lo:[0,1] neg_hi:[0,1]
  v_pk_add_f32 v[96:97], v[96:97], v[76:77] neg_lo:[0,1] neg_hi:[0,1]
  v_pk_add_f32 v[98:99], v[98:99], v[78:79] neg_lo:[0,1] neg_hi:[0,1]
  v_pk_add_f32 v[100:101], v[100:101], v[80:81] neg_lo:[0,1] neg_hi:[0,1]
  v_pk_add_f32 v[102:103], v[102:103], v[82:83] neg_lo:[0,1] neg_hi:[0,1]
  v_pk_add_f32 v[104:105], v[104:105], v[84:85] neg_lo:[0,1] neg_hi:[0,1]
  v_pk_add_f32 v[106:107], v[106:107], v[86:87] neg_lo:[0,1] neg_hi:[0,1]
  v_pk_fma_f32 v[92:93], v[92:93], v[108:109], v[72:73] op_sel:[0,0,0] op_sel_hi:[1,0,1]
  v_pk_fma_f32 v[94:95], v[94:95], v[108:109], v[74:75] op_sel:[0,0,0] op_sel_hi:[1,0,1]
  v_pk_fma_f32 v[96:97], v[96:97], v[108:109], v[76:77] op_sel:[0,0,0] op_sel_hi:[1,0,1]
  v_pk_fma_f32 v[98:99], v[98:99], v[108:109], v[78:79] op_sel:[0,0,0] op_sel_hi:[1,0,1]
  v_pk_fma_f32 v[100:101], v[100:101], v[108:109], v[80:81] op_sel:[0,0,0] op_sel_hi:[1,0,1]
  v_pk_fma_f32 v[102:103], v[102:103], v[108:109], v[82:83] op_sel:[0,0,0] op_sel_hi:[1,0,1]
  v_pk_fma_f32 v[104:105], v[104:105], v[108:109], v[84:85] op_sel:[0,0,0] op_sel_hi:[1,0,1]
  v_pk_fma_f32 v[106:107], v[106:107], v[108:109], v[86:87] op_sel:[0,0,0] op_sel_hi:[1,0,1]
  ds_write_b128 v113, v[92:95]
  ds_write_b128 v114, v[96:99]
  ds_write_b128 v115, v[100:103]
  ds_write_b128 v116, v[104:107]
  ds_read_b128 v[128:131], v121 offset:0
  ds_read_b128 v[132:135], v122 offset:0
  ds_read_b128 v[136:139], v121 offset:2048
  ds_read_b128 v[140:143], v122 offset:2048
  s_mov_b32 s52, s28
  s_mov_b32 s53, s29
  s_mov_b32 s54, 0x200000
  s_mov_b32 s55, 0x20000
  v_sub_f32 v110, 1.0, v110
  v_sub_f32 v111, 1.0, v111
  s_waitcnt lgkmcnt(0)
  v_lshlrev_b32 v144, 16, v4
  v_and_b32 v145, 0xffff0000, v4
  v_lshlrev_b32 v146, 16, v5
  v_and_b32 v147, 0xffff0000, v5
  v_lshlrev_b32 v148, 16, v6
  v_and_b32 v149, 0xffff0000, v6
  v_lshlrev_b32 v150, 16, v7
  v_and_b32 v151, 0xffff0000, v7
  v_pk_fma_f32 v[144:145], v[144:145], v[110:111], v[128:129] op_sel:[0,0,0] op_sel_hi:[1,0,1]
  v_pk_fma_f32 v[146:147], v[146:147], v[110:111], v[130:131] op_sel:[0,0,0] op_sel_hi:[1,0,1]
  v_pk_fma_f32 v[148:149], v[148:149], v[110:111], v[132:133] op_sel:[0,0,0] op_sel_hi:[1,0,1]
  v_pk_fma_f32 v[150:151], v[150:151], v[110:111], v[134:135] op_sel:[0,0,0] op_sel_hi:[1,0,1]
  v_cvt_pk_bf16_f32 v152, v144, v145
  v_cvt_pk_bf16_f32 v153, v146, v147
  v_cvt_pk_bf16_f32 v154, v148, v149
  v_cvt_pk_bf16_f32 v155, v150, v151
  buffer_store_dwordx4 v[152:155], v88, s[52:55], s63 offen
  v_lshlrev_b32 v144, 16, v8
  v_and_b32 v145, 0xffff0000, v8
  v_lshlrev_b32 v146, 16, v9
  v_and_b32 v147, 0xffff0000, v9
  v_lshlrev_b32 v148, 16, v10
  v_and_b32 v149, 0xffff0000, v10
  v_lshlrev_b32 v150, 16, v11
  v_and_b32 v151, 0xffff0000, v11
  v_pk_fma_f32 v[144:145], v[144:145], v[110:111], v[136:137] op_sel:[0,1,0] op_sel_hi:[1,1,1]
  v_pk_fma_f32 v[146:147], v[146:147], v[110:111], v[138:139] op_sel:[0,1,0] op_sel_hi:[1,1,1]
  v_pk_fma_f32 v[148:149], v[148:149], v[110:111], v[140:141] op_sel:[0,1,0] op_sel_hi:[1,1,1]
  v_pk_fma_f32 v[150:151], v[150:151], v[110:111], v[142:143] op_sel:[0,1,0] op_sel_hi:[1,1,1]
  v_cvt_pk_bf16_f32 v152, v144, v145
  v_cvt_pk_bf16_f32 v153, v146, v147
  v_cvt_pk_bf16_f32 v154, v148, v149
  v_cvt_pk_bf16_f32 v155, v150, v151
  s_add_u32 s63, s63, 16384
  buffer_store_dwordx4 v[152:155], v88, s[52:55], s63 offen
L_end:
  s_endpgm
.section .rodata,"a"
.p2align 6
.amdhsa_kernel gated_mix__linear_kernel_hedgehog__mixer_s_mlp__prompt_kernel
  .amdhsa_next_free_vgpr 248
  .amdhsa_next_free_sgpr 100
  .amdhsa_accum_offset 248
  .amdhsa_group_segment_fixed_size 0
  .amdhsa_kernarg_size 104
  .amdhsa_user_sgpr_count 2
  .amdhsa_user_sgpr_kernarg_segment_ptr 1
  .amdhsa_system_sgpr_workgroup_id_x 1
  .amdhsa_float_denorm_mode_32 3
.end_amdhsa_kernel
```
